```python
import torch

def _softmax(x, axis=-1):
    return torch.softmax(x, dim=axis)

def _gelu(x):
    return torch.nn.functional.gelu(x, approximate='tanh')

def _silu(x):
    return torch.nn.functional.silu(x)

def _sigmoid(x):
    return torch.sigmoid(x)

def _layernorm(x, axis=-1, eps=1e-05):
    m = x.mean(dim=axis, keepdim=True)
    v = x.var(dim=axis, keepdim=True, unbiased=False)
    return (x - m) / torch.sqrt(v + eps)

def _scatter_add(tgt, idx, src, axis=0):
    return tgt.clone().index_add_(axis, idx, src)

def _segment_sum(src, seg, n):
    out = torch.zeros((n,) + src.shape[1:], dtype=src.dtype)
    return out.index_add_(0, seg, src)

def _pad(x, pw):
    flat = tuple((v for pair in reversed(pw) for v in pair))
    return torch.nn.functional.pad(x, flat)
kernel_name = 'interleave_layers__memory_aug_recurrent_mem_tr__geglu_ffn__prompt'

def setup_inputs():

    _w = lambda a: (lambda t: t.to(torch.bfloat16) if t.is_floating_point() else t)(torch.as_tensor(a))

    def _A_setup():
        B, S, Dm = (1, 2048, 512)
        H, Dh = (32, 128)
        M, seg = (8, 32)
        seg = min(seg, S)
        S = S // seg * seg
        return {'x': _w((lambda *s: torch.randn(*s, dtype=torch.bfloat16) * 0.05)(B, S, Dm)), 'mem0': _w((lambda *s: torch.randn(*s, dtype=torch.bfloat16) * 0.8)(B, M, Dm)), 'Wq': _w((lambda *s: torch.randn(*s, dtype=torch.bfloat16) * 0.8)(Dm, H, Dh) * Dm ** (-0.5)), 'Wk': _w((lambda *s: torch.randn(*s, dtype=torch.bfloat16) * 0.8)(Dm, H, Dh) * Dm ** (-0.5)), 'Wv': _w((lambda *s: torch.randn(*s, dtype=torch.bfloat16) * 0.8)(Dm, H, Dh) * Dm ** (-0.5)), 'Wo': _w((lambda *s: torch.randn(*s, dtype=torch.bfloat16) * 0.8)(H, Dh, Dm) * (H * Dh) ** (-0.5)), 'seg_len': seg}
    _A_in = _A_setup()

    def _B_setup():
        B, S, D, F = (1, 2048, 512, 1792)
        return {'x': _w((lambda *s: torch.randn(*s, dtype=torch.bfloat16) * 0.05)(B, S, D)), 'w_gate': _w((lambda *s: torch.randn(*s, dtype=torch.bfloat16) * 0.05)(D, F)), 'w_up': _w((lambda *s: torch.randn(*s, dtype=torch.bfloat16) * 0.05)(D, F)), 'w_down': _w((lambda *s: torch.randn(*s, dtype=torch.bfloat16) * 0.05)(F, D))}
    _B_in = _B_setup()
    return {'A_x': _A_in['x'], 'A_mem0': _A_in['mem0'], 'A_Wq': _A_in['Wq'], 'A_Wk': _A_in['Wk'], 'A_Wv': _A_in['Wv'], 'A_Wo': _A_in['Wo'], 'A_seg_len': _A_in['seg_len'], 'B_x': _B_in['x'], 'B_w_gate': _B_in['w_gate'], 'B_w_up': _B_in['w_up'], 'B_w_down': _B_in['w_down']}

def reference(A_x, A_mem0, A_Wq, A_Wk, A_Wv, A_Wo, A_seg_len, B_x, B_w_gate, B_w_up, B_w_down):

    def _A_ref(x, mem0, Wq, Wk, Wv, Wo, seg_len):
        B, S, Dm = x.shape
        H, Dh = (Wq.shape[1], Wq.shape[2])
        M = mem0.shape[1]
        scale = Dh ** (-0.5)
        n_seg = S // seg_len
        L = M + seg_len
        idx = torch.arange(L)
        mask = (idx[:, None] < M) | (idx[:, None] >= idx[None, :])
        mem = mem0
        outs = []
        for s in range(n_seg):
            xs = x[:, s * seg_len:(s + 1) * seg_len, :].clone()
            h = torch.concatenate([mem, xs], axis=1)
            q = torch.einsum('btd,dhe->bhte', h, Wq)
            k = torch.einsum('btd,dhe->bhte', h, Wk)
            v = torch.einsum('btd,dhe->bhte', h, Wv)
            scores = torch.einsum('bhqe,bhke->bhqk', q, k) * scale
            scores = torch.where(mask[None, None], scores, -1000000000.0)
            p = _softmax(scores, axis=-1)
            o = torch.einsum('bhqk,bhke->bhqe', p, v)
            o = torch.einsum('bhte,hed->btd', o, Wo)
            mem = o[:, :M, :].clone()
            outs.append(o[:, M:, :])
        return torch.concatenate(outs, axis=1)

    def _B_ref(x, w_gate, w_up, w_down):
        return _gelu(x @ w_gate) * (x @ w_up) @ w_down
    x = A_x
    x = x + _A_ref(_layernorm(x, axis=-1), A_mem0, A_Wq, A_Wk, A_Wv, A_Wo, A_seg_len)
    x = x + _B_ref(_layernorm(x, axis=-1), B_w_gate, B_w_up, B_w_down)
    x = x + _A_ref(_layernorm(x, axis=-1), A_mem0, A_Wq, A_Wk, A_Wv, A_Wo, A_seg_len)
    x = x + _B_ref(_layernorm(x, axis=-1), B_w_gate, B_w_up, B_w_down)
    return x
```

```asm
; @launch kernel=mega_kernel grid=(256,1,1) block=(256,1,1) lds=163840
.amdgcn_target "amdgcn-amd-amdhsa--gfx950"
.text
.globl mega_kernel
.p2align 8
.type mega_kernel,@function
mega_kernel:
    s_cmp_ge_u32 s2, 256
    s_cbranch_scc1 Lmega_exit
    s_load_dwordx2 s[4:5], s[0:1], 104
    s_load_dwordx2 s[6:7], s[0:1], 0
    s_load_dwordx2 s[8:9], s[0:1], 88
    s_load_dwordx2 s[10:11], s[0:1], 96
    v_lshrrev_b32 v1, 6, v0
    s_nop 0
    v_readfirstlane_b32 s20, v1
    v_and_b32 v0, 63, v0
    s_getreg_b32 s22, hwreg(HW_REG_XCC_ID)
    s_and_b32 s22, s22, 7
    s_waitcnt lgkmcnt(0)
    s_cmp_lg_u32 s20, 0
    s_cbranch_scc1 Lticket_skip
    s_mov_b64 exec, 1
    s_lshl_b32 s23, s22, 2
    v_mov_b32 v2, s23
    v_mov_b32 v3, 1
    global_atomic_add v4, v2, v3, s[10:11] sc0 sc1
    v_mov_b32 v5, 0
    s_waitcnt vmcnt(0)
    ds_write_b32 v5, v4
    s_mov_b64 exec, -1
Lticket_skip:
    s_waitcnt lgkmcnt(0)
    s_barrier
    v_mov_b32 v5, 0
    ds_read_b32 v4, v5
    s_waitcnt lgkmcnt(0)
    v_readfirstlane_b32 s21, v4
    s_barrier
    s_cmp_ge_u32 s21, 32
    s_cbranch_scc1 Lmega_exit
    s_mov_b32 s94, 100
    v_and_b32 v1, 15, v0
    v_lshrrev_b32 v2, 4, v0
    v_lshlrev_b32 v7, 4, v0
    s_mul_i32 s23, s2, 5120
    s_lshl_b32 s24, s20, 10
    s_add_u32 s23, s23, s24
    v_add_u32 v24, s23, v7
    v_mov_b32 v28, 0
    v_mov_b32 v29, 0
    v_mov_b32 v30, 0
    v_mov_b32 v31, 0
    global_store_dwordx4 v24, v[28:31], s[4:5] sc1
    s_cmp_lg_u32 s20, 0
    s_cbranch_scc1 Lz_skip
    v_add_u32 v24, 4096, v24
    global_store_dwordx4 v24, v[28:31], s[4:5] sc1
Lz_skip:
    s_waitcnt vmcnt(0)
    s_barrier
    s_cmp_lg_u32 s20, 0
    s_cbranch_scc1 Lz_skip2
    s_mov_b64 exec, 1
    v_mov_b32 v24, 32
    v_mov_b32 v25, 1
    global_atomic_add v24, v25, s[10:11] sc1
    s_mov_b64 exec, -1
Lz_skip2:
    s_cmp_eq_u32 s22, 0
    s_cbranch_scc1 Lchain
    s_cmp_le_u32 s22, 2
    s_cbranch_scc1 LroleA
    s_cmp_le_u32 s22, 4
    s_cbranch_scc1 LroleB
    s_branch LroleF
Lmega_exit:
    s_endpgm
Lchain:
    s_load_dwordx2 s[12:13], s[0:1], 16
    s_load_dwordx2 s[14:15], s[0:1], 24
    s_load_dwordx2 s[16:17], s[0:1], 32
    s_load_dwordx2 s[18:19], s[0:1], 40
    s_load_dwordx2 s[48:49], s[0:1], 8
    s_waitcnt lgkmcnt(0)
    v_and_b32 v1, 15, v0
    v_lshrrev_b32 v2, 4, v0
    v_lshlrev_b32 v7, 4, v0
    s_lshl_b32 s23, s20, 7
    v_add_u32 v24, s23, v2
    v_lshlrev_b32 v25, 13, v24
    s_lshl_b32 s24, s21, 8
    v_lshl_add_u32 v25, v1, 4, v25
    v_add_u32 v25, s24, v25
    v_mul_u32_u24 v26, 272, v24
    v_lshl_add_u32 v26, v1, 4, v26
    v_lshrrev_b32 v27, 2, v1
    v_lshl_add_u32 v27, v2, 3, v27
    v_mul_u32_u24 v27, 272, v27
    v_and_b32 v28, 3, v1
    v_lshlrev_b32 v28, 3, v28
    v_add_u32 v27, v27, v28
    s_lshl_b32 s23, s20, 6
    v_add_u32 v27, s23, v27
    v_add_u32 v28, 34816, v27
    v_add_u32 v29, 69632, v27
    v_add_u32 v30, 104448, v27
    v_add_u32 v31, 0, v25
    global_load_dwordx4 v[32:35], v31, s[12:13]
    v_add_u32 v31, 32768, v25
    global_load_dwordx4 v[36:39], v31, s[12:13]
    v_add_u32 v31, 65536, v25
    global_load_dwordx4 v[40:43], v31, s[12:13]
    v_add_u32 v31, 98304, v25
    global_load_dwordx4 v[44:47], v31, s[12:13]
    v_add_u32 v31, 131072, v25
    global_load_dwordx4 v[48:51], v31, s[12:13]
    v_add_u32 v31, 163840, v25
    global_load_dwordx4 v[52:55], v31, s[12:13]
    v_add_u32 v31, 196608, v25
    global_load_dwordx4 v[56:59], v31, s[12:13]
    v_add_u32 v31, 229376, v25
    global_load_dwordx4 v[60:63], v31, s[12:13]
    s_waitcnt vmcnt(7)
    ds_write_b128 v26, v[32:35] offset:0
    s_waitcnt vmcnt(6)
    ds_write_b128 v26, v[36:39] offset:1088
    s_waitcnt vmcnt(5)
    ds_write_b128 v26, v[40:43] offset:2176
    s_waitcnt vmcnt(4)
    ds_write_b128 v26, v[44:47] offset:3264
    s_waitcnt vmcnt(3)
    ds_write_b128 v26, v[48:51] offset:4352
    s_waitcnt vmcnt(2)
    ds_write_b128 v26, v[52:55] offset:5440
    s_waitcnt vmcnt(1)
    ds_write_b128 v26, v[56:59] offset:6528
    s_waitcnt vmcnt(0)
    ds_write_b128 v26, v[60:63] offset:7616
    v_add_u32 v31, 262144, v25
    global_load_dwordx4 v[32:35], v31, s[12:13]
    v_add_u32 v31, 294912, v25
    global_load_dwordx4 v[36:39], v31, s[12:13]
    v_add_u32 v31, 327680, v25
    global_load_dwordx4 v[40:43], v31, s[12:13]
    v_add_u32 v31, 360448, v25
    global_load_dwordx4 v[44:47], v31, s[12:13]
    v_add_u32 v31, 393216, v25
    global_load_dwordx4 v[48:51], v31, s[12:13]
    v_add_u32 v31, 425984, v25
    global_load_dwordx4 v[52:55], v31, s[12:13]
    v_add_u32 v31, 458752, v25
    global_load_dwordx4 v[56:59], v31, s[12:13]
    v_add_u32 v31, 491520, v25
    global_load_dwordx4 v[60:63], v31, s[12:13]
    s_waitcnt vmcnt(7)
    ds_write_b128 v26, v[32:35] offset:8704
    s_waitcnt vmcnt(6)
    ds_write_b128 v26, v[36:39] offset:9792
    s_waitcnt vmcnt(5)
    ds_write_b128 v26, v[40:43] offset:10880
    s_waitcnt vmcnt(4)
    ds_write_b128 v26, v[44:47] offset:11968
    s_waitcnt vmcnt(3)
    ds_write_b128 v26, v[48:51] offset:13056
    s_waitcnt vmcnt(2)
    ds_write_b128 v26, v[52:55] offset:14144
    s_waitcnt vmcnt(1)
    ds_write_b128 v26, v[56:59] offset:15232
    s_waitcnt vmcnt(0)
    ds_write_b128 v26, v[60:63] offset:16320
    v_add_u32 v31, 524288, v25
    global_load_dwordx4 v[32:35], v31, s[12:13]
    v_add_u32 v31, 557056, v25
    global_load_dwordx4 v[36:39], v31, s[12:13]
    v_add_u32 v31, 589824, v25
    global_load_dwordx4 v[40:43], v31, s[12:13]
    v_add_u32 v31, 622592, v25
    global_load_dwordx4 v[44:47], v31, s[12:13]
    v_add_u32 v31, 655360, v25
    global_load_dwordx4 v[48:51], v31, s[12:13]
    v_add_u32 v31, 688128, v25
    global_load_dwordx4 v[52:55], v31, s[12:13]
    v_add_u32 v31, 720896, v25
    global_load_dwordx4 v[56:59], v31, s[12:13]
    v_add_u32 v31, 753664, v25
    global_load_dwordx4 v[60:63], v31, s[12:13]
    s_waitcnt vmcnt(7)
    ds_write_b128 v26, v[32:35] offset:17408
    s_waitcnt vmcnt(6)
    ds_write_b128 v26, v[36:39] offset:18496
    s_waitcnt vmcnt(5)
    ds_write_b128 v26, v[40:43] offset:19584
    s_waitcnt vmcnt(4)
    ds_write_b128 v26, v[44:47] offset:20672
    s_waitcnt vmcnt(3)
    ds_write_b128 v26, v[48:51] offset:21760
    s_waitcnt vmcnt(2)
    ds_write_b128 v26, v[52:55] offset:22848
    s_waitcnt vmcnt(1)
    ds_write_b128 v26, v[56:59] offset:23936
    s_waitcnt vmcnt(0)
    ds_write_b128 v26, v[60:63] offset:25024
    v_add_u32 v31, 786432, v25
    global_load_dwordx4 v[32:35], v31, s[12:13]
    v_add_u32 v31, 819200, v25
    global_load_dwordx4 v[36:39], v31, s[12:13]
    v_add_u32 v31, 851968, v25
    global_load_dwordx4 v[40:43], v31, s[12:13]
    v_add_u32 v31, 884736, v25
    global_load_dwordx4 v[44:47], v31, s[12:13]
    v_add_u32 v31, 917504, v25
    global_load_dwordx4 v[48:51], v31, s[12:13]
    v_add_u32 v31, 950272, v25
    global_load_dwordx4 v[52:55], v31, s[12:13]
    v_add_u32 v31, 983040, v25
    global_load_dwordx4 v[56:59], v31, s[12:13]
    v_add_u32 v31, 1015808, v25
    global_load_dwordx4 v[60:63], v31, s[12:13]
    s_waitcnt vmcnt(7)
    ds_write_b128 v26, v[32:35] offset:26112
    s_waitcnt vmcnt(6)
    ds_write_b128 v26, v[36:39] offset:27200
    s_waitcnt vmcnt(5)
    ds_write_b128 v26, v[40:43] offset:28288
    s_waitcnt vmcnt(4)
    ds_write_b128 v26, v[44:47] offset:29376
    s_waitcnt vmcnt(3)
    ds_write_b128 v26, v[48:51] offset:30464
    s_waitcnt vmcnt(2)
    ds_write_b128 v26, v[52:55] offset:31552
    s_waitcnt vmcnt(1)
    ds_write_b128 v26, v[56:59] offset:32640
    s_waitcnt vmcnt(0)
    ds_write_b128 v26, v[60:63] offset:33728
    s_waitcnt lgkmcnt(0)
    s_barrier
    ds_read_b64_tr_b16 a[0:1], v27 offset:0
    ds_read_b64_tr_b16 a[2:3], v27 offset:1088
    ds_read_b64_tr_b16 a[4:5], v27 offset:8704
    ds_read_b64_tr_b16 a[6:7], v27 offset:9792
    ds_read_b64_tr_b16 a[8:9], v27 offset:17408
    ds_read_b64_tr_b16 a[10:11], v27 offset:18496
    ds_read_b64_tr_b16 a[12:13], v27 offset:26112
    ds_read_b64_tr_b16 a[14:15], v27 offset:27200
    ds_read_b64_tr_b16 a[16:17], v28 offset:0
    ds_read_b64_tr_b16 a[18:19], v28 offset:1088
    ds_read_b64_tr_b16 a[20:21], v28 offset:8704
    ds_read_b64_tr_b16 a[22:23], v28 offset:9792
    ds_read_b64_tr_b16 a[24:25], v28 offset:17408
    ds_read_b64_tr_b16 a[26:27], v28 offset:18496
    ds_read_b64_tr_b16 a[28:29], v28 offset:26112
    ds_read_b64_tr_b16 a[30:31], v28 offset:27200
    ds_read_b64_tr_b16 a[32:33], v29 offset:0
    ds_read_b64_tr_b16 a[34:35], v29 offset:1088
    ds_read_b64_tr_b16 a[36:37], v29 offset:8704
    ds_read_b64_tr_b16 a[38:39], v29 offset:9792
    ds_read_b64_tr_b16 a[40:41], v29 offset:17408
    ds_read_b64_tr_b16 a[42:43], v29 offset:18496
    ds_read_b64_tr_b16 a[44:45], v29 offset:26112
    ds_read_b64_tr_b16 a[46:47], v29 offset:27200
    ds_read_b64_tr_b16 a[48:49], v30 offset:0
    ds_read_b64_tr_b16 a[50:51], v30 offset:1088
    ds_read_b64_tr_b16 a[52:53], v30 offset:8704
    ds_read_b64_tr_b16 a[54:55], v30 offset:9792
    ds_read_b64_tr_b16 a[56:57], v30 offset:17408
    ds_read_b64_tr_b16 a[58:59], v30 offset:18496
    ds_read_b64_tr_b16 a[60:61], v30 offset:26112
    ds_read_b64_tr_b16 a[62:63], v30 offset:27200
    ds_read_b64_tr_b16 a[64:65], v27 offset:32
    ds_read_b64_tr_b16 a[66:67], v27 offset:1120
    ds_read_b64_tr_b16 a[68:69], v27 offset:8736
    ds_read_b64_tr_b16 a[70:71], v27 offset:9824
    ds_read_b64_tr_b16 a[72:73], v27 offset:17440
    ds_read_b64_tr_b16 a[74:75], v27 offset:18528
    ds_read_b64_tr_b16 a[76:77], v27 offset:26144
    ds_read_b64_tr_b16 a[78:79], v27 offset:27232
    ds_read_b64_tr_b16 a[80:81], v28 offset:32
    ds_read_b64_tr_b16 a[82:83], v28 offset:1120
    ds_read_b64_tr_b16 a[84:85], v28 offset:8736
    ds_read_b64_tr_b16 a[86:87], v28 offset:9824
    ds_read_b64_tr_b16 a[88:89], v28 offset:17440
    ds_read_b64_tr_b16 a[90:91], v28 offset:18528
    ds_read_b64_tr_b16 a[92:93], v28 offset:26144
    ds_read_b64_tr_b16 a[94:95], v28 offset:27232
    ds_read_b64_tr_b16 a[96:97], v29 offset:32
    ds_read_b64_tr_b16 a[98:99], v29 offset:1120
    ds_read_b64_tr_b16 a[100:101], v29 offset:8736
    ds_read_b64_tr_b16 a[102:103], v29 offset:9824
    ds_read_b64_tr_b16 a[104:105], v29 offset:17440
    ds_read_b64_tr_b16 a[106:107], v29 offset:18528
    ds_read_b64_tr_b16 a[108:109], v29 offset:26144
    ds_read_b64_tr_b16 a[110:111], v29 offset:27232
    ds_read_b64_tr_b16 a[112:113], v30 offset:32
    ds_read_b64_tr_b16 a[114:115], v30 offset:1120
    ds_read_b64_tr_b16 a[116:117], v30 offset:8736
    ds_read_b64_tr_b16 a[118:119], v30 offset:9824
    ds_read_b64_tr_b16 a[120:121], v30 offset:17440
    ds_read_b64_tr_b16 a[122:123], v30 offset:18528
    ds_read_b64_tr_b16 a[124:125], v30 offset:26144
    ds_read_b64_tr_b16 a[126:127], v30 offset:27232
    s_waitcnt lgkmcnt(0)
    s_barrier
    v_add_u32 v31, 0, v25
    global_load_dwordx4 v[32:35], v31, s[14:15]
    v_add_u32 v31, 32768, v25
    global_load_dwordx4 v[36:39], v31, s[14:15]
    v_add_u32 v31, 65536, v25
    global_load_dwordx4 v[40:43], v31, s[14:15]
    v_add_u32 v31, 98304, v25
    global_load_dwordx4 v[44:47], v31, s[14:15]
    v_add_u32 v31, 131072, v25
    global_load_dwordx4 v[48:51], v31, s[14:15]
    v_add_u32 v31, 163840, v25
    global_load_dwordx4 v[52:55], v31, s[14:15]
    v_add_u32 v31, 196608, v25
    global_load_dwordx4 v[56:59], v31, s[14:15]
    v_add_u32 v31, 229376, v25
    global_load_dwordx4 v[60:63], v31, s[14:15]
    s_waitcnt vmcnt(7)
    ds_write_b128 v26, v[32:35] offset:0
    s_waitcnt vmcnt(6)
    ds_write_b128 v26, v[36:39] offset:1088
    s_waitcnt vmcnt(5)
    ds_write_b128 v26, v[40:43] offset:2176
    s_waitcnt vmcnt(4)
    ds_write_b128 v26, v[44:47] offset:3264
    s_waitcnt vmcnt(3)
    ds_write_b128 v26, v[48:51] offset:4352
    s_waitcnt vmcnt(2)
    ds_write_b128 v26, v[52:55] offset:5440
    s_waitcnt vmcnt(1)
    ds_write_b128 v26, v[56:59] offset:6528
    s_waitcnt vmcnt(0)
    ds_write_b128 v26, v[60:63] offset:7616
    v_add_u32 v31, 262144, v25
    global_load_dwordx4 v[32:35], v31, s[14:15]
    v_add_u32 v31, 294912, v25
    global_load_dwordx4 v[36:39], v31, s[14:15]
    v_add_u32 v31, 327680, v25
    global_load_dwordx4 v[40:43], v31, s[14:15]
    v_add_u32 v31, 360448, v25
    global_load_dwordx4 v[44:47], v31, s[14:15]
    v_add_u32 v31, 393216, v25
    global_load_dwordx4 v[48:51], v31, s[14:15]
    v_add_u32 v31, 425984, v25
    global_load_dwordx4 v[52:55], v31, s[14:15]
    v_add_u32 v31, 458752, v25
    global_load_dwordx4 v[56:59], v31, s[14:15]
    v_add_u32 v31, 491520, v25
    global_load_dwordx4 v[60:63], v31, s[14:15]
    s_waitcnt vmcnt(7)
    ds_write_b128 v26, v[32:35] offset:8704
    s_waitcnt vmcnt(6)
    ds_write_b128 v26, v[36:39] offset:9792
    s_waitcnt vmcnt(5)
    ds_write_b128 v26, v[40:43] offset:10880
    s_waitcnt vmcnt(4)
    ds_write_b128 v26, v[44:47] offset:11968
    s_waitcnt vmcnt(3)
    ds_write_b128 v26, v[48:51] offset:13056
    s_waitcnt vmcnt(2)
    ds_write_b128 v26, v[52:55] offset:14144
    s_waitcnt vmcnt(1)
    ds_write_b128 v26, v[56:59] offset:15232
    s_waitcnt vmcnt(0)
    ds_write_b128 v26, v[60:63] offset:16320
    v_add_u32 v31, 524288, v25
    global_load_dwordx4 v[32:35], v31, s[14:15]
    v_add_u32 v31, 557056, v25
    global_load_dwordx4 v[36:39], v31, s[14:15]
    v_add_u32 v31, 589824, v25
    global_load_dwordx4 v[40:43], v31, s[14:15]
    v_add_u32 v31, 622592, v25
    global_load_dwordx4 v[44:47], v31, s[14:15]
    v_add_u32 v31, 655360, v25
    global_load_dwordx4 v[48:51], v31, s[14:15]
    v_add_u32 v31, 688128, v25
    global_load_dwordx4 v[52:55], v31, s[14:15]
    v_add_u32 v31, 720896, v25
    global_load_dwordx4 v[56:59], v31, s[14:15]
    v_add_u32 v31, 753664, v25
    global_load_dwordx4 v[60:63], v31, s[14:15]
    s_waitcnt vmcnt(7)
    ds_write_b128 v26, v[32:35] offset:17408
    s_waitcnt vmcnt(6)
    ds_write_b128 v26, v[36:39] offset:18496
    s_waitcnt vmcnt(5)
    ds_write_b128 v26, v[40:43] offset:19584
    s_waitcnt vmcnt(4)
    ds_write_b128 v26, v[44:47] offset:20672
    s_waitcnt vmcnt(3)
    ds_write_b128 v26, v[48:51] offset:21760
    s_waitcnt vmcnt(2)
    ds_write_b128 v26, v[52:55] offset:22848
    s_waitcnt vmcnt(1)
    ds_write_b128 v26, v[56:59] offset:23936
    s_waitcnt vmcnt(0)
    ds_write_b128 v26, v[60:63] offset:25024
    v_add_u32 v31, 786432, v25
    global_load_dwordx4 v[32:35], v31, s[14:15]
    v_add_u32 v31, 819200, v25
    global_load_dwordx4 v[36:39], v31, s[14:15]
    v_add_u32 v31, 851968, v25
    global_load_dwordx4 v[40:43], v31, s[14:15]
    v_add_u32 v31, 884736, v25
    global_load_dwordx4 v[44:47], v31, s[14:15]
    v_add_u32 v31, 917504, v25
    global_load_dwordx4 v[48:51], v31, s[14:15]
    v_add_u32 v31, 950272, v25
    global_load_dwordx4 v[52:55], v31, s[14:15]
    v_add_u32 v31, 983040, v25
    global_load_dwordx4 v[56:59], v31, s[14:15]
    v_add_u32 v31, 1015808, v25
    global_load_dwordx4 v[60:63], v31, s[14:15]
    s_waitcnt vmcnt(7)
    ds_write_b128 v26, v[32:35] offset:26112
    s_waitcnt vmcnt(6)
    ds_write_b128 v26, v[36:39] offset:27200
    s_waitcnt vmcnt(5)
    ds_write_b128 v26, v[40:43] offset:28288
    s_waitcnt vmcnt(4)
    ds_write_b128 v26, v[44:47] offset:29376
    s_waitcnt vmcnt(3)
    ds_write_b128 v26, v[48:51] offset:30464
    s_waitcnt vmcnt(2)
    ds_write_b128 v26, v[52:55] offset:31552
    s_waitcnt vmcnt(1)
    ds_write_b128 v26, v[56:59] offset:32640
    s_waitcnt vmcnt(0)
    ds_write_b128 v26, v[60:63] offset:33728
    s_waitcnt lgkmcnt(0)
    s_barrier
    ds_read_b64_tr_b16 a[128:129], v27 offset:0
    ds_read_b64_tr_b16 a[130:131], v27 offset:1088
    ds_read_b64_tr_b16 a[132:133], v27 offset:8704
    ds_read_b64_tr_b16 a[134:135], v27 offset:9792
    ds_read_b64_tr_b16 a[136:137], v27 offset:17408
    ds_read_b64_tr_b16 a[138:139], v27 offset:18496
    ds_read_b64_tr_b16 a[140:141], v27 offset:26112
    ds_read_b64_tr_b16 a[142:143], v27 offset:27200
    ds_read_b64_tr_b16 a[144:145], v28 offset:0
    ds_read_b64_tr_b16 a[146:147], v28 offset:1088
    ds_read_b64_tr_b16 a[148:149], v28 offset:8704
    ds_read_b64_tr_b16 a[150:151], v28 offset:9792
    ds_read_b64_tr_b16 a[152:153], v28 offset:17408
    ds_read_b64_tr_b16 a[154:155], v28 offset:18496
    ds_read_b64_tr_b16 a[156:157], v28 offset:26112
    ds_read_b64_tr_b16 a[158:159], v28 offset:27200
    ds_read_b64_tr_b16 a[160:161], v29 offset:0
    ds_read_b64_tr_b16 a[162:163], v29 offset:1088
    ds_read_b64_tr_b16 a[164:165], v29 offset:8704
    ds_read_b64_tr_b16 a[166:167], v29 offset:9792
    ds_read_b64_tr_b16 a[168:169], v29 offset:17408
    ds_read_b64_tr_b16 a[170:171], v29 offset:18496
    ds_read_b64_tr_b16 a[172:173], v29 offset:26112
    ds_read_b64_tr_b16 a[174:175], v29 offset:27200
    ds_read_b64_tr_b16 a[176:177], v30 offset:0
    ds_read_b64_tr_b16 a[178:179], v30 offset:1088
    ds_read_b64_tr_b16 a[180:181], v30 offset:8704
    ds_read_b64_tr_b16 a[182:183], v30 offset:9792
    ds_read_b64_tr_b16 a[184:185], v30 offset:17408
    ds_read_b64_tr_b16 a[186:187], v30 offset:18496
    ds_read_b64_tr_b16 a[188:189], v30 offset:26112
    ds_read_b64_tr_b16 a[190:191], v30 offset:27200
    ds_read_b64_tr_b16 a[192:193], v27 offset:32
    ds_read_b64_tr_b16 a[194:195], v27 offset:1120
    ds_read_b64_tr_b16 a[196:197], v27 offset:8736
    ds_read_b64_tr_b16 a[198:199], v27 offset:9824
    ds_read_b64_tr_b16 a[200:201], v27 offset:17440
    ds_read_b64_tr_b16 a[202:203], v27 offset:18528
    ds_read_b64_tr_b16 a[204:205], v27 offset:26144
    ds_read_b64_tr_b16 a[206:207], v27 offset:27232
    ds_read_b64_tr_b16 a[208:209], v28 offset:32
    ds_read_b64_tr_b16 a[210:211], v28 offset:1120
    ds_read_b64_tr_b16 a[212:213], v28 offset:8736
    ds_read_b64_tr_b16 a[214:215], v28 offset:9824
    ds_read_b64_tr_b16 a[216:217], v28 offset:17440
    ds_read_b64_tr_b16 a[218:219], v28 offset:18528
    ds_read_b64_tr_b16 a[220:221], v28 offset:26144
    ds_read_b64_tr_b16 a[222:223], v28 offset:27232
    ds_read_b64_tr_b16 a[224:225], v29 offset:32
    ds_read_b64_tr_b16 a[226:227], v29 offset:1120
    ds_read_b64_tr_b16 a[228:229], v29 offset:8736
    ds_read_b64_tr_b16 a[230:231], v29 offset:9824
    ds_read_b64_tr_b16 a[232:233], v29 offset:17440
    ds_read_b64_tr_b16 a[234:235], v29 offset:18528
    ds_read_b64_tr_b16 a[236:237], v29 offset:26144
    ds_read_b64_tr_b16 a[238:239], v29 offset:27232
    ds_read_b64_tr_b16 a[240:241], v30 offset:32
    ds_read_b64_tr_b16 a[242:243], v30 offset:1120
    ds_read_b64_tr_b16 a[244:245], v30 offset:8736
    ds_read_b64_tr_b16 a[246:247], v30 offset:9824
    ds_read_b64_tr_b16 a[248:249], v30 offset:17440
    ds_read_b64_tr_b16 a[250:251], v30 offset:18528
    ds_read_b64_tr_b16 a[252:253], v30 offset:26144
    ds_read_b64_tr_b16 a[254:255], v30 offset:27232
    s_waitcnt lgkmcnt(0)
    s_barrier
    v_add_u32 v31, 0, v25
    global_load_dwordx4 v[32:35], v31, s[16:17]
    v_add_u32 v31, 32768, v25
    global_load_dwordx4 v[36:39], v31, s[16:17]
    v_add_u32 v31, 65536, v25
    global_load_dwordx4 v[40:43], v31, s[16:17]
    v_add_u32 v31, 98304, v25
    global_load_dwordx4 v[44:47], v31, s[16:17]
    v_add_u32 v31, 131072, v25
    global_load_dwordx4 v[48:51], v31, s[16:17]
    v_add_u32 v31, 163840, v25
    global_load_dwordx4 v[52:55], v31, s[16:17]
    v_add_u32 v31, 196608, v25
    global_load_dwordx4 v[56:59], v31, s[16:17]
    v_add_u32 v31, 229376, v25
    global_load_dwordx4 v[60:63], v31, s[16:17]
    s_waitcnt vmcnt(7)
    ds_write_b128 v26, v[32:35] offset:0
    s_waitcnt vmcnt(6)
    ds_write_b128 v26, v[36:39] offset:1088
    s_waitcnt vmcnt(5)
    ds_write_b128 v26, v[40:43] offset:2176
    s_waitcnt vmcnt(4)
    ds_write_b128 v26, v[44:47] offset:3264
    s_waitcnt vmcnt(3)
    ds_write_b128 v26, v[48:51] offset:4352
    s_waitcnt vmcnt(2)
    ds_write_b128 v26, v[52:55] offset:5440
    s_waitcnt vmcnt(1)
    ds_write_b128 v26, v[56:59] offset:6528
    s_waitcnt vmcnt(0)
    ds_write_b128 v26, v[60:63] offset:7616
    v_add_u32 v31, 262144, v25
    global_load_dwordx4 v[32:35], v31, s[16:17]
    v_add_u32 v31, 294912, v25
    global_load_dwordx4 v[36:39], v31, s[16:17]
    v_add_u32 v31, 327680, v25
    global_load_dwordx4 v[40:43], v31, s[16:17]
    v_add_u32 v31, 360448, v25
    global_load_dwordx4 v[44:47], v31, s[16:17]
    v_add_u32 v31, 393216, v25
    global_load_dwordx4 v[48:51], v31, s[16:17]
    v_add_u32 v31, 425984, v25
    global_load_dwordx4 v[52:55], v31, s[16:17]
    v_add_u32 v31, 458752, v25
    global_load_dwordx4 v[56:59], v31, s[16:17]
    v_add_u32 v31, 491520, v25
    global_load_dwordx4 v[60:63], v31, s[16:17]
    s_waitcnt vmcnt(7)
    ds_write_b128 v26, v[32:35] offset:8704
    s_waitcnt vmcnt(6)
    ds_write_b128 v26, v[36:39] offset:9792
    s_waitcnt vmcnt(5)
    ds_write_b128 v26, v[40:43] offset:10880
    s_waitcnt vmcnt(4)
    ds_write_b128 v26, v[44:47] offset:11968
    s_waitcnt vmcnt(3)
    ds_write_b128 v26, v[48:51] offset:13056
    s_waitcnt vmcnt(2)
    ds_write_b128 v26, v[52:55] offset:14144
    s_waitcnt vmcnt(1)
    ds_write_b128 v26, v[56:59] offset:15232
    s_waitcnt vmcnt(0)
    ds_write_b128 v26, v[60:63] offset:16320
    v_add_u32 v31, 524288, v25
    global_load_dwordx4 v[32:35], v31, s[16:17]
    v_add_u32 v31, 557056, v25
    global_load_dwordx4 v[36:39], v31, s[16:17]
    v_add_u32 v31, 589824, v25
    global_load_dwordx4 v[40:43], v31, s[16:17]
    v_add_u32 v31, 622592, v25
    global_load_dwordx4 v[44:47], v31, s[16:17]
    v_add_u32 v31, 655360, v25
    global_load_dwordx4 v[48:51], v31, s[16:17]
    v_add_u32 v31, 688128, v25
    global_load_dwordx4 v[52:55], v31, s[16:17]
    v_add_u32 v31, 720896, v25
    global_load_dwordx4 v[56:59], v31, s[16:17]
    v_add_u32 v31, 753664, v25
    global_load_dwordx4 v[60:63], v31, s[16:17]
    s_waitcnt vmcnt(7)
    ds_write_b128 v26, v[32:35] offset:17408
    s_waitcnt vmcnt(6)
    ds_write_b128 v26, v[36:39] offset:18496
    s_waitcnt vmcnt(5)
    ds_write_b128 v26, v[40:43] offset:19584
    s_waitcnt vmcnt(4)
    ds_write_b128 v26, v[44:47] offset:20672
    s_waitcnt vmcnt(3)
    ds_write_b128 v26, v[48:51] offset:21760
    s_waitcnt vmcnt(2)
    ds_write_b128 v26, v[52:55] offset:22848
    s_waitcnt vmcnt(1)
    ds_write_b128 v26, v[56:59] offset:23936
    s_waitcnt vmcnt(0)
    ds_write_b128 v26, v[60:63] offset:25024
    v_add_u32 v31, 786432, v25
    global_load_dwordx4 v[32:35], v31, s[16:17]
    v_add_u32 v31, 819200, v25
    global_load_dwordx4 v[36:39], v31, s[16:17]
    v_add_u32 v31, 851968, v25
    global_load_dwordx4 v[40:43], v31, s[16:17]
    v_add_u32 v31, 884736, v25
    global_load_dwordx4 v[44:47], v31, s[16:17]
    v_add_u32 v31, 917504, v25
    global_load_dwordx4 v[48:51], v31, s[16:17]
    v_add_u32 v31, 950272, v25
    global_load_dwordx4 v[52:55], v31, s[16:17]
    v_add_u32 v31, 983040, v25
    global_load_dwordx4 v[56:59], v31, s[16:17]
    v_add_u32 v31, 1015808, v25
    global_load_dwordx4 v[60:63], v31, s[16:17]
    s_waitcnt vmcnt(7)
    ds_write_b128 v26, v[32:35] offset:26112
    s_waitcnt vmcnt(6)
    ds_write_b128 v26, v[36:39] offset:27200
    s_waitcnt vmcnt(5)
    ds_write_b128 v26, v[40:43] offset:28288
    s_waitcnt vmcnt(4)
    ds_write_b128 v26, v[44:47] offset:29376
    s_waitcnt vmcnt(3)
    ds_write_b128 v26, v[48:51] offset:30464
    s_waitcnt vmcnt(2)
    ds_write_b128 v26, v[52:55] offset:31552
    s_waitcnt vmcnt(1)
    ds_write_b128 v26, v[56:59] offset:32640
    s_waitcnt vmcnt(0)
    ds_write_b128 v26, v[60:63] offset:33728
    s_waitcnt lgkmcnt(0)
    s_barrier
    ds_read_b64_tr_b16 v[128:129], v27 offset:0
    ds_read_b64_tr_b16 v[130:131], v27 offset:1088
    ds_read_b64_tr_b16 v[132:133], v27 offset:8704
    ds_read_b64_tr_b16 v[134:135], v27 offset:9792
    ds_read_b64_tr_b16 v[136:137], v27 offset:17408
    ds_read_b64_tr_b16 v[138:139], v27 offset:18496
    ds_read_b64_tr_b16 v[140:141], v27 offset:26112
    ds_read_b64_tr_b16 v[142:143], v27 offset:27200
    ds_read_b64_tr_b16 v[144:145], v28 offset:0
    ds_read_b64_tr_b16 v[146:147], v28 offset:1088
    ds_read_b64_tr_b16 v[148:149], v28 offset:8704
    ds_read_b64_tr_b16 v[150:151], v28 offset:9792
    ds_read_b64_tr_b16 v[152:153], v28 offset:17408
    ds_read_b64_tr_b16 v[154:155], v28 offset:18496
    ds_read_b64_tr_b16 v[156:157], v28 offset:26112
    ds_read_b64_tr_b16 v[158:159], v28 offset:27200
    ds_read_b64_tr_b16 v[160:161], v29 offset:0
    ds_read_b64_tr_b16 v[162:163], v29 offset:1088
    ds_read_b64_tr_b16 v[164:165], v29 offset:8704
    ds_read_b64_tr_b16 v[166:167], v29 offset:9792
    ds_read_b64_tr_b16 v[168:169], v29 offset:17408
    ds_read_b64_tr_b16 v[170:171], v29 offset:18496
    ds_read_b64_tr_b16 v[172:173], v29 offset:26112
    ds_read_b64_tr_b16 v[174:175], v29 offset:27200
    ds_read_b64_tr_b16 v[176:177], v30 offset:0
    ds_read_b64_tr_b16 v[178:179], v30 offset:1088
    ds_read_b64_tr_b16 v[180:181], v30 offset:8704
    ds_read_b64_tr_b16 v[182:183], v30 offset:9792
    ds_read_b64_tr_b16 v[184:185], v30 offset:17408
    ds_read_b64_tr_b16 v[186:187], v30 offset:18496
    ds_read_b64_tr_b16 v[188:189], v30 offset:26112
    ds_read_b64_tr_b16 v[190:191], v30 offset:27200
    ds_read_b64_tr_b16 v[192:193], v27 offset:32
    ds_read_b64_tr_b16 v[194:195], v27 offset:1120
    ds_read_b64_tr_b16 v[196:197], v27 offset:8736
    ds_read_b64_tr_b16 v[198:199], v27 offset:9824
    ds_read_b64_tr_b16 v[200:201], v27 offset:17440
    ds_read_b64_tr_b16 v[202:203], v27 offset:18528
    ds_read_b64_tr_b16 v[204:205], v27 offset:26144
    ds_read_b64_tr_b16 v[206:207], v27 offset:27232
    ds_read_b64_tr_b16 v[208:209], v28 offset:32
    ds_read_b64_tr_b16 v[210:211], v28 offset:1120
    ds_read_b64_tr_b16 v[212:213], v28 offset:8736
    ds_read_b64_tr_b16 v[214:215], v28 offset:9824
    ds_read_b64_tr_b16 v[216:217], v28 offset:17440
    ds_read_b64_tr_b16 v[218:219], v28 offset:18528
    ds_read_b64_tr_b16 v[220:221], v28 offset:26144
    ds_read_b64_tr_b16 v[222:223], v28 offset:27232
    ds_read_b64_tr_b16 v[224:225], v29 offset:32
    ds_read_b64_tr_b16 v[226:227], v29 offset:1120
    ds_read_b64_tr_b16 v[228:229], v29 offset:8736
    ds_read_b64_tr_b16 v[230:231], v29 offset:9824
    ds_read_b64_tr_b16 v[232:233], v29 offset:17440
    ds_read_b64_tr_b16 v[234:235], v29 offset:18528
    ds_read_b64_tr_b16 v[236:237], v29 offset:26144
    ds_read_b64_tr_b16 v[238:239], v29 offset:27232
    ds_read_b64_tr_b16 v[240:241], v30 offset:32
    ds_read_b64_tr_b16 v[242:243], v30 offset:1120
    ds_read_b64_tr_b16 v[244:245], v30 offset:8736
    ds_read_b64_tr_b16 v[246:247], v30 offset:9824
    ds_read_b64_tr_b16 v[248:249], v30 offset:17440
    ds_read_b64_tr_b16 v[250:251], v30 offset:18528
    ds_read_b64_tr_b16 v[252:253], v30 offset:26144
    ds_read_b64_tr_b16 v[254:255], v30 offset:27232
    s_waitcnt lgkmcnt(0)
    s_barrier
    s_lshl_b32 s23, s21, 17
    s_lshl_b32 s24, s20, 12
    s_add_u32 s23, s23, s24
    v_add_u32 v24, s23, v7
    s_mul_i32 s24, s20, 4160
    v_add_u32 v25, s24, v7
    v_add_u32 v25, 131072, v25
    v_lshrrev_b32 v26, 2, v1
    v_lshl_add_u32 v26, v2, 2, v26
    v_mul_u32_u24 v26, 1040, v26
    v_and_b32 v27, 3, v1
    v_lshl_add_u32 v26, v27, 3, v26
    s_lshl_b32 s24, s20, 8
    v_add_u32 v26, s24, v26
    v_add_u32 v26, 131072, v26
    s_lshl_b32 s24, s20, 13
    v_add_u32 v27, s24, v7
    v_add_u32 v28, 65536, v27
    v_add_u32 v29, 0, v24
    global_load_dwordx4 v[32:35], v29, s[18:19] offset:0
    global_load_dwordx4 v[36:39], v29, s[18:19] offset:1024
    global_load_dwordx4 v[40:43], v29, s[18:19] offset:2048
    global_load_dwordx4 v[44:47], v29, s[18:19] offset:3072
    s_waitcnt vmcnt(3)
    ds_write_b128 v25, v[32:35] offset:0
    s_waitcnt vmcnt(2)
    ds_write_b128 v25, v[36:39] offset:1040
    s_waitcnt vmcnt(1)
    ds_write_b128 v25, v[40:43] offset:2080
    s_waitcnt vmcnt(0)
    ds_write_b128 v25, v[44:47] offset:3120
    s_waitcnt lgkmcnt(0)
    s_barrier
    ds_read_b64_tr_b16 v[48:49], v26 offset:0
    ds_read_b64_tr_b16 v[50:51], v26 offset:32
    ds_read_b64_tr_b16 v[52:53], v26 offset:64
    ds_read_b64_tr_b16 v[54:55], v26 offset:96
    ds_read_b64_tr_b16 v[56:57], v26 offset:128
    ds_read_b64_tr_b16 v[58:59], v26 offset:160
    ds_read_b64_tr_b16 v[60:61], v26 offset:192
    ds_read_b64_tr_b16 v[62:63], v26 offset:224
    s_waitcnt lgkmcnt(7)
    ds_write_b64 v27, v[48:49] offset:0
    s_waitcnt lgkmcnt(6)
    ds_write_b64 v27, v[50:51] offset:1024
    s_waitcnt lgkmcnt(5)
    ds_write_b64 v27, v[52:53] offset:2048
    s_waitcnt lgkmcnt(4)
    ds_write_b64 v27, v[54:55] offset:3072
    s_waitcnt lgkmcnt(3)
    ds_write_b64 v27, v[56:57] offset:4096
    s_waitcnt lgkmcnt(2)
    ds_write_b64 v27, v[58:59] offset:5120
    s_waitcnt lgkmcnt(1)
    ds_write_b64 v27, v[60:61] offset:6144
    s_waitcnt lgkmcnt(0)
    ds_write_b64 v27, v[62:63] offset:7168
    s_waitcnt lgkmcnt(0)
    s_barrier
    v_add_u32 v29, 16384, v24
    global_load_dwordx4 v[32:35], v29, s[18:19] offset:0
    global_load_dwordx4 v[36:39], v29, s[18:19] offset:1024
    global_load_dwordx4 v[40:43], v29, s[18:19] offset:2048
    global_load_dwordx4 v[44:47], v29, s[18:19] offset:3072
    s_waitcnt vmcnt(3)
    ds_write_b128 v25, v[32:35] offset:0
    s_waitcnt vmcnt(2)
    ds_write_b128 v25, v[36:39] offset:1040
    s_waitcnt vmcnt(1)
    ds_write_b128 v25, v[40:43] offset:2080
    s_waitcnt vmcnt(0)
    ds_write_b128 v25, v[44:47] offset:3120
    s_waitcnt lgkmcnt(0)
    s_barrier
    ds_read_b64_tr_b16 v[48:49], v26 offset:0
    ds_read_b64_tr_b16 v[50:51], v26 offset:32
    ds_read_b64_tr_b16 v[52:53], v26 offset:64
    ds_read_b64_tr_b16 v[54:55], v26 offset:96
    ds_read_b64_tr_b16 v[56:57], v26 offset:128
    ds_read_b64_tr_b16 v[58:59], v26 offset:160
    ds_read_b64_tr_b16 v[60:61], v26 offset:192
    ds_read_b64_tr_b16 v[62:63], v26 offset:224
    s_waitcnt lgkmcnt(7)
    ds_write_b64 v27, v[48:49] offset:8
    s_waitcnt lgkmcnt(6)
    ds_write_b64 v27, v[50:51] offset:1032
    s_waitcnt lgkmcnt(5)
    ds_write_b64 v27, v[52:53] offset:2056
    s_waitcnt lgkmcnt(4)
    ds_write_b64 v27, v[54:55] offset:3080
    s_waitcnt lgkmcnt(3)
    ds_write_b64 v27, v[56:57] offset:4104
    s_waitcnt lgkmcnt(2)
    ds_write_b64 v27, v[58:59] offset:5128
    s_waitcnt lgkmcnt(1)
    ds_write_b64 v27, v[60:61] offset:6152
    s_waitcnt lgkmcnt(0)
    ds_write_b64 v27, v[62:63] offset:7176
    s_waitcnt lgkmcnt(0)
    s_barrier
    v_add_u32 v29, 32768, v24
    global_load_dwordx4 v[32:35], v29, s[18:19] offset:0
    global_load_dwordx4 v[36:39], v29, s[18:19] offset:1024
    global_load_dwordx4 v[40:43], v29, s[18:19] offset:2048
    global_load_dwordx4 v[44:47], v29, s[18:19] offset:3072
    s_waitcnt vmcnt(3)
    ds_write_b128 v25, v[32:35] offset:0
    s_waitcnt vmcnt(2)
    ds_write_b128 v25, v[36:39] offset:1040
    s_waitcnt vmcnt(1)
    ds_write_b128 v25, v[40:43] offset:2080
    s_waitcnt vmcnt(0)
    ds_write_b128 v25, v[44:47] offset:3120
    s_waitcnt lgkmcnt(0)
    s_barrier
    ds_read_b64_tr_b16 v[48:49], v26 offset:0
    ds_read_b64_tr_b16 v[50:51], v26 offset:32
    ds_read_b64_tr_b16 v[52:53], v26 offset:64
    ds_read_b64_tr_b16 v[54:55], v26 offset:96
    ds_read_b64_tr_b16 v[56:57], v26 offset:128
    ds_read_b64_tr_b16 v[58:59], v26 offset:160
    ds_read_b64_tr_b16 v[60:61], v26 offset:192
    ds_read_b64_tr_b16 v[62:63], v26 offset:224
    s_waitcnt lgkmcnt(7)
    ds_write_b64 v27, v[48:49] offset:32768
    s_waitcnt lgkmcnt(6)
    ds_write_b64 v27, v[50:51] offset:33792
    s_waitcnt lgkmcnt(5)
    ds_write_b64 v27, v[52:53] offset:34816
    s_waitcnt lgkmcnt(4)
    ds_write_b64 v27, v[54:55] offset:35840
    s_waitcnt lgkmcnt(3)
    ds_write_b64 v27, v[56:57] offset:36864
    s_waitcnt lgkmcnt(2)
    ds_write_b64 v27, v[58:59] offset:37888
    s_waitcnt lgkmcnt(1)
    ds_write_b64 v27, v[60:61] offset:38912
    s_waitcnt lgkmcnt(0)
    ds_write_b64 v27, v[62:63] offset:39936
    s_waitcnt lgkmcnt(0)
    s_barrier
    v_add_u32 v29, 49152, v24
    global_load_dwordx4 v[32:35], v29, s[18:19] offset:0
    global_load_dwordx4 v[36:39], v29, s[18:19] offset:1024
    global_load_dwordx4 v[40:43], v29, s[18:19] offset:2048
    global_load_dwordx4 v[44:47], v29, s[18:19] offset:3072
    s_waitcnt vmcnt(3)
    ds_write_b128 v25, v[32:35] offset:0
    s_waitcnt vmcnt(2)
    ds_write_b128 v25, v[36:39] offset:1040
    s_waitcnt vmcnt(1)
    ds_write_b128 v25, v[40:43] offset:2080
    s_waitcnt vmcnt(0)
    ds_write_b128 v25, v[44:47] offset:3120
    s_waitcnt lgkmcnt(0)
    s_barrier
    ds_read_b64_tr_b16 v[48:49], v26 offset:0
    ds_read_b64_tr_b16 v[50:51], v26 offset:32
    ds_read_b64_tr_b16 v[52:53], v26 offset:64
    ds_read_b64_tr_b16 v[54:55], v26 offset:96
    ds_read_b64_tr_b16 v[56:57], v26 offset:128
    ds_read_b64_tr_b16 v[58:59], v26 offset:160
    ds_read_b64_tr_b16 v[60:61], v26 offset:192
    ds_read_b64_tr_b16 v[62:63], v26 offset:224
    s_waitcnt lgkmcnt(7)
    ds_write_b64 v27, v[48:49] offset:32776
    s_waitcnt lgkmcnt(6)
    ds_write_b64 v27, v[50:51] offset:33800
    s_waitcnt lgkmcnt(5)
    ds_write_b64 v27, v[52:53] offset:34824
    s_waitcnt lgkmcnt(4)
    ds_write_b64 v27, v[54:55] offset:35848
    s_waitcnt lgkmcnt(3)
    ds_write_b64 v27, v[56:57] offset:36872
    s_waitcnt lgkmcnt(2)
    ds_write_b64 v27, v[58:59] offset:37896
    s_waitcnt lgkmcnt(1)
    ds_write_b64 v27, v[60:61] offset:38920
    s_waitcnt lgkmcnt(0)
    ds_write_b64 v27, v[62:63] offset:39944
    s_waitcnt lgkmcnt(0)
    s_barrier
    v_add_u32 v29, 65536, v24
    global_load_dwordx4 v[32:35], v29, s[18:19] offset:0
    global_load_dwordx4 v[36:39], v29, s[18:19] offset:1024
    global_load_dwordx4 v[40:43], v29, s[18:19] offset:2048
    global_load_dwordx4 v[44:47], v29, s[18:19] offset:3072
    s_waitcnt vmcnt(3)
    ds_write_b128 v25, v[32:35] offset:0
    s_waitcnt vmcnt(2)
    ds_write_b128 v25, v[36:39] offset:1040
    s_waitcnt vmcnt(1)
    ds_write_b128 v25, v[40:43] offset:2080
    s_waitcnt vmcnt(0)
    ds_write_b128 v25, v[44:47] offset:3120
    s_waitcnt lgkmcnt(0)
    s_barrier
    ds_read_b64_tr_b16 v[48:49], v26 offset:0
    ds_read_b64_tr_b16 v[50:51], v26 offset:32
    ds_read_b64_tr_b16 v[52:53], v26 offset:64
    ds_read_b64_tr_b16 v[54:55], v26 offset:96
    ds_read_b64_tr_b16 v[56:57], v26 offset:128
    ds_read_b64_tr_b16 v[58:59], v26 offset:160
    ds_read_b64_tr_b16 v[60:61], v26 offset:192
    ds_read_b64_tr_b16 v[62:63], v26 offset:224
    s_waitcnt lgkmcnt(7)
    ds_write_b64 v28, v[48:49] offset:0
    s_waitcnt lgkmcnt(6)
    ds_write_b64 v28, v[50:51] offset:1024
    s_waitcnt lgkmcnt(5)
    ds_write_b64 v28, v[52:53] offset:2048
    s_waitcnt lgkmcnt(4)
    ds_write_b64 v28, v[54:55] offset:3072
    s_waitcnt lgkmcnt(3)
    ds_write_b64 v28, v[56:57] offset:4096
    s_waitcnt lgkmcnt(2)
    ds_write_b64 v28, v[58:59] offset:5120
    s_waitcnt lgkmcnt(1)
    ds_write_b64 v28, v[60:61] offset:6144
    s_waitcnt lgkmcnt(0)
    ds_write_b64 v28, v[62:63] offset:7168
    s_waitcnt lgkmcnt(0)
    s_barrier
    v_add_u32 v29, 81920, v24
    global_load_dwordx4 v[32:35], v29, s[18:19] offset:0
    global_load_dwordx4 v[36:39], v29, s[18:19] offset:1024
    global_load_dwordx4 v[40:43], v29, s[18:19] offset:2048
    global_load_dwordx4 v[44:47], v29, s[18:19] offset:3072
    s_waitcnt vmcnt(3)
    ds_write_b128 v25, v[32:35] offset:0
    s_waitcnt vmcnt(2)
    ds_write_b128 v25, v[36:39] offset:1040
    s_waitcnt vmcnt(1)
    ds_write_b128 v25, v[40:43] offset:2080
    s_waitcnt vmcnt(0)
    ds_write_b128 v25, v[44:47] offset:3120
    s_waitcnt lgkmcnt(0)
    s_barrier
    ds_read_b64_tr_b16 v[48:49], v26 offset:0
    ds_read_b64_tr_b16 v[50:51], v26 offset:32
    ds_read_b64_tr_b16 v[52:53], v26 offset:64
    ds_read_b64_tr_b16 v[54:55], v26 offset:96
    ds_read_b64_tr_b16 v[56:57], v26 offset:128
    ds_read_b64_tr_b16 v[58:59], v26 offset:160
    ds_read_b64_tr_b16 v[60:61], v26 offset:192
    ds_read_b64_tr_b16 v[62:63], v26 offset:224
    s_waitcnt lgkmcnt(7)
    ds_write_b64 v28, v[48:49] offset:8
    s_waitcnt lgkmcnt(6)
    ds_write_b64 v28, v[50:51] offset:1032
    s_waitcnt lgkmcnt(5)
    ds_write_b64 v28, v[52:53] offset:2056
    s_waitcnt lgkmcnt(4)
    ds_write_b64 v28, v[54:55] offset:3080
    s_waitcnt lgkmcnt(3)
    ds_write_b64 v28, v[56:57] offset:4104
    s_waitcnt lgkmcnt(2)
    ds_write_b64 v28, v[58:59] offset:5128
    s_waitcnt lgkmcnt(1)
    ds_write_b64 v28, v[60:61] offset:6152
    s_waitcnt lgkmcnt(0)
    ds_write_b64 v28, v[62:63] offset:7176
    s_waitcnt lgkmcnt(0)
    s_barrier
    v_add_u32 v29, 98304, v24
    global_load_dwordx4 v[32:35], v29, s[18:19] offset:0
    global_load_dwordx4 v[36:39], v29, s[18:19] offset:1024
    global_load_dwordx4 v[40:43], v29, s[18:19] offset:2048
    global_load_dwordx4 v[44:47], v29, s[18:19] offset:3072
    s_waitcnt vmcnt(3)
    ds_write_b128 v25, v[32:35] offset:0
    s_waitcnt vmcnt(2)
    ds_write_b128 v25, v[36:39] offset:1040
    s_waitcnt vmcnt(1)
    ds_write_b128 v25, v[40:43] offset:2080
    s_waitcnt vmcnt(0)
    ds_write_b128 v25, v[44:47] offset:3120
    s_waitcnt lgkmcnt(0)
    s_barrier
    ds_read_b64_tr_b16 v[48:49], v26 offset:0
    ds_read_b64_tr_b16 v[50:51], v26 offset:32
    ds_read_b64_tr_b16 v[52:53], v26 offset:64
    ds_read_b64_tr_b16 v[54:55], v26 offset:96
    ds_read_b64_tr_b16 v[56:57], v26 offset:128
    ds_read_b64_tr_b16 v[58:59], v26 offset:160
    ds_read_b64_tr_b16 v[60:61], v26 offset:192
    ds_read_b64_tr_b16 v[62:63], v26 offset:224
    s_waitcnt lgkmcnt(7)
    ds_write_b64 v28, v[48:49] offset:32768
    s_waitcnt lgkmcnt(6)
    ds_write_b64 v28, v[50:51] offset:33792
    s_waitcnt lgkmcnt(5)
    ds_write_b64 v28, v[52:53] offset:34816
    s_waitcnt lgkmcnt(4)
    ds_write_b64 v28, v[54:55] offset:35840
    s_waitcnt lgkmcnt(3)
    ds_write_b64 v28, v[56:57] offset:36864
    s_waitcnt lgkmcnt(2)
    ds_write_b64 v28, v[58:59] offset:37888
    s_waitcnt lgkmcnt(1)
    ds_write_b64 v28, v[60:61] offset:38912
    s_waitcnt lgkmcnt(0)
    ds_write_b64 v28, v[62:63] offset:39936
    s_waitcnt lgkmcnt(0)
    s_barrier
    v_add_u32 v29, 114688, v24
    global_load_dwordx4 v[32:35], v29, s[18:19] offset:0
    global_load_dwordx4 v[36:39], v29, s[18:19] offset:1024
    global_load_dwordx4 v[40:43], v29, s[18:19] offset:2048
    global_load_dwordx4 v[44:47], v29, s[18:19] offset:3072
    s_waitcnt vmcnt(3)
    ds_write_b128 v25, v[32:35] offset:0
    s_waitcnt vmcnt(2)
    ds_write_b128 v25, v[36:39] offset:1040
    s_waitcnt vmcnt(1)
    ds_write_b128 v25, v[40:43] offset:2080
    s_waitcnt vmcnt(0)
    ds_write_b128 v25, v[44:47] offset:3120
    s_waitcnt lgkmcnt(0)
    s_barrier
    ds_read_b64_tr_b16 v[48:49], v26 offset:0
    ds_read_b64_tr_b16 v[50:51], v26 offset:32
    ds_read_b64_tr_b16 v[52:53], v26 offset:64
    ds_read_b64_tr_b16 v[54:55], v26 offset:96
    ds_read_b64_tr_b16 v[56:57], v26 offset:128
    ds_read_b64_tr_b16 v[58:59], v26 offset:160
    ds_read_b64_tr_b16 v[60:61], v26 offset:192
    ds_read_b64_tr_b16 v[62:63], v26 offset:224
    s_waitcnt lgkmcnt(7)
    ds_write_b64 v28, v[48:49] offset:32776
    s_waitcnt lgkmcnt(6)
    ds_write_b64 v28, v[50:51] offset:33800
    s_waitcnt lgkmcnt(5)
    ds_write_b64 v28, v[52:53] offset:34824
    s_waitcnt lgkmcnt(4)
    ds_write_b64 v28, v[54:55] offset:35848
    s_waitcnt lgkmcnt(3)
    ds_write_b64 v28, v[56:57] offset:36872
    s_waitcnt lgkmcnt(2)
    ds_write_b64 v28, v[58:59] offset:37896
    s_waitcnt lgkmcnt(1)
    ds_write_b64 v28, v[60:61] offset:38920
    s_waitcnt lgkmcnt(0)
    ds_write_b64 v28, v[62:63] offset:39944
    s_waitcnt lgkmcnt(0)
    s_barrier
    v_add_u32 v124, 0, v2
    v_xor_b32 v124, v124, v1
    v_lshlrev_b32 v124, 4, v124
    v_lshl_add_u32 v124, v1, 10, v124
    v_add_u32 v3, 131072, v124
    v_add_u32 v124, 4, v2
    v_xor_b32 v124, v124, v1
    v_lshlrev_b32 v124, 4, v124
    v_lshl_add_u32 v124, v1, 10, v124
    v_add_u32 v4, 131072, v124
    v_add_u32 v124, 8, v2
    v_xor_b32 v124, v124, v1
    v_lshlrev_b32 v124, 4, v124
    v_lshl_add_u32 v124, v1, 10, v124
    v_add_u32 v5, 131072, v124
    v_add_u32 v124, 12, v2
    v_xor_b32 v124, v124, v1
    v_lshlrev_b32 v124, 4, v124
    v_lshl_add_u32 v124, v1, 10, v124
    v_add_u32 v6, 131072, v124
    v_lshrrev_b32 v24, 2, v0
    v_and_b32 v25, 3, v0
    v_lshrrev_b32 v26, 1, v25
    v_xor_b32 v26, v26, v24
    v_lshlrev_b32 v26, 4, v26
    v_and_b32 v27, 1, v25
    v_lshlrev_b32 v27, 3, v27
    v_lshl_add_u32 v27, v24, 10, v27
    s_lshl_b32 s23, s20, 8
    v_add_u32 v27, s23, v27
    v_add_u32 v27, 131072, v27
    v_or_b32 v8, v27, v26
    v_add_u32 v21, 147456, v7
    s_mul_i32 s23, s20, 3072
    v_add_u32 v9, s23, v21
    s_lshl_b32 s23, s20, 10
    v_add_u32 v20, s23, v21
    v_add_u32 v20, 12288, v20
    v_mov_b32 v10, 0xfffffffe
    s_lshl_b32 s23, s20, 17
    s_lshl_b32 s24, s21, 9
    s_add_u32 s23, s23, s24
    s_add_u32 s23, s23, 262144
    v_lshlrev_b32 v24, 5, v1
    v_lshl_add_u32 v24, v2, 3, v24
    v_add_u32 v11, s23, v24
    v_lshrrev_b32 v24, 2, v1
    v_and_b32 v25, 3, v1
    s_lshl_b32 s23, s20, 2
    v_add_u32 v26, s23, v25
    v_lshlrev_b32 v26, 5, v26
    v_lshl_add_u32 v26, v24, 3, v26
    v_lshl_add_u32 v26, v2, 9, v26
    s_lshl_b32 s24, s21, 14
    s_add_u32 s24, s24, 262144
    v_add_u32 v12, s24, v26
    v_add_u32 v26, s23, v25
    v_lshl_add_u32 v27, v26, 2, v24
    v_lshlrev_b32 v27, 4, v27
    s_lshl_b32 s24, s21, 10
    s_add_u32 s24, s24, 196608
    v_add_u32 v13, s24, v27
    v_and_b32 v27, 7, v26
    v_lshlrev_b32 v27, 10, v27
    v_lshl_add_u32 v27, v24, 3, v27
    s_lshl_b32 s24, s21, 5
    v_add_u32 v27, s24, v27
    global_load_dwordx2 v[28:29], v27, s[48:49]
    v_cmp_le_u32 s[50:51], 8, v26
    s_lshl_b32 s23, s20, 13
    s_add_u32 s23, s23, 196608
    v_add_u32 v14, s23, v7
    v_add_u32 v15, 4096, v14
    s_lshl_b32 s23, s20, 13
    v_add_u32 v22, s23, v7
    v_add_u32 v23, 65536, v22
    s_waitcnt vmcnt(0)
    v_mov_b32 v16, v28
    v_mov_b32 v17, v29
    v_mov_b32 v18, 0
    v_mov_b32 v19, 0
    v_cmp_le_u32 s[44:45], 8, v1
    v_lshrrev_b32 v24, 1, v2
    v_lshrrev_b32 v25, 3, v1
    v_cmp_eq_u32 s[46:47], v24, v25
    v_mov_b32 v80, 0
    v_mov_b32 v81, 0
    v_mov_b32 v82, 0
    v_mov_b32 v83, 0
    v_mov_b32 v84, 0
    v_mov_b32 v85, 0
    v_mov_b32 v86, 0
    v_mov_b32 v87, 0
    v_mov_b32 v88, 0
    v_mov_b32 v89, 0
    v_mov_b32 v90, 0
    v_mov_b32 v91, 0
    v_mov_b32 v92, 0
    v_mov_b32 v93, 0
    v_mov_b32 v94, 0
    v_mov_b32 v95, 0
    v_mov_b32 v96, 0
    v_mov_b32 v97, 0
    v_mov_b32 v98, 0
    v_mov_b32 v99, 0
    v_mov_b32 v100, 0
    v_mov_b32 v101, 0
    v_mov_b32 v102, 0
    v_mov_b32 v103, 0
    v_mov_b32 v104, 0
    v_mov_b32 v105, 0
    v_mov_b32 v106, 0
    v_mov_b32 v107, 0
    v_mov_b32 v108, 0
    v_mov_b32 v109, 0
    v_mov_b32 v110, 0
    v_mov_b32 v111, 0
    v_lshrrev_b32 v24, 2, v0
    v_and_b32 v24, 7, v24
    v_lshlrev_b32 v24, 10, v24
    v_and_b32 v25, 3, v0
    v_lshl_add_u32 v24, v25, 3, v24
    s_lshl_b32 s23, s20, 8
    v_add_u32 v24, s23, v24
    global_load_dwordx2 v[48:49], v24, s[48:49] offset:0
    global_load_dwordx2 v[50:51], v24, s[48:49] offset:32
    global_load_dwordx2 v[52:53], v24, s[48:49] offset:64
    global_load_dwordx2 v[54:55], v24, s[48:49] offset:96
    global_load_dwordx2 v[56:57], v24, s[48:49] offset:128
    global_load_dwordx2 v[58:59], v24, s[48:49] offset:160
    global_load_dwordx2 v[60:61], v24, s[48:49] offset:192
    global_load_dwordx2 v[62:63], v24, s[48:49] offset:224
    s_waitcnt vmcnt(7)
    v_xor_b32 v25, 0, v8
    ds_write_b64 v25, v[48:49]
    s_waitcnt vmcnt(6)
    v_xor_b32 v25, 32, v8
    ds_write_b64 v25, v[50:51]
    s_waitcnt vmcnt(5)
    v_xor_b32 v25, 64, v8
    ds_write_b64 v25, v[52:53]
    s_waitcnt vmcnt(4)
    v_xor_b32 v25, 96, v8
    ds_write_b64 v25, v[54:55]
    s_waitcnt vmcnt(3)
    v_xor_b32 v25, 128, v8
    ds_write_b64 v25, v[56:57]
    s_waitcnt vmcnt(2)
    v_xor_b32 v25, 160, v8
    ds_write_b64 v25, v[58:59]
    s_waitcnt vmcnt(1)
    v_xor_b32 v25, 192, v8
    ds_write_b64 v25, v[60:61]
    s_waitcnt vmcnt(0)
    v_xor_b32 v25, 224, v8
    ds_write_b64 v25, v[62:63]
    s_mov_b32 s30, 0
    s_lshl_b32 s52, s21, 2
    s_add_u32 s52, s52, s20
    s_mul_i32 s53, s21, 24576
    s_lshl_b32 s23, s20, 10
    s_add_u32 s53, s53, s23
    s_add_u32 s53, s53, 50331648
    s_lshl_b32 s23, s20, 10
    s_add_u32 s54, s23, 229376
    s_add_u32 s23, s20, 1
    s_and_b32 s23, s23, 3
    s_mul_i32 s23, s23, 3072
    v_add_u32 v0, s23, v21
    s_add_u32 s23, s20, 2
    s_and_b32 s23, s23, 3
    s_mul_i32 s23, s23, 3072
    v_add_u32 v1, s23, v21
    s_add_u32 s23, s20, 3
    s_and_b32 s23, s23, 3
    s_mul_i32 s23, s23, 3072
    v_add_u32 v2, s23, v21
    v_mov_b32 v124, 32
    s_mov_b32 s90, 0
    s_nop 0
Lpoll_1:
    global_load_dword v125, v124, s[10:11] sc1
    s_waitcnt vmcnt(0)
    s_movk_i32 s23, 0x100
    v_cmp_gt_u32 s[40:41], s23, v125
    s_cmp_eq_u64 s[40:41], 0
    s_cbranch_scc1 Lpd_2
    s_add_u32 s90, s90, 1
    s_cmp_lt_u32 s90, 400000
    s_nop 0
    s_cbranch_scc1 Lpoll_1
    v_mov_b32 v126, 108
    v_mov_b32 v127, 267
    global_store_dword v126, v127, s[10:11]
    s_waitcnt vmcnt(0)
    s_endpgm
Lpd_2:
    s_mov_b32 s35, 0
    s_sub_u32 s36, s35, 11
    s_min_u32 s23, s35, 63
    s_add_u32 s23, s23, 0
    s_lshl_b32 s23, s23, 7
    s_add_u32 s23, s23, s52
    s_lshl_b32 s23, s23, 2
    v_mov_b32 v124, s23
    s_mov_b32 s90, 0
    s_nop 0
Lpoll_3:
    global_load_dword v125, v124, s[4:5] offset:0 sc1
    s_waitcnt vmcnt(0)
    v_cmp_ne_u32 s[40:41], 1, v125
    s_cmp_eq_u64 s[40:41], 0
    s_cbranch_scc1 Lpd_4
    s_add_u32 s90, s90, 1
    s_cmp_lt_u32 s90, 400000
    s_nop 0
    s_cbranch_scc1 Lpoll_3
    v_mov_b32 v126, 68
    v_mov_b32 v127, 257
    global_store_dword v126, v127, s[10:11]
    s_waitcnt vmcnt(0)
    s_endpgm
Lpd_4:
    s_add_u32 s23, s35, 0
    s_mul_i32 s23, s23, 786432
    s_add_u32 s23, s23, s53
    s_cmp_lt_u32 s35, 64
    s_cselect_b32 s24, s23, s54
    s_add_u32 s24, s24, 8192
    v_add_u32 v124, s24, v7
    v_add_u32 v125, 4096, v124
    global_load_dwordx4 v[80:83], v124, s[4:5] sc1
    global_load_dwordx4 v[84:87], v125, s[4:5] sc1
    s_add_u32 s23, s36, 64
    s_mul_i32 s23, s23, 786432
    s_add_u32 s23, s23, s53
    s_cmp_lt_u32 s36, 64
    s_cselect_b32 s24, s23, s54
    s_add_u32 s24, s24, 8192
    v_add_u32 v124, s24, v7
    v_add_u32 v125, 4096, v124
    global_load_dwordx4 v[88:91], v124, s[4:5] sc1
    global_load_dwordx4 v[92:95], v125, s[4:5] sc1
    s_mov_b32 s35, 1
    s_sub_u32 s36, s35, 11
    s_min_u32 s23, s35, 63
    s_add_u32 s23, s23, 0
    s_lshl_b32 s23, s23, 7
    s_add_u32 s23, s23, s52
    s_lshl_b32 s23, s23, 2
    v_mov_b32 v124, s23
    global_load_dword v18, v124, s[4:5] offset:0 sc1
    s_min_u32 s23, s36, 63
    s_add_u32 s23, s23, 64
    s_lshl_b32 s23, s23, 7
    s_add_u32 s23, s23, s52
    s_lshl_b32 s23, s23, 2
    v_mov_b32 v124, s23
    global_load_dword v19, v124, s[4:5] offset:0 sc1
    s_waitcnt vmcnt(0)
    s_mov_b32 s39, 95
Lchain_step:
    s_waitcnt lgkmcnt(0)
    s_cmp_eq_u32 s20, 1
    s_cbranch_scc1 Lp1_1
    s_cmp_eq_u32 s20, 2
    s_cbranch_scc1 Lp1_2
    s_cmp_eq_u32 s20, 3
    s_cbranch_scc1 Lp1_3
Lp1_0:
    ds_read_b128 v[48:51], v3 offset:0
    ds_read_b128 v[52:55], v4 offset:0
    ds_read_b128 v[56:59], v5 offset:0
    ds_read_b128 v[60:63], v6 offset:0
    s_waitcnt lgkmcnt(3)
    v_mfma_f32_16x16x32_bf16 v[24:27], a[0:3], v[48:51], 0
    s_sub_u32 s36, s30, 11
    v_mfma_f32_16x16x32_bf16 v[28:31], a[64:67], v[48:51], 0
    s_add_u32 s23, s30, 0
    v_mfma_f32_16x16x32_bf16 v[32:35], a[128:131], v[48:51], 0
    s_mul_i32 s23, s23, 786432
    v_mfma_f32_16x16x32_bf16 v[36:39], a[192:195], v[48:51], 0
    s_add_u32 s23, s23, s53
    s_waitcnt lgkmcnt(2)
    v_mfma_f32_16x16x32_bf16 v[24:27], a[4:7], v[52:55], v[24:27]
    s_cmp_lt_u32 s30, 64
    v_mfma_f32_16x16x32_bf16 v[28:31], a[68:71], v[52:55], v[28:31]
    s_cselect_b32 s24, s23, s54
    v_mfma_f32_16x16x32_bf16 v[32:35], a[132:135], v[52:55], v[32:35]
    s_lshl_b32 s25, s20, 10
    v_mfma_f32_16x16x32_bf16 v[36:39], a[196:199], v[52:55], v[36:39]
    s_add_u32 s24, s24, s25
    s_barrier
    ds_read_b128 v[64:67], v3 offset:256
    ds_read_b128 v[68:71], v4 offset:256
    ds_read_b128 v[72:75], v5 offset:256
    ds_read_b128 v[76:79], v6 offset:256
    ds_read_b128 v[48:51], v3 offset:512
    ds_read_b128 v[52:55], v4 offset:512
    s_waitcnt lgkmcnt(7)
    v_mfma_f32_16x16x32_bf16 v[24:27], a[8:11], v[56:59], v[24:27]
    s_add_u32 s24, s24, 16384
    v_mfma_f32_16x16x32_bf16 v[28:31], a[72:75], v[56:59], v[28:31]
    v_add_u32 v124, s24, v7
    v_mfma_f32_16x16x32_bf16 v[32:35], a[136:139], v[56:59], v[32:35]
    global_load_dwordx4 v[96:99], v124, s[4:5] sc1
    v_mfma_f32_16x16x32_bf16 v[36:39], a[200:203], v[56:59], v[36:39]
    global_load_dwordx4 v[100:103], v124, s[4:5] offset:1024 sc1
    ds_read_b128 v[56:59], v5 offset:512
    s_waitcnt lgkmcnt(7)
    v_mfma_f32_16x16x32_bf16 v[24:27], a[12:15], v[60:63], v[24:27]
    s_add_u32 s23, s36, 64
    v_mfma_f32_16x16x32_bf16 v[28:31], a[76:79], v[60:63], v[28:31]
    s_mul_i32 s23, s23, 786432
    v_mfma_f32_16x16x32_bf16 v[32:35], a[140:143], v[60:63], v[32:35]
    s_add_u32 s23, s23, s53
    v_mfma_f32_16x16x32_bf16 v[36:39], a[204:207], v[60:63], v[36:39]
    s_cmp_lt_u32 s36, 64
    ds_read_b128 v[60:63], v6 offset:512
    s_waitcnt lgkmcnt(7)
    v_mfma_f32_16x16x32_bf16 v[24:27], a[16:19], v[64:67], v[24:27]
    s_cselect_b32 s24, s23, s54
    v_mfma_f32_16x16x32_bf16 v[28:31], a[80:83], v[64:67], v[28:31]
    s_lshl_b32 s25, s20, 10
    v_mfma_f32_16x16x32_bf16 v[32:35], a[144:147], v[64:67], v[32:35]
    s_add_u32 s24, s24, s25
    v_mfma_f32_16x16x32_bf16 v[36:39], a[208:211], v[64:67], v[36:39]
    s_add_u32 s24, s24, 16384
    ds_read_b128 v[64:67], v3 offset:768
    s_waitcnt lgkmcnt(7)
    v_mfma_f32_16x16x32_bf16 v[24:27], a[20:23], v[68:71], v[24:27]
    v_add_u32 v124, s24, v7
    v_mfma_f32_16x16x32_bf16 v[28:31], a[84:87], v[68:71], v[28:31]
    global_load_dwordx4 v[104:107], v124, s[4:5] sc1
    v_mfma_f32_16x16x32_bf16 v[32:35], a[148:151], v[68:71], v[32:35]
    global_load_dwordx4 v[108:111], v124, s[4:5] offset:1024 sc1
    v_mfma_f32_16x16x32_bf16 v[36:39], a[212:215], v[68:71], v[36:39]
    ds_read_b128 v[68:71], v4 offset:768
    s_waitcnt lgkmcnt(7)
    v_mfma_f32_16x16x32_bf16 v[24:27], a[24:27], v[72:75], v[24:27]
    s_lshl_b32 s23, s39, 7
    v_mfma_f32_16x16x32_bf16 v[28:31], a[88:91], v[72:75], v[28:31]
    s_add_u32 s23, s23, s52
    v_mfma_f32_16x16x32_bf16 v[32:35], a[152:155], v[72:75], v[32:35]
    s_lshl_b32 s23, s23, 2
    v_mfma_f32_16x16x32_bf16 v[36:39], a[216:219], v[72:75], v[36:39]
    v_mov_b32 v124, s23
    ds_read_b128 v[72:75], v5 offset:768
    s_waitcnt lgkmcnt(7)
    v_mfma_f32_16x16x32_bf16 v[24:27], a[28:31], v[76:79], v[24:27]
    v_mov_b32 v125, 1
    v_mfma_f32_16x16x32_bf16 v[28:31], a[92:95], v[76:79], v[28:31]
    v_add_u32 v124, 65536, v124
    v_mfma_f32_16x16x32_bf16 v[32:35], a[156:159], v[76:79], v[32:35]
    global_store_dword v124, v125, s[4:5] sc1
    v_mfma_f32_16x16x32_bf16 v[36:39], a[220:223], v[76:79], v[36:39]
    s_lshl_b32 s23, s30, 5
    ds_read_b128 v[76:79], v6 offset:768
    s_waitcnt lgkmcnt(7)
    v_mfma_f32_16x16x32_bf16 v[24:27], a[32:35], v[48:51], v[24:27]
    s_add_u32 s23, s23, s21
    v_mfma_f32_16x16x32_bf16 v[28:31], a[96:99], v[48:51], v[28:31]
    s_lshl_b32 s23, s23, 13
    v_mfma_f32_16x16x32_bf16 v[32:35], a[160:163], v[48:51], v[32:35]
    s_lshl_b32 s24, s20, 10
    v_mfma_f32_16x16x32_bf16 v[36:39], a[224:227], v[48:51], v[36:39]
    s_add_u32 s23, s23, s24
    s_waitcnt lgkmcnt(6)
    v_mfma_f32_16x16x32_bf16 v[24:27], a[36:39], v[52:55], v[24:27]
    s_add_u32 s33, s23, 2097152
    v_mfma_f32_16x16x32_bf16 v[28:31], a[100:103], v[52:55], v[28:31]
    s_add_u32 s31, s30, 1
    v_mfma_f32_16x16x32_bf16 v[32:35], a[164:167], v[52:55], v[32:35]
    s_and_b32 s31, s31, 1
    v_mfma_f32_16x16x32_bf16 v[36:39], a[228:231], v[52:55], v[36:39]
    s_waitcnt lgkmcnt(5)
    v_mfma_f32_16x16x32_bf16 v[24:27], a[40:43], v[56:59], v[24:27]
    v_mfma_f32_16x16x32_bf16 v[28:31], a[104:107], v[56:59], v[28:31]
    v_mfma_f32_16x16x32_bf16 v[32:35], a[168:171], v[56:59], v[32:35]
    v_mfma_f32_16x16x32_bf16 v[36:39], a[232:235], v[56:59], v[36:39]
    s_waitcnt lgkmcnt(4)
    v_mfma_f32_16x16x32_bf16 v[24:27], a[44:47], v[60:63], v[24:27]
    v_mfma_f32_16x16x32_bf16 v[28:31], a[108:111], v[60:63], v[28:31]
    v_mfma_f32_16x16x32_bf16 v[32:35], a[172:175], v[60:63], v[32:35]
    v_mfma_f32_16x16x32_bf16 v[36:39], a[236:239], v[60:63], v[36:39]
    s_waitcnt lgkmcnt(3)
    v_mfma_f32_16x16x32_bf16 v[24:27], a[48:51], v[64:67], v[24:27]
    v_mfma_f32_16x16x32_bf16 v[28:31], a[112:115], v[64:67], v[28:31]
    v_mfma_f32_16x16x32_bf16 v[32:35], a[176:179], v[64:67], v[32:35]
    v_mfma_f32_16x16x32_bf16 v[36:39], a[240:243], v[64:67], v[36:39]
    s_waitcnt lgkmcnt(2)
    v_mfma_f32_16x16x32_bf16 v[24:27], a[52:55], v[68:71], v[24:27]
    v_mfma_f32_16x16x32_bf16 v[28:31], a[116:119], v[68:71], v[28:31]
    v_mfma_f32_16x16x32_bf16 v[32:35], a[180:183], v[68:71], v[32:35]
    v_mfma_f32_16x16x32_bf16 v[36:39], a[244:247], v[68:71], v[36:39]
    s_waitcnt lgkmcnt(1)
    v_mfma_f32_16x16x32_bf16 v[24:27], a[56:59], v[72:75], v[24:27]
    v_mfma_f32_16x16x32_bf16 v[28:31], a[120:123], v[72:75], v[28:31]
    v_mfma_f32_16x16x32_bf16 v[32:35], a[184:187], v[72:75], v[32:35]
    v_mfma_f32_16x16x32_bf16 v[36:39], a[248:251], v[72:75], v[36:39]
    s_waitcnt lgkmcnt(0)
    v_mfma_f32_16x16x32_bf16 v[24:27], a[60:63], v[76:79], v[24:27]
    v_mfma_f32_16x16x32_bf16 v[28:31], a[124:127], v[76:79], v[28:31]
    v_mfma_f32_16x16x32_bf16 v[32:35], a[188:191], v[76:79], v[32:35]
    v_mfma_f32_16x16x32_bf16 v[36:39], a[252:255], v[76:79], v[36:39]
    s_branch Lp1_done
    s_nop 6
Lp1_1:
    ds_read_b128 v[48:51], v3 offset:256
    ds_read_b128 v[52:55], v4 offset:256
    ds_read_b128 v[56:59], v5 offset:256
    ds_read_b128 v[60:63], v6 offset:256
    s_waitcnt lgkmcnt(3)
    v_mfma_f32_16x16x32_bf16 v[24:27], a[16:19], v[48:51], 0
    s_sub_u32 s36, s30, 11
    v_mfma_f32_16x16x32_bf16 v[28:31], a[80:83], v[48:51], 0
    s_add_u32 s23, s30, 0
    v_mfma_f32_16x16x32_bf16 v[32:35], a[144:147], v[48:51], 0
    s_mul_i32 s23, s23, 786432
    v_mfma_f32_16x16x32_bf16 v[36:39], a[208:211], v[48:51], 0
    s_add_u32 s23, s23, s53
    s_waitcnt lgkmcnt(2)
    v_mfma_f32_16x16x32_bf16 v[24:27], a[20:23], v[52:55], v[24:27]
    s_cmp_lt_u32 s30, 64
    v_mfma_f32_16x16x32_bf16 v[28:31], a[84:87], v[52:55], v[28:31]
    s_cselect_b32 s24, s23, s54
    v_mfma_f32_16x16x32_bf16 v[32:35], a[148:151], v[52:55], v[32:35]
    s_lshl_b32 s25, s20, 10
    v_mfma_f32_16x16x32_bf16 v[36:39], a[212:215], v[52:55], v[36:39]
    s_add_u32 s24, s24, s25
    s_barrier
    ds_read_b128 v[64:67], v3 offset:0
    ds_read_b128 v[68:71], v4 offset:0
    ds_read_b128 v[72:75], v5 offset:0
    ds_read_b128 v[76:79], v6 offset:0
    ds_read_b128 v[48:51], v3 offset:512
    ds_read_b128 v[52:55], v4 offset:512
    s_waitcnt lgkmcnt(7)
    v_mfma_f32_16x16x32_bf16 v[24:27], a[24:27], v[56:59], v[24:27]
    s_add_u32 s24, s24, 16384
    v_mfma_f32_16x16x32_bf16 v[28:31], a[88:91], v[56:59], v[28:31]
    v_add_u32 v124, s24, v7
    v_mfma_f32_16x16x32_bf16 v[32:35], a[152:155], v[56:59], v[32:35]
    global_load_dwordx4 v[96:99], v124, s[4:5] sc1
    v_mfma_f32_16x16x32_bf16 v[36:39], a[216:219], v[56:59], v[36:39]
    global_load_dwordx4 v[100:103], v124, s[4:5] offset:1024 sc1
    ds_read_b128 v[56:59], v5 offset:512
    s_waitcnt lgkmcnt(7)
    v_mfma_f32_16x16x32_bf16 v[24:27], a[28:31], v[60:63], v[24:27]
    s_add_u32 s23, s36, 64
    v_mfma_f32_16x16x32_bf16 v[28:31], a[92:95], v[60:63], v[28:31]
    s_mul_i32 s23, s23, 786432
    v_mfma_f32_16x16x32_bf16 v[32:35], a[156:159], v[60:63], v[32:35]
    s_add_u32 s23, s23, s53
    v_mfma_f32_16x16x32_bf16 v[36:39], a[220:223], v[60:63], v[36:39]
    s_cmp_lt_u32 s36, 64
    ds_read_b128 v[60:63], v6 offset:512
    s_waitcnt lgkmcnt(7)
    v_mfma_f32_16x16x32_bf16 v[24:27], a[0:3], v[64:67], v[24:27]
    s_cselect_b32 s24, s23, s54
    v_mfma_f32_16x16x32_bf16 v[28:31], a[64:67], v[64:67], v[28:31]
    s_lshl_b32 s25, s20, 10
    v_mfma_f32_16x16x32_bf16 v[32:35], a[128:131], v[64:67], v[32:35]
    s_add_u32 s24, s24, s25
    v_mfma_f32_16x16x32_bf16 v[36:39], a[192:195], v[64:67], v[36:39]
    s_add_u32 s24, s24, 16384
    ds_read_b128 v[64:67], v3 offset:768
    s_waitcnt lgkmcnt(7)
    v_mfma_f32_16x16x32_bf16 v[24:27], a[4:7], v[68:71], v[24:27]
    v_add_u32 v124, s24, v7
    v_mfma_f32_16x16x32_bf16 v[28:31], a[68:71], v[68:71], v[28:31]
    global_load_dwordx4 v[104:107], v124, s[4:5] sc1
    v_mfma_f32_16x16x32_bf16 v[32:35], a[132:135], v[68:71], v[32:35]
    global_load_dwordx4 v[108:111], v124, s[4:5] offset:1024 sc1
    v_mfma_f32_16x16x32_bf16 v[36:39], a[196:199], v[68:71], v[36:39]
    ds_read_b128 v[68:71], v4 offset:768
    s_waitcnt lgkmcnt(7)
    v_mfma_f32_16x16x32_bf16 v[24:27], a[8:11], v[72:75], v[24:27]
    s_lshl_b32 s23, s39, 7
    v_mfma_f32_16x16x32_bf16 v[28:31], a[72:75], v[72:75], v[28:31]
    s_add_u32 s23, s23, s52
    v_mfma_f32_16x16x32_bf16 v[32:35], a[136:139], v[72:75], v[32:35]
    s_lshl_b32 s23, s23, 2
    v_mfma_f32_16x16x32_bf16 v[36:39], a[200:203], v[72:75], v[36:39]
    v_mov_b32 v124, s23
    ds_read_b128 v[72:75], v5 offset:768
    s_waitcnt lgkmcnt(7)
    v_mfma_f32_16x16x32_bf16 v[24:27], a[12:15], v[76:79], v[24:27]
    v_mov_b32 v125, 1
    v_mfma_f32_16x16x32_bf16 v[28:31], a[76:79], v[76:79], v[28:31]
    v_add_u32 v124, 65536, v124
    v_mfma_f32_16x16x32_bf16 v[32:35], a[140:143], v[76:79], v[32:35]
    global_store_dword v124, v125, s[4:5] sc1
    v_mfma_f32_16x16x32_bf16 v[36:39], a[204:207], v[76:79], v[36:39]
    s_lshl_b32 s23, s30, 5
    ds_read_b128 v[76:79], v6 offset:768
    s_waitcnt lgkmcnt(7)
    v_mfma_f32_16x16x32_bf16 v[24:27], a[32:35], v[48:51], v[24:27]
    s_add_u32 s23, s23, s21
    v_mfma_f32_16x16x32_bf16 v[28:31], a[96:99], v[48:51], v[28:31]
    s_lshl_b32 s23, s23, 13
    v_mfma_f32_16x16x32_bf16 v[32:35], a[160:163], v[48:51], v[32:35]
    s_lshl_b32 s24, s20, 10
    v_mfma_f32_16x16x32_bf16 v[36:39], a[224:227], v[48:51], v[36:39]
    s_add_u32 s23, s23, s24
    s_waitcnt lgkmcnt(6)
    v_mfma_f32_16x16x32_bf16 v[24:27], a[36:39], v[52:55], v[24:27]
    s_add_u32 s33, s23, 2097152
    v_mfma_f32_16x16x32_bf16 v[28:31], a[100:103], v[52:55], v[28:31]
    s_add_u32 s31, s30, 1
    v_mfma_f32_16x16x32_bf16 v[32:35], a[164:167], v[52:55], v[32:35]
    s_and_b32 s31, s31, 1
    v_mfma_f32_16x16x32_bf16 v[36:39], a[228:231], v[52:55], v[36:39]
    s_waitcnt lgkmcnt(5)
    v_mfma_f32_16x16x32_bf16 v[24:27], a[40:43], v[56:59], v[24:27]
    v_mfma_f32_16x16x32_bf16 v[28:31], a[104:107], v[56:59], v[28:31]
    v_mfma_f32_16x16x32_bf16 v[32:35], a[168:171], v[56:59], v[32:35]
    v_mfma_f32_16x16x32_bf16 v[36:39], a[232:235], v[56:59], v[36:39]
    s_waitcnt lgkmcnt(4)
    v_mfma_f32_16x16x32_bf16 v[24:27], a[44:47], v[60:63], v[24:27]
    v_mfma_f32_16x16x32_bf16 v[28:31], a[108:111], v[60:63], v[28:31]
    v_mfma_f32_16x16x32_bf16 v[32:35], a[172:175], v[60:63], v[32:35]
    v_mfma_f32_16x16x32_bf16 v[36:39], a[236:239], v[60:63], v[36:39]
    s_waitcnt lgkmcnt(3)
    v_mfma_f32_16x16x32_bf16 v[24:27], a[48:51], v[64:67], v[24:27]
    v_mfma_f32_16x16x32_bf16 v[28:31], a[112:115], v[64:67], v[28:31]
    v_mfma_f32_16x16x32_bf16 v[32:35], a[176:179], v[64:67], v[32:35]
    v_mfma_f32_16x16x32_bf16 v[36:39], a[240:243], v[64:67], v[36:39]
    s_waitcnt lgkmcnt(2)
    v_mfma_f32_16x16x32_bf16 v[24:27], a[52:55], v[68:71], v[24:27]
    v_mfma_f32_16x16x32_bf16 v[28:31], a[116:119], v[68:71], v[28:31]
    v_mfma_f32_16x16x32_bf16 v[32:35], a[180:183], v[68:71], v[32:35]
    v_mfma_f32_16x16x32_bf16 v[36:39], a[244:247], v[68:71], v[36:39]
    s_waitcnt lgkmcnt(1)
    v_mfma_f32_16x16x32_bf16 v[24:27], a[56:59], v[72:75], v[24:27]
    v_mfma_f32_16x16x32_bf16 v[28:31], a[120:123], v[72:75], v[28:31]
    v_mfma_f32_16x16x32_bf16 v[32:35], a[184:187], v[72:75], v[32:35]
    v_mfma_f32_16x16x32_bf16 v[36:39], a[248:251], v[72:75], v[36:39]
    s_waitcnt lgkmcnt(0)
    v_mfma_f32_16x16x32_bf16 v[24:27], a[60:63], v[76:79], v[24:27]
    v_mfma_f32_16x16x32_bf16 v[28:31], a[124:127], v[76:79], v[28:31]
    v_mfma_f32_16x16x32_bf16 v[32:35], a[188:191], v[76:79], v[32:35]
    v_mfma_f32_16x16x32_bf16 v[36:39], a[252:255], v[76:79], v[36:39]
    s_branch Lp1_done
    s_nop 6
Lp1_2:
    ds_read_b128 v[48:51], v3 offset:512
    ds_read_b128 v[52:55], v4 offset:512
    ds_read_b128 v[56:59], v5 offset:512
    ds_read_b128 v[60:63], v6 offset:512
    s_waitcnt lgkmcnt(3)
    v_mfma_f32_16x16x32_bf16 v[24:27], a[32:35], v[48:51], 0
    s_sub_u32 s36, s30, 11
    v_mfma_f32_16x16x32_bf16 v[28:31], a[96:99], v[48:51], 0
    s_add_u32 s23, s30, 0
    v_mfma_f32_16x16x32_bf16 v[32:35], a[160:163], v[48:51], 0
    s_mul_i32 s23, s23, 786432
    v_mfma_f32_16x16x32_bf16 v[36:39], a[224:227], v[48:51], 0
    s_add_u32 s23, s23, s53
    s_waitcnt lgkmcnt(2)
    v_mfma_f32_16x16x32_bf16 v[24:27], a[36:39], v[52:55], v[24:27]
    s_cmp_lt_u32 s30, 64
    v_mfma_f32_16x16x32_bf16 v[28:31], a[100:103], v[52:55], v[28:31]
    s_cselect_b32 s24, s23, s54
    v_mfma_f32_16x16x32_bf16 v[32:35], a[164:167], v[52:55], v[32:35]
    s_lshl_b32 s25, s20, 10
    v_mfma_f32_16x16x32_bf16 v[36:39], a[228:231], v[52:55], v[36:39]
    s_add_u32 s24, s24, s25
    s_barrier
    ds_read_b128 v[64:67], v3 offset:0
    ds_read_b128 v[68:71], v4 offset:0
    ds_read_b128 v[72:75], v5 offset:0
    ds_read_b128 v[76:79], v6 offset:0
    ds_read_b128 v[48:51], v3 offset:256
    ds_read_b128 v[52:55], v4 offset:256
    s_waitcnt lgkmcnt(7)
    v_mfma_f32_16x16x32_bf16 v[24:27], a[40:43], v[56:59], v[24:27]
    s_add_u32 s24, s24, 16384
    v_mfma_f32_16x16x32_bf16 v[28:31], a[104:107], v[56:59], v[28:31]
    v_add_u32 v124, s24, v7
    v_mfma_f32_16x16x32_bf16 v[32:35], a[168:171], v[56:59], v[32:35]
    global_load_dwordx4 v[96:99], v124, s[4:5] sc1
    v_mfma_f32_16x16x32_bf16 v[36:39], a[232:235], v[56:59], v[36:39]
    global_load_dwordx4 v[100:103], v124, s[4:5] offset:1024 sc1
    ds_read_b128 v[56:59], v5 offset:256
    s_waitcnt lgkmcnt(7)
    v_mfma_f32_16x16x32_bf16 v[24:27], a[44:47], v[60:63], v[24:27]
    s_add_u32 s23, s36, 64
    v_mfma_f32_16x16x32_bf16 v[28:31], a[108:111], v[60:63], v[28:31]
    s_mul_i32 s23, s23, 786432
    v_mfma_f32_16x16x32_bf16 v[32:35], a[172:175], v[60:63], v[32:35]
    s_add_u32 s23, s23, s53
    v_mfma_f32_16x16x32_bf16 v[36:39], a[236:239], v[60:63], v[36:39]
    s_cmp_lt_u32 s36, 64
    ds_read_b128 v[60:63], v6 offset:256
    s_waitcnt lgkmcnt(7)
    v_mfma_f32_16x16x32_bf16 v[24:27], a[0:3], v[64:67], v[24:27]
    s_cselect_b32 s24, s23, s54
    v_mfma_f32_16x16x32_bf16 v[28:31], a[64:67], v[64:67], v[28:31]
    s_lshl_b32 s25, s20, 10
    v_mfma_f32_16x16x32_bf16 v[32:35], a[128:131], v[64:67], v[32:35]
    s_add_u32 s24, s24, s25
    v_mfma_f32_16x16x32_bf16 v[36:39], a[192:195], v[64:67], v[36:39]
    s_add_u32 s24, s24, 16384
    ds_read_b128 v[64:67], v3 offset:768
    s_waitcnt lgkmcnt(7)
    v_mfma_f32_16x16x32_bf16 v[24:27], a[4:7], v[68:71], v[24:27]
    v_add_u32 v124, s24, v7
    v_mfma_f32_16x16x32_bf16 v[28:31], a[68:71], v[68:71], v[28:31]
    global_load_dwordx4 v[104:107], v124, s[4:5] sc1
    v_mfma_f32_16x16x32_bf16 v[32:35], a[132:135], v[68:71], v[32:35]
    global_load_dwordx4 v[108:111], v124, s[4:5] offset:1024 sc1
    v_mfma_f32_16x16x32_bf16 v[36:39], a[196:199], v[68:71], v[36:39]
    ds_read_b128 v[68:71], v4 offset:768
    s_waitcnt lgkmcnt(7)
    v_mfma_f32_16x16x32_bf16 v[24:27], a[8:11], v[72:75], v[24:27]
    s_lshl_b32 s23, s39, 7
    v_mfma_f32_16x16x32_bf16 v[28:31], a[72:75], v[72:75], v[28:31]
    s_add_u32 s23, s23, s52
    v_mfma_f32_16x16x32_bf16 v[32:35], a[136:139], v[72:75], v[32:35]
    s_lshl_b32 s23, s23, 2
    v_mfma_f32_16x16x32_bf16 v[36:39], a[200:203], v[72:75], v[36:39]
    v_mov_b32 v124, s23
    ds_read_b128 v[72:75], v5 offset:768
    s_waitcnt lgkmcnt(7)
    v_mfma_f32_16x16x32_bf16 v[24:27], a[12:15], v[76:79], v[24:27]
    v_mov_b32 v125, 1
    v_mfma_f32_16x16x32_bf16 v[28:31], a[76:79], v[76:79], v[28:31]
    v_add_u32 v124, 65536, v124
    v_mfma_f32_16x16x32_bf16 v[32:35], a[140:143], v[76:79], v[32:35]
    global_store_dword v124, v125, s[4:5] sc1
    v_mfma_f32_16x16x32_bf16 v[36:39], a[204:207], v[76:79], v[36:39]
    s_lshl_b32 s23, s30, 5
    ds_read_b128 v[76:79], v6 offset:768
    s_waitcnt lgkmcnt(7)
    v_mfma_f32_16x16x32_bf16 v[24:27], a[16:19], v[48:51], v[24:27]
    s_add_u32 s23, s23, s21
    v_mfma_f32_16x16x32_bf16 v[28:31], a[80:83], v[48:51], v[28:31]
    s_lshl_b32 s23, s23, 13
    v_mfma_f32_16x16x32_bf16 v[32:35], a[144:147], v[48:51], v[32:35]
    s_lshl_b32 s24, s20, 10
    v_mfma_f32_16x16x32_bf16 v[36:39], a[208:211], v[48:51], v[36:39]
    s_add_u32 s23, s23, s24
    s_waitcnt lgkmcnt(6)
    v_mfma_f32_16x16x32_bf16 v[24:27], a[20:23], v[52:55], v[24:27]
    s_add_u32 s33, s23, 2097152
    v_mfma_f32_16x16x32_bf16 v[28:31], a[84:87], v[52:55], v[28:31]
    s_add_u32 s31, s30, 1
    v_mfma_f32_16x16x32_bf16 v[32:35], a[148:151], v[52:55], v[32:35]
    s_and_b32 s31, s31, 1
    v_mfma_f32_16x16x32_bf16 v[36:39], a[212:215], v[52:55], v[36:39]
    s_waitcnt lgkmcnt(5)
    v_mfma_f32_16x16x32_bf16 v[24:27], a[24:27], v[56:59], v[24:27]
    v_mfma_f32_16x16x32_bf16 v[28:31], a[88:91], v[56:59], v[28:31]
    v_mfma_f32_16x16x32_bf16 v[32:35], a[152:155], v[56:59], v[32:35]
    v_mfma_f32_16x16x32_bf16 v[36:39], a[216:219], v[56:59], v[36:39]
    s_waitcnt lgkmcnt(4)
    v_mfma_f32_16x16x32_bf16 v[24:27], a[28:31], v[60:63], v[24:27]
    v_mfma_f32_16x16x32_bf16 v[28:31], a[92:95], v[60:63], v[28:31]
    v_mfma_f32_16x16x32_bf16 v[32:35], a[156:159], v[60:63], v[32:35]
    v_mfma_f32_16x16x32_bf16 v[36:39], a[220:223], v[60:63], v[36:39]
    s_waitcnt lgkmcnt(3)
    v_mfma_f32_16x16x32_bf16 v[24:27], a[48:51], v[64:67], v[24:27]
    v_mfma_f32_16x16x32_bf16 v[28:31], a[112:115], v[64:67], v[28:31]
    v_mfma_f32_16x16x32_bf16 v[32:35], a[176:179], v[64:67], v[32:35]
    v_mfma_f32_16x16x32_bf16 v[36:39], a[240:243], v[64:67], v[36:39]
    s_waitcnt lgkmcnt(2)
    v_mfma_f32_16x16x32_bf16 v[24:27], a[52:55], v[68:71], v[24:27]
    v_mfma_f32_16x16x32_bf16 v[28:31], a[116:119], v[68:71], v[28:31]
    v_mfma_f32_16x16x32_bf16 v[32:35], a[180:183], v[68:71], v[32:35]
    v_mfma_f32_16x16x32_bf16 v[36:39], a[244:247], v[68:71], v[36:39]
    s_waitcnt lgkmcnt(1)
    v_mfma_f32_16x16x32_bf16 v[24:27], a[56:59], v[72:75], v[24:27]
    v_mfma_f32_16x16x32_bf16 v[28:31], a[120:123], v[72:75], v[28:31]
    v_mfma_f32_16x16x32_bf16 v[32:35], a[184:187], v[72:75], v[32:35]
    v_mfma_f32_16x16x32_bf16 v[36:39], a[248:251], v[72:75], v[36:39]
    s_waitcnt lgkmcnt(0)
    v_mfma_f32_16x16x32_bf16 v[24:27], a[60:63], v[76:79], v[24:27]
    v_mfma_f32_16x16x32_bf16 v[28:31], a[124:127], v[76:79], v[28:31]
    v_mfma_f32_16x16x32_bf16 v[32:35], a[188:191], v[76:79], v[32:35]
    v_mfma_f32_16x16x32_bf16 v[36:39], a[252:255], v[76:79], v[36:39]
    s_branch Lp1_done
    s_nop 6
Lp1_3:
    ds_read_b128 v[48:51], v3 offset:768
    ds_read_b128 v[52:55], v4 offset:768
    ds_read_b128 v[56:59], v5 offset:768
    ds_read_b128 v[60:63], v6 offset:768
    s_waitcnt lgkmcnt(3)
    v_mfma_f32_16x16x32_bf16 v[24:27], a[48:51], v[48:51], 0
    s_sub_u32 s36, s30, 11
    v_mfma_f32_16x16x32_bf16 v[28:31], a[112:115], v[48:51], 0
    s_add_u32 s23, s30, 0
    v_mfma_f32_16x16x32_bf16 v[32:35], a[176:179], v[48:51], 0
    s_mul_i32 s23, s23, 786432
    v_mfma_f32_16x16x32_bf16 v[36:39], a[240:243], v[48:51], 0
    s_add_u32 s23, s23, s53
    s_waitcnt lgkmcnt(2)
    v_mfma_f32_16x16x32_bf16 v[24:27], a[52:55], v[52:55], v[24:27]
    s_cmp_lt_u32 s30, 64
    v_mfma_f32_16x16x32_bf16 v[28:31], a[116:119], v[52:55], v[28:31]
    s_cselect_b32 s24, s23, s54
    v_mfma_f32_16x16x32_bf16 v[32:35], a[180:183], v[52:55], v[32:35]
    s_lshl_b32 s25, s20, 10
    v_mfma_f32_16x16x32_bf16 v[36:39], a[244:247], v[52:55], v[36:39]
    s_add_u32 s24, s24, s25
    s_barrier
    ds_read_b128 v[64:67], v3 offset:0
    ds_read_b128 v[68:71], v4 offset:0
    ds_read_b128 v[72:75], v5 offset:0
    ds_read_b128 v[76:79], v6 offset:0
    ds_read_b128 v[48:51], v3 offset:256
    ds_read_b128 v[52:55], v4 offset:256
    s_waitcnt lgkmcnt(7)
    v_mfma_f32_16x16x32_bf16 v[24:27], a[56:59], v[56:59], v[24:27]
    s_add_u32 s24, s24, 16384
    v_mfma_f32_16x16x32_bf16 v[28:31], a[120:123], v[56:59], v[28:31]
    v_add_u32 v124, s24, v7
    v_mfma_f32_16x16x32_bf16 v[32:35], a[184:187], v[56:59], v[32:35]
    global_load_dwordx4 v[96:99], v124, s[4:5] sc1
    v_mfma_f32_16x16x32_bf16 v[36:39], a[248:251], v[56:59], v[36:39]
    global_load_dwordx4 v[100:103], v124, s[4:5] offset:1024 sc1
    ds_read_b128 v[56:59], v5 offset:256
    s_waitcnt lgkmcnt(7)
    v_mfma_f32_16x16x32_bf16 v[24:27], a[60:63], v[60:63], v[24:27]
    s_add_u32 s23, s36, 64
    v_mfma_f32_16x16x32_bf16 v[28:31], a[124:127], v[60:63], v[28:31]
    s_mul_i32 s23, s23, 786432
    v_mfma_f32_16x16x32_bf16 v[32:35], a[188:191], v[60:63], v[32:35]
    s_add_u32 s23, s23, s53
    v_mfma_f32_16x16x32_bf16 v[36:39], a[252:255], v[60:63], v[36:39]
    s_cmp_lt_u32 s36, 64
    ds_read_b128 v[60:63], v6 offset:256
    s_waitcnt lgkmcnt(7)
    v_mfma_f32_16x16x32_bf16 v[24:27], a[0:3], v[64:67], v[24:27]
    s_cselect_b32 s24, s23, s54
    v_mfma_f32_16x16x32_bf16 v[28:31], a[64:67], v[64:67], v[28:31]
    s_lshl_b32 s25, s20, 10
    v_mfma_f32_16x16x32_bf16 v[32:35], a[128:131], v[64:67], v[32:35]
    s_add_u32 s24, s24, s25
    v_mfma_f32_16x16x32_bf16 v[36:39], a[192:195], v[64:67], v[36:39]
    s_add_u32 s24, s24, 16384
    ds_read_b128 v[64:67], v3 offset:512
    s_waitcnt lgkmcnt(7)
    v_mfma_f32_16x16x32_bf16 v[24:27], a[4:7], v[68:71], v[24:27]
    v_add_u32 v124, s24, v7
    v_mfma_f32_16x16x32_bf16 v[28:31], a[68:71], v[68:71], v[28:31]
    global_load_dwordx4 v[104:107], v124, s[4:5] sc1
    v_mfma_f32_16x16x32_bf16 v[32:35], a[132:135], v[68:71], v[32:35]
    global_load_dwordx4 v[108:111], v124, s[4:5] offset:1024 sc1
    v_mfma_f32_16x16x32_bf16 v[36:39], a[196:199], v[68:71], v[36:39]
    ds_read_b128 v[68:71], v4 offset:512
    s_waitcnt lgkmcnt(7)
    v_mfma_f32_16x16x32_bf16 v[24:27], a[8:11], v[72:75], v[24:27]
    s_lshl_b32 s23, s39, 7
    v_mfma_f32_16x16x32_bf16 v[28:31], a[72:75], v[72:75], v[28:31]
    s_add_u32 s23, s23, s52
    v_mfma_f32_16x16x32_bf16 v[32:35], a[136:139], v[72:75], v[32:35]
    s_lshl_b32 s23, s23, 2
    v_mfma_f32_16x16x32_bf16 v[36:39], a[200:203], v[72:75], v[36:39]
    v_mov_b32 v124, s23
    ds_read_b128 v[72:75], v5 offset:512
    s_waitcnt lgkmcnt(7)
    v_mfma_f32_16x16x32_bf16 v[24:27], a[12:15], v[76:79], v[24:27]
    v_mov_b32 v125, 1
    v_mfma_f32_16x16x32_bf16 v[28:31], a[76:79], v[76:79], v[28:31]
    v_add_u32 v124, 65536, v124
    v_mfma_f32_16x16x32_bf16 v[32:35], a[140:143], v[76:79], v[32:35]
    global_store_dword v124, v125, s[4:5] sc1
    v_mfma_f32_16x16x32_bf16 v[36:39], a[204:207], v[76:79], v[36:39]
    s_lshl_b32 s23, s30, 5
    ds_read_b128 v[76:79], v6 offset:512
    s_waitcnt lgkmcnt(7)
    v_mfma_f32_16x16x32_bf16 v[24:27], a[16:19], v[48:51], v[24:27]
    s_add_u32 s23, s23, s21
    v_mfma_f32_16x16x32_bf16 v[28:31], a[80:83], v[48:51], v[28:31]
    s_lshl_b32 s23, s23, 13
    v_mfma_f32_16x16x32_bf16 v[32:35], a[144:147], v[48:51], v[32:35]
    s_lshl_b32 s24, s20, 10
    v_mfma_f32_16x16x32_bf16 v[36:39], a[208:211], v[48:51], v[36:39]
    s_add_u32 s23, s23, s24
    s_waitcnt lgkmcnt(6)
    v_mfma_f32_16x16x32_bf16 v[24:27], a[20:23], v[52:55], v[24:27]
    s_add_u32 s33, s23, 2097152
    v_mfma_f32_16x16x32_bf16 v[28:31], a[84:87], v[52:55], v[28:31]
    s_add_u32 s31, s30, 1
    v_mfma_f32_16x16x32_bf16 v[32:35], a[148:151], v[52:55], v[32:35]
    s_and_b32 s31, s31, 1
    v_mfma_f32_16x16x32_bf16 v[36:39], a[212:215], v[52:55], v[36:39]
    s_waitcnt lgkmcnt(5)
    v_mfma_f32_16x16x32_bf16 v[24:27], a[24:27], v[56:59], v[24:27]
    v_mfma_f32_16x16x32_bf16 v[28:31], a[88:91], v[56:59], v[28:31]
    v_mfma_f32_16x16x32_bf16 v[32:35], a[152:155], v[56:59], v[32:35]
    v_mfma_f32_16x16x32_bf16 v[36:39], a[216:219], v[56:59], v[36:39]
    s_waitcnt lgkmcnt(4)
    v_mfma_f32_16x16x32_bf16 v[24:27], a[28:31], v[60:63], v[24:27]
    v_mfma_f32_16x16x32_bf16 v[28:31], a[92:95], v[60:63], v[28:31]
    v_mfma_f32_16x16x32_bf16 v[32:35], a[156:159], v[60:63], v[32:35]
    v_mfma_f32_16x16x32_bf16 v[36:39], a[220:223], v[60:63], v[36:39]
    s_waitcnt lgkmcnt(3)
    v_mfma_f32_16x16x32_bf16 v[24:27], a[32:35], v[64:67], v[24:27]
    v_mfma_f32_16x16x32_bf16 v[28:31], a[96:99], v[64:67], v[28:31]
    v_mfma_f32_16x16x32_bf16 v[32:35], a[160:163], v[64:67], v[32:35]
    v_mfma_f32_16x16x32_bf16 v[36:39], a[224:227], v[64:67], v[36:39]
    s_waitcnt lgkmcnt(2)
    v_mfma_f32_16x16x32_bf16 v[24:27], a[36:39], v[68:71], v[24:27]
    v_mfma_f32_16x16x32_bf16 v[28:31], a[100:103], v[68:71], v[28:31]
    v_mfma_f32_16x16x32_bf16 v[32:35], a[164:167], v[68:71], v[32:35]
    v_mfma_f32_16x16x32_bf16 v[36:39], a[228:231], v[68:71], v[36:39]
    s_waitcnt lgkmcnt(1)
    v_mfma_f32_16x16x32_bf16 v[24:27], a[40:43], v[72:75], v[24:27]
    v_mfma_f32_16x16x32_bf16 v[28:31], a[104:107], v[72:75], v[28:31]
    v_mfma_f32_16x16x32_bf16 v[32:35], a[168:171], v[72:75], v[32:35]
    v_mfma_f32_16x16x32_bf16 v[36:39], a[232:235], v[72:75], v[36:39]
    s_waitcnt lgkmcnt(0)
    v_mfma_f32_16x16x32_bf16 v[24:27], a[44:47], v[76:79], v[24:27]
    v_mfma_f32_16x16x32_bf16 v[28:31], a[108:111], v[76:79], v[28:31]
    v_mfma_f32_16x16x32_bf16 v[32:35], a[172:175], v[76:79], v[32:35]
    v_mfma_f32_16x16x32_bf16 v[36:39], a[236:239], v[76:79], v[36:39]
    s_nop 7
Lp1_done:
    v_add_u32 v124, s33, v7
    v_cvt_pk_bf16_f32 v112, v24, v25
    v_cvt_pk_bf16_f32 v116, v32, v33
    v_cvt_pk_bf16_f32 v113, v26, v27
    v_cvt_pk_bf16_f32 v117, v34, v35
    v_cvt_pk_bf16_f32 v114, v28, v29
    v_cvt_pk_bf16_f32 v118, v36, v37
    v_cvt_pk_bf16_f32 v115, v30, v31
    v_cvt_pk_bf16_f32 v119, v38, v39
    s_nop 0
    v_mfma_f32_16x16x32_bf16 v[48:51], v[80:83], v[112:115], 0
    v_mfma_f32_16x16x32_bf16 v[52:55], v[84:87], v[112:115], 0
    v_mfma_f32_16x16x32_bf16 v[56:59], v[88:91], v[112:115], 0
    v_mfma_f32_16x16x32_bf16 v[60:63], v[92:95], v[112:115], 0
    v_mfma_f32_16x16x32_bf16 v[76:79], v[116:119], v[112:115], 0
    global_store_dwordx4 v124, v[116:119], s[4:5] sc1
    s_add_u32 s35, s30, 1
    s_sub_u32 s36, s35, 11
    s_nop 2
    v_cndmask_b32 v68, v48, v56, s[44:45]
    v_cndmask_b32 v69, v49, v57, s[44:45]
    v_cndmask_b32 v70, v50, v58, s[44:45]
    v_cndmask_b32 v71, v51, v59, s[44:45]
    v_cndmask_b32 v72, v52, v60, s[44:45]
    v_cndmask_b32 v73, v53, v61, s[44:45]
    v_cndmask_b32 v74, v54, v62, s[44:45]
    v_cndmask_b32 v75, v55, v63, s[44:45]
    ds_write_b128 v9, v[68:71] offset:0
    ds_write_b128 v9, v[72:75] offset:1024
    ds_write_b128 v9, v[76:79] offset:2048
    s_waitcnt lgkmcnt(0)
    s_barrier
    ds_read_b128 v[24:27], v0 offset:0
    ds_read_b128 v[28:31], v0 offset:1024
    ds_read_b128 v[32:35], v0 offset:2048
    ds_read_b128 v[80:83], v1 offset:0
    ds_read_b128 v[84:87], v1 offset:1024
    ds_read_b128 v[88:91], v1 offset:2048
    ds_read_b128 v[112:115], v2 offset:0
    ds_read_b128 v[116:119], v2 offset:1024
    ds_read_b128 v[120:123], v2 offset:2048
    ds_read_b128 v[48:51], v3 offset:0
    ds_read_b128 v[52:55], v4 offset:0
    ds_read_b128 v[56:59], v5 offset:0
    ds_read_b128 v[60:63], v6 offset:0
    s_cmp_ge_u32 s35, 64
    s_cbranch_scc1 Lfok_5
    v_cmp_ne_u32 s[40:41], 1, v18
    s_cmp_eq_u64 s[40:41], 0
    s_cbranch_scc1 Lfok_5
    s_min_u32 s23, s35, 63
    s_add_u32 s23, s23, 0
    s_lshl_b32 s23, s23, 7
    s_add_u32 s23, s23, s52
    s_lshl_b32 s23, s23, 2
    v_mov_b32 v124, s23
    s_mov_b32 s90, 0
    s_nop 0
Lpoll_6:
    global_load_dword v125, v124, s[4:5] offset:0 sc1
    s_waitcnt vmcnt(0)
    v_cmp_ne_u32 s[40:41], 1, v125
    s_cmp_eq_u64 s[40:41], 0
    s_cbranch_scc1 Lpd_7
    s_add_u32 s90, s90, 1
    s_cmp_lt_u32 s90, 400000
    s_nop 0
    s_cbranch_scc1 Lpoll_6
    v_mov_b32 v126, 68
    v_mov_b32 v127, 257
    global_store_dword v126, v127, s[10:11]
    s_waitcnt vmcnt(0)
    s_endpgm
Lpd_7:
Lfok_5:
    s_cmp_ge_u32 s36, 64
    s_cbranch_scc1 Lfok_8
    v_cmp_ne_u32 s[40:41], 1, v19
    s_cmp_eq_u64 s[40:41], 0
    s_cbranch_scc1 Lfok_8
    s_min_u32 s23, s36, 63
    s_add_u32 s23, s23, 64
    s_lshl_b32 s23, s23, 7
    s_add_u32 s23, s23, s52
    s_lshl_b32 s23, s23, 2
    v_mov_b32 v124, s23
    s_mov_b32 s90, 0
    s_nop 0
Lpoll_9:
    global_load_dword v125, v124, s[4:5] offset:0 sc1
    s_waitcnt vmcnt(0)
    v_cmp_ne_u32 s[40:41], 1, v125
    s_cmp_eq_u64 s[40:41], 0
    s_cbranch_scc1 Lpd_10
    s_add_u32 s90, s90, 1
    s_cmp_lt_u32 s90, 400000
    s_nop 0
    s_cbranch_scc1 Lpoll_9
    v_mov_b32 v126, 68
    v_mov_b32 v127, 257
    global_store_dword v126, v127, s[10:11]
    s_waitcnt vmcnt(0)
    s_endpgm
Lpd_10:
Lfok_8:
    s_waitcnt lgkmcnt(3)
    v_mfma_f32_16x16x32_bf16 v[40:43], v[48:51], v[128:131], 0
    s_add_u32 s37, s30, 2
    s_sub_u32 s38, s37, 11
    s_min_u32 s23, s37, 63
    s_add_u32 s23, s23, 0
    s_lshl_b32 s23, s23, 7
    v_mfma_f32_16x16x32_bf16 v[44:47], v[48:51], v[192:195], 0
    s_add_u32 s23, s23, s52
    s_lshl_b32 s23, s23, 2
    v_mov_b32 v124, s23
    global_load_dword v18, v124, s[4:5] offset:0 sc1
    s_min_u32 s23, s38, 63
    ds_read_b128 v[48:51], v3 offset:256
    s_waitcnt lgkmcnt(3)
    v_mfma_f32_16x16x32_bf16 v[40:43], v[52:55], v[132:135], v[40:43]
    s_add_u32 s23, s23, 64
    s_lshl_b32 s23, s23, 7
    s_add_u32 s23, s23, s52
    s_lshl_b32 s23, s23, 2
    v_mov_b32 v124, s23
    v_mfma_f32_16x16x32_bf16 v[44:47], v[52:55], v[196:199], v[44:47]
    global_load_dword v19, v124, s[4:5] offset:0 sc1
    v_mov_b32 v124, 0xf149f2ca
    s_waitcnt lgkmcnt(5)
    v_pk_add_f32 v[24:25], v[24:25], v[80:81]
    v_pk_add_f32 v[68:69], v[68:69], v[112:113]
    ds_read_b128 v[52:55], v4 offset:256
    s_waitcnt lgkmcnt(3)
    v_mfma_f32_16x16x32_bf16 v[40:43], v[56:59], v[136:139], v[40:43]
    v_pk_add_f32 v[26:27], v[26:27], v[82:83]
    v_pk_add_f32 v[70:71], v[70:71], v[114:115]
    v_pk_add_f32 v[28:29], v[28:29], v[84:85]
    v_pk_add_f32 v[72:73], v[72:73], v[116:117]
    v_pk_add_f32 v[30:31], v[30:31], v[86:87]
    v_mfma_f32_16x16x32_bf16 v[44:47], v[56:59], v[200:203], v[44:47]
    v_pk_add_f32 v[74:75], v[74:75], v[118:119]
    v_pk_add_f32 v[32:33], v[32:33], v[88:89]
    v_pk_add_f32 v[76:77], v[76:77], v[120:121]
    v_pk_add_f32 v[34:35], v[34:35], v[90:91]
    v_pk_add_f32 v[78:79], v[78:79], v[122:123]
    ds_read_b128 v[56:59], v5 offset:256
    s_waitcnt lgkmcnt(3)
    v_mfma_f32_16x16x32_bf16 v[40:43], v[60:63], v[140:143], v[40:43]
    v_pk_add_f32 v[68:69], v[68:69], v[24:25]
    v_pk_add_f32 v[70:71], v[70:71], v[26:27]
    v_pk_add_f32 v[72:73], v[72:73], v[28:29]
    v_pk_add_f32 v[74:75], v[74:75], v[30:31]
    v_pk_add_f32 v[76:77], v[76:77], v[32:33]
    v_mfma_f32_16x16x32_bf16 v[44:47], v[60:63], v[204:207], v[44:47]
    v_pk_add_f32 v[78:79], v[78:79], v[34:35]
    v_cndmask_b32 v76, v124, v76, s[46:47]
    v_cndmask_b32 v77, v124, v77, s[46:47]
    v_cndmask_b32 v78, v124, v78, s[46:47]
    v_cndmask_b32 v79, v124, v79, s[46:47]
    ds_read_b128 v[60:63], v6 offset:256
    s_waitcnt lgkmcnt(3)
    v_mfma_f32_16x16x32_bf16 v[40:43], v[48:51], v[144:147], v[40:43]
    v_max3_f32 v124, v68, v69, v70
    v_max3_f32 v124, v124, v71, v72
    v_max3_f32 v124, v124, v73, v74
    v_max3_f32 v124, v124, v75, v76
    v_max3_f32 v124, v124, v77, v78
    v_mfma_f32_16x16x32_bf16 v[44:47], v[48:51], v[208:211], v[44:47]
    v_max_f32 v124, v124, v79
    v_mov_b32 v125, v124
    s_nop 1
    v_permlane16_swap_b32 v124, v125
    v_max_f32 v124, v124, v125
    v_mov_b32 v125, v124
    ds_read_b128 v[48:51], v3 offset:512
    s_waitcnt lgkmcnt(3)
    v_mfma_f32_16x16x32_bf16 v[40:43], v[52:55], v[148:151], v[40:43]
    v_permlane32_swap_b32 v124, v125
    v_max_f32 v124, v124, v125
    s_mov_b32 s23, 1040356334
    v_mul_f32 v124, s23, v124
    v_fma_f32 v68, v68, s23, -v124
    v_mfma_f32_16x16x32_bf16 v[44:47], v[52:55], v[212:215], v[44:47]
    v_fma_f32 v69, v69, s23, -v124
    v_fma_f32 v70, v70, s23, -v124
    v_fma_f32 v71, v71, s23, -v124
    v_fma_f32 v72, v72, s23, -v124
    v_fma_f32 v73, v73, s23, -v124
    ds_read_b128 v[52:55], v4 offset:512
    s_waitcnt lgkmcnt(3)
    v_mfma_f32_16x16x32_bf16 v[40:43], v[56:59], v[152:155], v[40:43]
    v_fma_f32 v74, v74, s23, -v124
    v_fma_f32 v75, v75, s23, -v124
    v_fma_f32 v76, v76, s23, -v124
    v_fma_f32 v77, v77, s23, -v124
    v_fma_f32 v78, v78, s23, -v124
    v_mfma_f32_16x16x32_bf16 v[44:47], v[56:59], v[216:219], v[44:47]
    v_fma_f32 v79, v79, s23, -v124
    v_exp_f32 v68, v68
    v_exp_f32 v69, v69
    v_exp_f32 v70, v70
    v_exp_f32 v71, v71
    ds_read_b128 v[56:59], v5 offset:512
    s_waitcnt lgkmcnt(3)
    v_mfma_f32_16x16x32_bf16 v[40:43], v[60:63], v[156:159], v[40:43]
    v_exp_f32 v72, v72
    v_exp_f32 v73, v73
    v_exp_f32 v74, v74
    v_exp_f32 v75, v75
    v_exp_f32 v76, v76
    v_mfma_f32_16x16x32_bf16 v[44:47], v[60:63], v[220:223], v[44:47]
    v_exp_f32 v77, v77
    v_exp_f32 v78, v78
    v_exp_f32 v79, v79
    v_add_f32 v124, v68, v69
    v_add_f32 v124, v124, v70
    ds_read_b128 v[60:63], v6 offset:512
    s_waitcnt lgkmcnt(3)
    v_mfma_f32_16x16x32_bf16 v[40:43], v[48:51], v[160:163], v[40:43]
    v_add_f32 v124, v124, v71
    v_add_f32 v124, v124, v72
    v_add_f32 v124, v124, v73
    v_add_f32 v124, v124, v74
    v_add_f32 v124, v124, v75
    v_mfma_f32_16x16x32_bf16 v[44:47], v[48:51], v[224:227], v[44:47]
    v_add_f32 v124, v124, v76
    v_add_f32 v124, v124, v77
    v_add_f32 v124, v124, v78
    v_add_f32 v124, v124, v79
    v_mov_b32 v125, v124
    ds_read_b128 v[48:51], v3 offset:768
    s_waitcnt lgkmcnt(3)
    v_mfma_f32_16x16x32_bf16 v[40:43], v[52:55], v[164:167], v[40:43]
    v_permlane16_swap_b32 v124, v125
    v_add_f32 v124, v124, v125
    v_mov_b32 v125, v124
    s_nop 1
    v_permlane32_swap_b32 v124, v125
    v_add_f32 v124, v124, v125
    v_mfma_f32_16x16x32_bf16 v[44:47], v[52:55], v[228:231], v[44:47]
    v_rcp_f32 v124, v124
    s_nop 0
    v_mul_f32 v68, v68, v124
    v_mul_f32 v69, v69, v124
    v_mul_f32 v70, v70, v124
    v_mul_f32 v71, v71, v124
    ds_read_b128 v[52:55], v4 offset:768
    s_waitcnt lgkmcnt(3)
    v_mfma_f32_16x16x32_bf16 v[40:43], v[56:59], v[168:171], v[40:43]
    v_mul_f32 v72, v72, v124
    v_mul_f32 v73, v73, v124
    v_mul_f32 v74, v74, v124
    v_mul_f32 v75, v75, v124
    v_mul_f32 v76, v76, v124
    v_mfma_f32_16x16x32_bf16 v[44:47], v[56:59], v[232:235], v[44:47]
    v_mul_f32 v77, v77, v124
    v_mul_f32 v78, v78, v124
    v_mul_f32 v79, v79, v124
    v_cvt_pk_bf16_f32 v24, v68, v69
    v_cvt_pk_bf16_f32 v25, v70, v71
    ds_read_b128 v[56:59], v5 offset:768
    s_waitcnt lgkmcnt(3)
    v_mfma_f32_16x16x32_bf16 v[40:43], v[60:63], v[172:175], v[40:43]
    v_cvt_pk_bf16_f32 v26, v72, v73
    v_cvt_pk_bf16_f32 v27, v74, v75
    v_cvt_pk_bf16_f32 v36, v76, v77
    v_cvt_pk_bf16_f32 v37, v78, v79
    v_cndmask_b32 v28, v24, 0, s[44:45]
    v_mfma_f32_16x16x32_bf16 v[44:47], v[60:63], v[236:239], v[44:47]
    v_cndmask_b32 v32, 0, v24, s[44:45]
    v_cndmask_b32 v29, v25, 0, s[44:45]
    v_cndmask_b32 v33, 0, v25, s[44:45]
    v_cndmask_b32 v30, v26, 0, s[44:45]
    v_cndmask_b32 v34, 0, v26, s[44:45]
    ds_read_b128 v[60:63], v6 offset:768
    s_waitcnt lgkmcnt(3)
    v_mfma_f32_16x16x32_bf16 v[40:43], v[48:51], v[176:179], v[40:43]
    v_cndmask_b32 v31, v27, 0, s[44:45]
    v_cndmask_b32 v35, 0, v27, s[44:45]
    s_add_u32 s23, s35, 0
    s_mul_i32 s23, s23, 786432
    s_add_u32 s23, s23, s53
    v_mfma_f32_16x16x32_bf16 v[44:47], v[48:51], v[240:243], v[44:47]
    s_cmp_lt_u32 s35, 64
    s_cselect_b32 s24, s23, s54
    s_add_u32 s24, s24, 8192
    v_add_u32 v124, s24, v7
    v_add_u32 v125, 4096, v124
    s_waitcnt lgkmcnt(2)
    v_mfma_f32_16x16x32_bf16 v[40:43], v[52:55], v[180:183], v[40:43]
    global_load_dwordx4 v[80:83], v124, s[4:5] sc1
    global_load_dwordx4 v[84:87], v125, s[4:5] sc1
    s_add_u32 s23, s36, 64
    s_mul_i32 s23, s23, 786432
    s_add_u32 s23, s23, s53
    v_mfma_f32_16x16x32_bf16 v[44:47], v[52:55], v[244:247], v[44:47]
    s_cmp_lt_u32 s36, 64
    s_cselect_b32 s24, s23, s54
    s_add_u32 s24, s24, 8192
    v_add_u32 v124, s24, v7
    v_add_u32 v125, 4096, v124
    s_waitcnt lgkmcnt(1)
    v_mfma_f32_16x16x32_bf16 v[40:43], v[56:59], v[184:187], v[40:43]
    global_load_dwordx4 v[88:91], v124, s[4:5] sc1
    global_load_dwordx4 v[92:95], v125, s[4:5] sc1
    v_mfma_f32_16x16x32_bf16 v[44:47], v[56:59], v[248:251], v[44:47]
    s_waitcnt lgkmcnt(0)
    v_mfma_f32_16x16x32_bf16 v[40:43], v[60:63], v[188:191], v[40:43]
    v_mfma_f32_16x16x32_bf16 v[44:47], v[60:63], v[252:255], v[44:47]
    ds_read_b128 v[48:51], v22 offset:0
    ds_read_b128 v[52:55], v22 offset:32768
    ds_read_b128 v[56:59], v23 offset:0
    ds_read_b128 v[60:63], v23 offset:32768
    s_nop 2
    v_cvt_pk_bf16_f32 v120, v40, v41
    v_cvt_pk_bf16_f32 v121, v42, v43
    v_cvt_pk_bf16_f32 v122, v44, v45
    v_cvt_pk_bf16_f32 v123, v46, v47
    v_add_u32 v124, s33, v7
    v_add_u32 v124, 4096, v124
    s_waitcnt vmcnt(8)
    v_mfma_f32_16x16x32_bf16 v[64:67], v[96:99], v[28:31], 0
    v_mfma_f32_16x16x32_bf16 v[68:71], v[100:103], v[28:31], 0
    v_mfma_f32_16x16x32_bf16 v[64:67], v[104:107], v[32:35], v[64:67]
    v_mfma_f32_16x16x32_bf16 v[68:71], v[108:111], v[32:35], v[68:71]
    v_mfma_f32_16x16x16_bf16 v[40:43], v[120:121], v[36:37], 0
    v_mfma_f32_16x16x16_bf16 v[44:47], v[122:123], v[36:37], 0
    global_store_dwordx4 v124, v[120:123], s[4:5] sc1
    s_nop 5
    v_pk_add_f32 v[64:65], v[64:65], v[40:41]
    v_pk_add_f32 v[66:67], v[66:67], v[42:43]
    v_pk_add_f32 v[68:69], v[68:69], v[44:45]
    v_pk_add_f32 v[70:71], v[70:71], v[46:47]
    v_cvt_pk_bf16_f32 v72, v64, v65
    v_cvt_pk_bf16_f32 v73, v66, v67
    v_cvt_pk_bf16_f32 v74, v68, v69
    v_cvt_pk_bf16_f32 v75, v70, v71
    ds_write_b128 v20, v[72:75]
    s_waitcnt lgkmcnt(0)
    s_barrier
    ds_read_b128 v[96:99], v21 offset:12288
    ds_read_b128 v[100:103], v21 offset:13312
    ds_read_b128 v[104:107], v21 offset:14336
    ds_read_b128 v[108:111], v21 offset:15360
    ds_read_b128 v[24:27], v22 offset:1024
    ds_read_b128 v[28:31], v22 offset:33792
    ds_read_b128 v[32:35], v23 offset:1024
    ds_read_b128 v[36:39], v23 offset:33792
    ds_read_b128 v[64:67], v22 offset:2048
    ds_read_b128 v[68:71], v22 offset:34816
    ds_read_b128 v[72:75], v23 offset:2048
    ds_read_b128 v[76:79], v23 offset:34816
    s_waitcnt lgkmcnt(4)
    v_mfma_f32_16x16x32_bf16 v[40:43], v[48:51], v[96:99], 0
    v_mfma_f32_16x16x32_bf16 v[40:43], v[52:55], v[100:103], v[40:43]
    v_mfma_f32_16x16x32_bf16 v[40:43], v[56:59], v[104:107], v[40:43]
    v_mfma_f32_16x16x32_bf16 v[40:43], v[60:63], v[108:111], v[40:43]
    ds_read_b128 v[48:51], v22 offset:3072
    ds_read_b128 v[52:55], v22 offset:35840
    ds_read_b128 v[56:59], v23 offset:3072
    ds_read_b128 v[60:63], v23 offset:35840
    s_waitcnt lgkmcnt(8)
    v_mfma_f32_16x16x32_bf16 v[44:47], v[24:27], v[96:99], 0
    v_mfma_f32_16x16x32_bf16 v[44:47], v[28:31], v[100:103], v[44:47]
    v_mfma_f32_16x16x32_bf16 v[44:47], v[32:35], v[104:107], v[44:47]
    v_mfma_f32_16x16x32_bf16 v[44:47], v[36:39], v[108:111], v[44:47]
    v_cvt_pk_bf16_f32 v124, v40, v41
    v_cvt_pk_bf16_f32 v125, v42, v43
    v_and_or_b32 v124, v124, v10, s31
    v_and_or_b32 v125, v125, v10, s31
    v_add_u32 v40, 0, v11
    global_store_dwordx2 v40, v[124:125], s[4:5]
    ds_read_b128 v[24:27], v22 offset:4096
    ds_read_b128 v[28:31], v22 offset:36864
    ds_read_b128 v[32:35], v23 offset:4096
    ds_read_b128 v[36:39], v23 offset:36864
    s_waitcnt lgkmcnt(8)
    v_mfma_f32_16x16x32_bf16 v[40:43], v[64:67], v[96:99], 0
    v_mfma_f32_16x16x32_bf16 v[40:43], v[68:71], v[100:103], v[40:43]
    v_mfma_f32_16x16x32_bf16 v[40:43], v[72:75], v[104:107], v[40:43]
    v_mfma_f32_16x16x32_bf16 v[40:43], v[76:79], v[108:111], v[40:43]
    v_cvt_pk_bf16_f32 v126, v44, v45
    v_cvt_pk_bf16_f32 v127, v46, v47
    v_and_or_b32 v126, v126, v10, s31
    v_and_or_b32 v127, v127, v10, s31
    v_add_u32 v44, 16384, v11
    global_store_dwordx2 v44, v[126:127], s[4:5]
    ds_read_b128 v[64:67], v22 offset:5120
    ds_read_b128 v[68:71], v22 offset:37888
    ds_read_b128 v[72:75], v23 offset:5120
    ds_read_b128 v[76:79], v23 offset:37888
    s_waitcnt lgkmcnt(8)
    v_mfma_f32_16x16x32_bf16 v[44:47], v[48:51], v[96:99], 0
    v_mfma_f32_16x16x32_bf16 v[44:47], v[52:55], v[100:103], v[44:47]
    v_mfma_f32_16x16x32_bf16 v[44:47], v[56:59], v[104:107], v[44:47]
    v_mfma_f32_16x16x32_bf16 v[44:47], v[60:63], v[108:111], v[44:47]
    v_cvt_pk_bf16_f32 v124, v40, v41
    v_cvt_pk_bf16_f32 v125, v42, v43
    v_and_or_b32 v124, v124, v10, s31
    v_and_or_b32 v125, v125, v10, s31
    v_add_u32 v40, 32768, v11
    global_store_dwordx2 v40, v[124:125], s[4:5]
    ds_read_b128 v[48:51], v22 offset:6144
    ds_read_b128 v[52:55], v22 offset:38912
    ds_read_b128 v[56:59], v23 offset:6144
    ds_read_b128 v[60:63], v23 offset:38912
    s_waitcnt lgkmcnt(8)
    v_mfma_f32_16x16x32_bf16 v[40:43], v[24:27], v[96:99], 0
    v_mfma_f32_16x16x32_bf16 v[40:43], v[28:31], v[100:103], v[40:43]
    v_mfma_f32_16x16x32_bf16 v[40:43], v[32:35], v[104:107], v[40:43]
    v_mfma_f32_16x16x32_bf16 v[40:43], v[36:39], v[108:111], v[40:43]
    v_cvt_pk_bf16_f32 v126, v44, v45
    v_cvt_pk_bf16_f32 v127, v46, v47
    v_and_or_b32 v126, v126, v10, s31
    v_and_or_b32 v127, v127, v10, s31
    v_add_u32 v44, 49152, v11
    global_store_dwordx2 v44, v[126:127], s[4:5]
    ds_read_b128 v[24:27], v22 offset:7168
    ds_read_b128 v[28:31], v22 offset:39936
    ds_read_b128 v[32:35], v23 offset:7168
    ds_read_b128 v[36:39], v23 offset:39936
    s_waitcnt lgkmcnt(8)
    v_mfma_f32_16x16x32_bf16 v[44:47], v[64:67], v[96:99], 0
    v_mfma_f32_16x16x32_bf16 v[44:47], v[68:71], v[100:103], v[44:47]
    v_mfma_f32_16x16x32_bf16 v[44:47], v[72:75], v[104:107], v[44:47]
    v_mfma_f32_16x16x32_bf16 v[44:47], v[76:79], v[108:111], v[44:47]
    v_cvt_pk_bf16_f32 v124, v40, v41
    v_cvt_pk_bf16_f32 v125, v42, v43
    v_and_or_b32 v124, v124, v10, s31
    v_and_or_b32 v125, v125, v10, s31
    v_add_u32 v40, 65536, v11
    global_store_dwordx2 v40, v[124:125], s[4:5]
    s_waitcnt lgkmcnt(4)
    v_mfma_f32_16x16x32_bf16 v[40:43], v[48:51], v[96:99], 0
    v_mfma_f32_16x16x32_bf16 v[40:43], v[52:55], v[100:103], v[40:43]
    v_mfma_f32_16x16x32_bf16 v[40:43], v[56:59], v[104:107], v[40:43]
    v_mfma_f32_16x16x32_bf16 v[40:43], v[60:63], v[108:111], v[40:43]
    v_cvt_pk_bf16_f32 v126, v44, v45
    v_cvt_pk_bf16_f32 v127, v46, v47
    v_and_or_b32 v126, v126, v10, s31
    v_and_or_b32 v127, v127, v10, s31
    v_add_u32 v44, 81920, v11
    global_store_dwordx2 v44, v[126:127], s[4:5]
    s_waitcnt lgkmcnt(0)
    v_mfma_f32_16x16x32_bf16 v[44:47], v[24:27], v[96:99], 0
    v_mfma_f32_16x16x32_bf16 v[44:47], v[28:31], v[100:103], v[44:47]
    v_mfma_f32_16x16x32_bf16 v[44:47], v[32:35], v[104:107], v[44:47]
    v_mfma_f32_16x16x32_bf16 v[44:47], v[36:39], v[108:111], v[44:47]
    v_cvt_pk_bf16_f32 v124, v40, v41
    v_cvt_pk_bf16_f32 v125, v42, v43
    v_and_or_b32 v124, v124, v10, s31
    v_and_or_b32 v125, v125, v10, s31
    v_add_u32 v40, 98304, v11
    global_store_dwordx2 v40, v[124:125], s[4:5]
    s_nop 1
    v_cvt_pk_bf16_f32 v126, v44, v45
    v_cvt_pk_bf16_f32 v127, v46, v47
    v_and_or_b32 v126, v126, v10, s31
    v_and_or_b32 v127, v127, v10, s31
    v_add_u32 v44, 114688, v11
    global_store_dwordx2 v44, v[126:127], s[4:5]
    s_mov_b32 s90, 0
Lpoll_11:
    v_add_u32 v124, 4096, v12
    v_add_u32 v125, 8192, v12
    v_add_u32 v126, 12288, v12
    global_load_dwordx2 v[48:49], v12, s[4:5] offset:0 sc1
    global_load_dwordx2 v[50:51], v12, s[4:5] offset:2048 sc1
    global_load_dwordx2 v[52:53], v124, s[4:5] offset:0 sc1
    global_load_dwordx2 v[54:55], v124, s[4:5] offset:2048 sc1
    global_load_dwordx2 v[56:57], v125, s[4:5] offset:0 sc1
    global_load_dwordx2 v[58:59], v125, s[4:5] offset:2048 sc1
    global_load_dwordx2 v[60:61], v126, s[4:5] offset:0 sc1
    global_load_dwordx2 v[62:63], v126, s[4:5] offset:2048 sc1
    s_waitcnt vmcnt(0)
    v_and_b32 v124, v48, v50
    v_or3_b32 v125, v48, v50, v52
    v_and_b32 v124, v124, v52
    v_and_b32 v124, v124, v54
    v_and_b32 v124, v124, v56
    v_and_b32 v124, v124, v58
    v_and_b32 v124, v124, v60
    v_and_b32 v124, v124, v62
    v_or3_b32 v125, v125, v54, v56
    v_or3_b32 v125, v125, v58, v60
    v_or_b32 v125, v125, v62
    v_and_b32 v124, 1, v124
    v_and_b32 v125, 1, v125
    v_cmp_ne_u32 s[40:41], s31, v124
    v_cmp_ne_u32 s[42:43], s31, v125
    s_or_b64 s[40:41], s[40:41], s[42:43]
    s_cmp_eq_u64 s[40:41], 0
    s_cbranch_scc1 Lpd_12
    s_add_u32 s90, s90, 1
    s_cmp_lt_u32 s90, 400000
    s_cbranch_scc1 Lpoll_11
    v_mov_b32 v126, 72
    v_mov_b32 v127, 258
    global_store_dword v126, v127, s[10:11]
    s_waitcnt vmcnt(0)
    s_endpgm
Lpd_12:
    v_lshlrev_b32 v24, 16, v48
    v_and_b32 v25, 0xffff0000, v48
    v_lshlrev_b32 v26, 16, v49
    v_and_b32 v27, 0xffff0000, v49
    v_lshlrev_b32 v28, 16, v50
    v_and_b32 v29, 0xffff0000, v50
    v_pk_add_f32 v[24:25], v[24:25], v[28:29]
    v_lshlrev_b32 v30, 16, v51
    v_and_b32 v31, 0xffff0000, v51
    v_pk_add_f32 v[26:27], v[26:27], v[30:31]
    v_lshlrev_b32 v28, 16, v52
    v_and_b32 v29, 0xffff0000, v52
    v_pk_add_f32 v[24:25], v[24:25], v[28:29]
    v_lshlrev_b32 v30, 16, v53
    v_and_b32 v31, 0xffff0000, v53
    v_pk_add_f32 v[26:27], v[26:27], v[30:31]
    v_lshlrev_b32 v28, 16, v54
    v_and_b32 v29, 0xffff0000, v54
    v_pk_add_f32 v[24:25], v[24:25], v[28:29]
    v_lshlrev_b32 v30, 16, v55
    v_and_b32 v31, 0xffff0000, v55
    v_pk_add_f32 v[26:27], v[26:27], v[30:31]
    v_lshlrev_b32 v28, 16, v56
    v_and_b32 v29, 0xffff0000, v56
    v_pk_add_f32 v[24:25], v[24:25], v[28:29]
    v_lshlrev_b32 v30, 16, v57
    v_and_b32 v31, 0xffff0000, v57
    v_pk_add_f32 v[26:27], v[26:27], v[30:31]
    v_lshlrev_b32 v28, 16, v58
    v_and_b32 v29, 0xffff0000, v58
    v_pk_add_f32 v[24:25], v[24:25], v[28:29]
    v_lshlrev_b32 v30, 16, v59
    v_and_b32 v31, 0xffff0000, v59
    v_pk_add_f32 v[26:27], v[26:27], v[30:31]
    v_lshlrev_b32 v28, 16, v60
    v_and_b32 v29, 0xffff0000, v60
    v_pk_add_f32 v[24:25], v[24:25], v[28:29]
    v_lshlrev_b32 v30, 16, v61
    v_and_b32 v31, 0xffff0000, v61
    v_pk_add_f32 v[26:27], v[26:27], v[30:31]
    v_lshlrev_b32 v28, 16, v62
    v_and_b32 v29, 0xffff0000, v62
    v_pk_add_f32 v[24:25], v[24:25], v[28:29]
    v_lshlrev_b32 v30, 16, v63
    v_and_b32 v31, 0xffff0000, v63
    v_pk_add_f32 v[26:27], v[26:27], v[30:31]
    v_mov_b32 v28, v24
    s_nop 1
    v_permlane16_swap_b32 v24, v28
    v_add_f32 v24, v24, v28
    v_mov_b32 v28, v24
    s_nop 1
    v_permlane32_swap_b32 v24, v28
    v_add_f32 v24, v24, v28
    v_mov_b32 v29, v25
    s_nop 1
    v_permlane16_swap_b32 v25, v29
    v_add_f32 v25, v25, v29
    v_mov_b32 v29, v25
    s_nop 1
    v_permlane32_swap_b32 v25, v29
    v_add_f32 v25, v25, v29
    v_mov_b32 v30, v26
    s_nop 1
    v_permlane16_swap_b32 v26, v30
    v_add_f32 v26, v26, v30
    v_mov_b32 v30, v26
    s_nop 1
    v_permlane32_swap_b32 v26, v30
    v_add_f32 v26, v26, v30
    v_mov_b32 v31, v27
    s_nop 1
    v_permlane16_swap_b32 v27, v31
    v_add_f32 v27, v27, v31
    v_mov_b32 v31, v27
    s_nop 1
    v_permlane32_swap_b32 v27, v31
    v_add_f32 v27, v27, v31
    s_add_u32 s32, s30, 1
    v_cvt_pk_bf16_f32 v24, v24, v25
    v_cvt_pk_bf16_f32 v25, v26, v27
    v_mov_b32 v26, s32
    v_mov_b32 v27, s32
    s_cmp_gt_u32 s32, 11
    s_cbranch_scc1 Lov_13
    v_cndmask_b32 v24, v24, v16, s[50:51]
    v_cndmask_b32 v25, v25, v17, s[50:51]
    s_nop 1
Lov_13:
    s_mov_b64 exec, 0xffff
    global_store_dwordx4 v13, v[24:27], s[4:5]
    s_mov_b64 exec, -1
    s_cmp_ge_u32 s32, 75
    s_cbranch_scc1 Lchain_done
    s_mov_b32 s90, 0
Lpoll_14:
    global_load_dwordx4 v[48:51], v14, s[4:5] offset:0 sc1
    global_load_dwordx4 v[52:55], v14, s[4:5] offset:1024 sc1
    global_load_dwordx4 v[56:59], v14, s[4:5] offset:2048 sc1
    global_load_dwordx4 v[60:63], v14, s[4:5] offset:3072 sc1
    global_load_dwordx4 v[64:67], v15, s[4:5] offset:0 sc1
    global_load_dwordx4 v[68:71], v15, s[4:5] offset:1024 sc1
    global_load_dwordx4 v[72:75], v15, s[4:5] offset:2048 sc1
    global_load_dwordx4 v[76:79], v15, s[4:5] offset:3072 sc1
    s_waitcnt vmcnt(0)
    v_and_b32 v124, v50, v54
    v_or3_b32 v125, v50, v54, v58
    v_and_b32 v124, v124, v58
    v_and_b32 v124, v124, v62
    v_and_b32 v124, v124, v66
    v_and_b32 v124, v124, v70
    v_and_b32 v124, v124, v74
    v_and_b32 v124, v124, v78
    v_or3_b32 v125, v125, v62, v66
    v_or3_b32 v125, v125, v70, v74
    v_or_b32 v125, v125, v78
    v_cmp_ne_u32 s[40:41], s32, v124
    v_cmp_ne_u32 s[42:43], s32, v125
    s_or_b64 s[40:41], s[40:41], s[42:43]
    s_cmp_eq_u64 s[40:41], 0
    s_cbranch_scc1 Lpd_15
    s_add_u32 s90, s90, 1
    s_cmp_lt_u32 s90, 400000
    s_cbranch_scc1 Lpoll_14
    v_mov_b32 v126, 76
    v_mov_b32 v127, 259
    global_store_dword v126, v127, s[10:11]
    s_waitcnt vmcnt(0)
    s_endpgm
Lpd_15:
    v_xor_b32 v24, 0, v8
    ds_write_b64 v24, v[48:49]
    v_xor_b32 v25, 32, v8
    ds_write_b64 v25, v[52:53]
    v_xor_b32 v26, 64, v8
    ds_write_b64 v26, v[56:57]
    v_xor_b32 v27, 96, v8
    ds_write_b64 v27, v[60:61]
    v_xor_b32 v28, 128, v8
    ds_write_b64 v28, v[64:65]
    v_xor_b32 v29, 160, v8
    ds_write_b64 v29, v[68:69]
    v_xor_b32 v30, 192, v8
    ds_write_b64 v30, v[72:73]
    v_xor_b32 v31, 224, v8
    ds_write_b64 v31, v[76:77]
    s_mov_b32 s39, s30
    s_mov_b32 s30, s32
    s_branch Lchain_step
Lchain_done:
    s_lshl_b32 s23, s30, 7
    s_add_u32 s23, s23, s52
    s_lshl_b32 s23, s23, 2
    v_mov_b32 v124, s23
    v_mov_b32 v125, 1
    v_add_u32 v124, 65536, v124
    global_store_dword v124, v125, s[4:5] sc1
    s_waitcnt vmcnt(0)
    s_endpgm
LroleA:
    s_load_dwordx2 s[12:13], s[0:1], 16
    s_load_dwordx2 s[14:15], s[0:1], 24
    s_load_dwordx2 s[16:17], s[0:1], 32
    s_waitcnt lgkmcnt(0)
    v_and_b32 v1, 15, v0
    v_lshrrev_b32 v2, 4, v0
    v_lshlrev_b32 v7, 4, v0
    s_lshl_b32 s23, s20, 7
    v_add_u32 v24, s23, v2
    v_lshlrev_b32 v25, 13, v24
    s_lshl_b32 s24, s21, 8
    v_lshl_add_u32 v25, v1, 4, v25
    v_add_u32 v25, s24, v25
    v_mul_u32_u24 v26, 272, v24
    v_lshl_add_u32 v26, v1, 4, v26
    v_lshrrev_b32 v27, 2, v1
    v_lshl_add_u32 v27, v2, 3, v27
    v_mul_u32_u24 v27, 272, v27
    v_and_b32 v28, 3, v1
    v_lshlrev_b32 v28, 3, v28
    v_add_u32 v27, v27, v28
    s_lshl_b32 s23, s20, 6
    v_add_u32 v27, s23, v27
    v_add_u32 v28, 34816, v27
    v_add_u32 v29, 69632, v27
    v_add_u32 v30, 104448, v27
    v_add_u32 v31, 0, v25
    global_load_dwordx4 v[32:35], v31, s[12:13]
    v_add_u32 v31, 32768, v25
    global_load_dwordx4 v[36:39], v31, s[12:13]
    v_add_u32 v31, 65536, v25
    global_load_dwordx4 v[40:43], v31, s[12:13]
    v_add_u32 v31, 98304, v25
    global_load_dwordx4 v[44:47], v31, s[12:13]
    v_add_u32 v31, 131072, v25
    global_load_dwordx4 v[48:51], v31, s[12:13]
    v_add_u32 v31, 163840, v25
    global_load_dwordx4 v[52:55], v31, s[12:13]
    v_add_u32 v31, 196608, v25
    global_load_dwordx4 v[56:59], v31, s[12:13]
    v_add_u32 v31, 229376, v25
    global_load_dwordx4 v[60:63], v31, s[12:13]
    s_waitcnt vmcnt(7)
    ds_write_b128 v26, v[32:35] offset:0
    s_waitcnt vmcnt(6)
    ds_write_b128 v26, v[36:39] offset:1088
    s_waitcnt vmcnt(5)
    ds_write_b128 v26, v[40:43] offset:2176
    s_waitcnt vmcnt(4)
    ds_write_b128 v26, v[44:47] offset:3264
    s_waitcnt vmcnt(3)
    ds_write_b128 v26, v[48:51] offset:4352
    s_waitcnt vmcnt(2)
    ds_write_b128 v26, v[52:55] offset:5440
    s_waitcnt vmcnt(1)
    ds_write_b128 v26, v[56:59] offset:6528
    s_waitcnt vmcnt(0)
    ds_write_b128 v26, v[60:63] offset:7616
    v_add_u32 v31, 262144, v25
    global_load_dwordx4 v[32:35], v31, s[12:13]
    v_add_u32 v31, 294912, v25
    global_load_dwordx4 v[36:39], v31, s[12:13]
    v_add_u32 v31, 327680, v25
    global_load_dwordx4 v[40:43], v31, s[12:13]
    v_add_u32 v31, 360448, v25
    global_load_dwordx4 v[44:47], v31, s[12:13]
    v_add_u32 v31, 393216, v25
    global_load_dwordx4 v[48:51], v31, s[12:13]
    v_add_u32 v31, 425984, v25
    global_load_dwordx4 v[52:55], v31, s[12:13]
    v_add_u32 v31, 458752, v25
    global_load_dwordx4 v[56:59], v31, s[12:13]
    v_add_u32 v31, 491520, v25
    global_load_dwordx4 v[60:63], v31, s[12:13]
    s_waitcnt vmcnt(7)
    ds_write_b128 v26, v[32:35] offset:8704
    s_waitcnt vmcnt(6)
    ds_write_b128 v26, v[36:39] offset:9792
    s_waitcnt vmcnt(5)
    ds_write_b128 v26, v[40:43] offset:10880
    s_waitcnt vmcnt(4)
    ds_write_b128 v26, v[44:47] offset:11968
    s_waitcnt vmcnt(3)
    ds_write_b128 v26, v[48:51] offset:13056
    s_waitcnt vmcnt(2)
    ds_write_b128 v26, v[52:55] offset:14144
    s_waitcnt vmcnt(1)
    ds_write_b128 v26, v[56:59] offset:15232
    s_waitcnt vmcnt(0)
    ds_write_b128 v26, v[60:63] offset:16320
    v_add_u32 v31, 524288, v25
    global_load_dwordx4 v[32:35], v31, s[12:13]
    v_add_u32 v31, 557056, v25
    global_load_dwordx4 v[36:39], v31, s[12:13]
    v_add_u32 v31, 589824, v25
    global_load_dwordx4 v[40:43], v31, s[12:13]
    v_add_u32 v31, 622592, v25
    global_load_dwordx4 v[44:47], v31, s[12:13]
    v_add_u32 v31, 655360, v25
    global_load_dwordx4 v[48:51], v31, s[12:13]
    v_add_u32 v31, 688128, v25
    global_load_dwordx4 v[52:55], v31, s[12:13]
    v_add_u32 v31, 720896, v25
    global_load_dwordx4 v[56:59], v31, s[12:13]
    v_add_u32 v31, 753664, v25
    global_load_dwordx4 v[60:63], v31, s[12:13]
    s_waitcnt vmcnt(7)
    ds_write_b128 v26, v[32:35] offset:17408
    s_waitcnt vmcnt(6)
    ds_write_b128 v26, v[36:39] offset:18496
    s_waitcnt vmcnt(5)
    ds_write_b128 v26, v[40:43] offset:19584
    s_waitcnt vmcnt(4)
    ds_write_b128 v26, v[44:47] offset:20672
    s_waitcnt vmcnt(3)
    ds_write_b128 v26, v[48:51] offset:21760
    s_waitcnt vmcnt(2)
    ds_write_b128 v26, v[52:55] offset:22848
    s_waitcnt vmcnt(1)
    ds_write_b128 v26, v[56:59] offset:23936
    s_waitcnt vmcnt(0)
    ds_write_b128 v26, v[60:63] offset:25024
    v_add_u32 v31, 786432, v25
    global_load_dwordx4 v[32:35], v31, s[12:13]
    v_add_u32 v31, 819200, v25
    global_load_dwordx4 v[36:39], v31, s[12:13]
    v_add_u32 v31, 851968, v25
    global_load_dwordx4 v[40:43], v31, s[12:13]
    v_add_u32 v31, 884736, v25
    global_load_dwordx4 v[44:47], v31, s[12:13]
    v_add_u32 v31, 917504, v25
    global_load_dwordx4 v[48:51], v31, s[12:13]
    v_add_u32 v31, 950272, v25
    global_load_dwordx4 v[52:55], v31, s[12:13]
    v_add_u32 v31, 983040, v25
    global_load_dwordx4 v[56:59], v31, s[12:13]
    v_add_u32 v31, 1015808, v25
    global_load_dwordx4 v[60:63], v31, s[12:13]
    s_waitcnt vmcnt(7)
    ds_write_b128 v26, v[32:35] offset:26112
    s_waitcnt vmcnt(6)
    ds_write_b128 v26, v[36:39] offset:27200
    s_waitcnt vmcnt(5)
    ds_write_b128 v26, v[40:43] offset:28288
    s_waitcnt vmcnt(4)
    ds_write_b128 v26, v[44:47] offset:29376
    s_waitcnt vmcnt(3)
    ds_write_b128 v26, v[48:51] offset:30464
    s_waitcnt vmcnt(2)
    ds_write_b128 v26, v[52:55] offset:31552
    s_waitcnt vmcnt(1)
    ds_write_b128 v26, v[56:59] offset:32640
    s_waitcnt vmcnt(0)
    ds_write_b128 v26, v[60:63] offset:33728
    s_waitcnt lgkmcnt(0)
    s_barrier
    ds_read_b64_tr_b16 a[0:1], v27 offset:0
    ds_read_b64_tr_b16 a[2:3], v27 offset:1088
    ds_read_b64_tr_b16 a[4:5], v27 offset:8704
    ds_read_b64_tr_b16 a[6:7], v27 offset:9792
    ds_read_b64_tr_b16 a[8:9], v27 offset:17408
    ds_read_b64_tr_b16 a[10:11], v27 offset:18496
    ds_read_b64_tr_b16 a[12:13], v27 offset:26112
    ds_read_b64_tr_b16 a[14:15], v27 offset:27200
    ds_read_b64_tr_b16 a[16:17], v28 offset:0
    ds_read_b64_tr_b16 a[18:19], v28 offset:1088
    ds_read_b64_tr_b16 a[20:21], v28 offset:8704
    ds_read_b64_tr_b16 a[22:23], v28 offset:9792
    ds_read_b64_tr_b16 a[24:25], v28 offset:17408
    ds_read_b64_tr_b16 a[26:27], v28 offset:18496
    ds_read_b64_tr_b16 a[28:29], v28 offset:26112
    ds_read_b64_tr_b16 a[30:31], v28 offset:27200
    ds_read_b64_tr_b16 a[32:33], v29 offset:0
    ds_read_b64_tr_b16 a[34:35], v29 offset:1088
    ds_read_b64_tr_b16 a[36:37], v29 offset:8704
    ds_read_b64_tr_b16 a[38:39], v29 offset:9792
    ds_read_b64_tr_b16 a[40:41], v29 offset:17408
    ds_read_b64_tr_b16 a[42:43], v29 offset:18496
    ds_read_b64_tr_b16 a[44:45], v29 offset:26112
    ds_read_b64_tr_b16 a[46:47], v29 offset:27200
    ds_read_b64_tr_b16 a[48:49], v30 offset:0
    ds_read_b64_tr_b16 a[50:51], v30 offset:1088
    ds_read_b64_tr_b16 a[52:53], v30 offset:8704
    ds_read_b64_tr_b16 a[54:55], v30 offset:9792
    ds_read_b64_tr_b16 a[56:57], v30 offset:17408
    ds_read_b64_tr_b16 a[58:59], v30 offset:18496
    ds_read_b64_tr_b16 a[60:61], v30 offset:26112
    ds_read_b64_tr_b16 a[62:63], v30 offset:27200
    ds_read_b64_tr_b16 a[64:65], v27 offset:32
    ds_read_b64_tr_b16 a[66:67], v27 offset:1120
    ds_read_b64_tr_b16 a[68:69], v27 offset:8736
    ds_read_b64_tr_b16 a[70:71], v27 offset:9824
    ds_read_b64_tr_b16 a[72:73], v27 offset:17440
    ds_read_b64_tr_b16 a[74:75], v27 offset:18528
    ds_read_b64_tr_b16 a[76:77], v27 offset:26144
    ds_read_b64_tr_b16 a[78:79], v27 offset:27232
    ds_read_b64_tr_b16 a[80:81], v28 offset:32
    ds_read_b64_tr_b16 a[82:83], v28 offset:1120
    ds_read_b64_tr_b16 a[84:85], v28 offset:8736
    ds_read_b64_tr_b16 a[86:87], v28 offset:9824
    ds_read_b64_tr_b16 a[88:89], v28 offset:17440
    ds_read_b64_tr_b16 a[90:91], v28 offset:18528
    ds_read_b64_tr_b16 a[92:93], v28 offset:26144
    ds_read_b64_tr_b16 a[94:95], v28 offset:27232
    ds_read_b64_tr_b16 a[96:97], v29 offset:32
    ds_read_b64_tr_b16 a[98:99], v29 offset:1120
    ds_read_b64_tr_b16 a[100:101], v29 offset:8736
    ds_read_b64_tr_b16 a[102:103], v29 offset:9824
    ds_read_b64_tr_b16 a[104:105], v29 offset:17440
    ds_read_b64_tr_b16 a[106:107], v29 offset:18528
    ds_read_b64_tr_b16 a[108:109], v29 offset:26144
    ds_read_b64_tr_b16 a[110:111], v29 offset:27232
    ds_read_b64_tr_b16 a[112:113], v30 offset:32
    ds_read_b64_tr_b16 a[114:115], v30 offset:1120
    ds_read_b64_tr_b16 a[116:117], v30 offset:8736
    ds_read_b64_tr_b16 a[118:119], v30 offset:9824
    ds_read_b64_tr_b16 a[120:121], v30 offset:17440
    ds_read_b64_tr_b16 a[122:123], v30 offset:18528
    ds_read_b64_tr_b16 a[124:125], v30 offset:26144
    ds_read_b64_tr_b16 a[126:127], v30 offset:27232
    s_waitcnt lgkmcnt(0)
    s_barrier
    v_add_u32 v31, 0, v25
    global_load_dwordx4 v[32:35], v31, s[14:15]
    v_add_u32 v31, 32768, v25
    global_load_dwordx4 v[36:39], v31, s[14:15]
    v_add_u32 v31, 65536, v25
    global_load_dwordx4 v[40:43], v31, s[14:15]
    v_add_u32 v31, 98304, v25
    global_load_dwordx4 v[44:47], v31, s[14:15]
    v_add_u32 v31, 131072, v25
    global_load_dwordx4 v[48:51], v31, s[14:15]
    v_add_u32 v31, 163840, v25
    global_load_dwordx4 v[52:55], v31, s[14:15]
    v_add_u32 v31, 196608, v25
    global_load_dwordx4 v[56:59], v31, s[14:15]
    v_add_u32 v31, 229376, v25
    global_load_dwordx4 v[60:63], v31, s[14:15]
    s_waitcnt vmcnt(7)
    ds_write_b128 v26, v[32:35] offset:0
    s_waitcnt vmcnt(6)
    ds_write_b128 v26, v[36:39] offset:1088
    s_waitcnt vmcnt(5)
    ds_write_b128 v26, v[40:43] offset:2176
    s_waitcnt vmcnt(4)
    ds_write_b128 v26, v[44:47] offset:3264
    s_waitcnt vmcnt(3)
    ds_write_b128 v26, v[48:51] offset:4352
    s_waitcnt vmcnt(2)
    ds_write_b128 v26, v[52:55] offset:5440
    s_waitcnt vmcnt(1)
    ds_write_b128 v26, v[56:59] offset:6528
    s_waitcnt vmcnt(0)
    ds_write_b128 v26, v[60:63] offset:7616
    v_add_u32 v31, 262144, v25
    global_load_dwordx4 v[32:35], v31, s[14:15]
    v_add_u32 v31, 294912, v25
    global_load_dwordx4 v[36:39], v31, s[14:15]
    v_add_u32 v31, 327680, v25
    global_load_dwordx4 v[40:43], v31, s[14:15]
    v_add_u32 v31, 360448, v25
    global_load_dwordx4 v[44:47], v31, s[14:15]
    v_add_u32 v31, 393216, v25
    global_load_dwordx4 v[48:51], v31, s[14:15]
    v_add_u32 v31, 425984, v25
    global_load_dwordx4 v[52:55], v31, s[14:15]
    v_add_u32 v31, 458752, v25
    global_load_dwordx4 v[56:59], v31, s[14:15]
    v_add_u32 v31, 491520, v25
    global_load_dwordx4 v[60:63], v31, s[14:15]
    s_waitcnt vmcnt(7)
    ds_write_b128 v26, v[32:35] offset:8704
    s_waitcnt vmcnt(6)
    ds_write_b128 v26, v[36:39] offset:9792
    s_waitcnt vmcnt(5)
    ds_write_b128 v26, v[40:43] offset:10880
    s_waitcnt vmcnt(4)
    ds_write_b128 v26, v[44:47] offset:11968
    s_waitcnt vmcnt(3)
    ds_write_b128 v26, v[48:51] offset:13056
    s_waitcnt vmcnt(2)
    ds_write_b128 v26, v[52:55] offset:14144
    s_waitcnt vmcnt(1)
    ds_write_b128 v26, v[56:59] offset:15232
    s_waitcnt vmcnt(0)
    ds_write_b128 v26, v[60:63] offset:16320
    v_add_u32 v31, 524288, v25
    global_load_dwordx4 v[32:35], v31, s[14:15]
    v_add_u32 v31, 557056, v25
    global_load_dwordx4 v[36:39], v31, s[14:15]
    v_add_u32 v31, 589824, v25
    global_load_dwordx4 v[40:43], v31, s[14:15]
    v_add_u32 v31, 622592, v25
    global_load_dwordx4 v[44:47], v31, s[14:15]
    v_add_u32 v31, 655360, v25
    global_load_dwordx4 v[48:51], v31, s[14:15]
    v_add_u32 v31, 688128, v25
    global_load_dwordx4 v[52:55], v31, s[14:15]
    v_add_u32 v31, 720896, v25
    global_load_dwordx4 v[56:59], v31, s[14:15]
    v_add_u32 v31, 753664, v25
    global_load_dwordx4 v[60:63], v31, s[14:15]
    s_waitcnt vmcnt(7)
    ds_write_b128 v26, v[32:35] offset:17408
    s_waitcnt vmcnt(6)
    ds_write_b128 v26, v[36:39] offset:18496
    s_waitcnt vmcnt(5)
    ds_write_b128 v26, v[40:43] offset:19584
    s_waitcnt vmcnt(4)
    ds_write_b128 v26, v[44:47] offset:20672
    s_waitcnt vmcnt(3)
    ds_write_b128 v26, v[48:51] offset:21760
    s_waitcnt vmcnt(2)
    ds_write_b128 v26, v[52:55] offset:22848
    s_waitcnt vmcnt(1)
    ds_write_b128 v26, v[56:59] offset:23936
    s_waitcnt vmcnt(0)
    ds_write_b128 v26, v[60:63] offset:25024
    v_add_u32 v31, 786432, v25
    global_load_dwordx4 v[32:35], v31, s[14:15]
    v_add_u32 v31, 819200, v25
    global_load_dwordx4 v[36:39], v31, s[14:15]
    v_add_u32 v31, 851968, v25
    global_load_dwordx4 v[40:43], v31, s[14:15]
    v_add_u32 v31, 884736, v25
    global_load_dwordx4 v[44:47], v31, s[14:15]
    v_add_u32 v31, 917504, v25
    global_load_dwordx4 v[48:51], v31, s[14:15]
    v_add_u32 v31, 950272, v25
    global_load_dwordx4 v[52:55], v31, s[14:15]
    v_add_u32 v31, 983040, v25
    global_load_dwordx4 v[56:59], v31, s[14:15]
    v_add_u32 v31, 1015808, v25
    global_load_dwordx4 v[60:63], v31, s[14:15]
    s_waitcnt vmcnt(7)
    ds_write_b128 v26, v[32:35] offset:26112
    s_waitcnt vmcnt(6)
    ds_write_b128 v26, v[36:39] offset:27200
    s_waitcnt vmcnt(5)
    ds_write_b128 v26, v[40:43] offset:28288
    s_waitcnt vmcnt(4)
    ds_write_b128 v26, v[44:47] offset:29376
    s_waitcnt vmcnt(3)
    ds_write_b128 v26, v[48:51] offset:30464
    s_waitcnt vmcnt(2)
    ds_write_b128 v26, v[52:55] offset:31552
    s_waitcnt vmcnt(1)
    ds_write_b128 v26, v[56:59] offset:32640
    s_waitcnt vmcnt(0)
    ds_write_b128 v26, v[60:63] offset:33728
    s_waitcnt lgkmcnt(0)
    s_barrier
    ds_read_b64_tr_b16 a[128:129], v27 offset:0
    ds_read_b64_tr_b16 a[130:131], v27 offset:1088
    ds_read_b64_tr_b16 a[132:133], v27 offset:8704
    ds_read_b64_tr_b16 a[134:135], v27 offset:9792
    ds_read_b64_tr_b16 a[136:137], v27 offset:17408
    ds_read_b64_tr_b16 a[138:139], v27 offset:18496
    ds_read_b64_tr_b16 a[140:141], v27 offset:26112
    ds_read_b64_tr_b16 a[142:143], v27 offset:27200
    ds_read_b64_tr_b16 a[144:145], v28 offset:0
    ds_read_b64_tr_b16 a[146:147], v28 offset:1088
    ds_read_b64_tr_b16 a[148:149], v28 offset:8704
    ds_read_b64_tr_b16 a[150:151], v28 offset:9792
    ds_read_b64_tr_b16 a[152:153], v28 offset:17408
    ds_read_b64_tr_b16 a[154:155], v28 offset:18496
    ds_read_b64_tr_b16 a[156:157], v28 offset:26112
    ds_read_b64_tr_b16 a[158:159], v28 offset:27200
    ds_read_b64_tr_b16 a[160:161], v29 offset:0
    ds_read_b64_tr_b16 a[162:163], v29 offset:1088
    ds_read_b64_tr_b16 a[164:165], v29 offset:8704
    ds_read_b64_tr_b16 a[166:167], v29 offset:9792
    ds_read_b64_tr_b16 a[168:169], v29 offset:17408
    ds_read_b64_tr_b16 a[170:171], v29 offset:18496
    ds_read_b64_tr_b16 a[172:173], v29 offset:26112
    ds_read_b64_tr_b16 a[174:175], v29 offset:27200
    ds_read_b64_tr_b16 a[176:177], v30 offset:0
    ds_read_b64_tr_b16 a[178:179], v30 offset:1088
    ds_read_b64_tr_b16 a[180:181], v30 offset:8704
    ds_read_b64_tr_b16 a[182:183], v30 offset:9792
    ds_read_b64_tr_b16 a[184:185], v30 offset:17408
    ds_read_b64_tr_b16 a[186:187], v30 offset:18496
    ds_read_b64_tr_b16 a[188:189], v30 offset:26112
    ds_read_b64_tr_b16 a[190:191], v30 offset:27200
    ds_read_b64_tr_b16 a[192:193], v27 offset:32
    ds_read_b64_tr_b16 a[194:195], v27 offset:1120
    ds_read_b64_tr_b16 a[196:197], v27 offset:8736
    ds_read_b64_tr_b16 a[198:199], v27 offset:9824
    ds_read_b64_tr_b16 a[200:201], v27 offset:17440
    ds_read_b64_tr_b16 a[202:203], v27 offset:18528
    ds_read_b64_tr_b16 a[204:205], v27 offset:26144
    ds_read_b64_tr_b16 a[206:207], v27 offset:27232
    ds_read_b64_tr_b16 a[208:209], v28 offset:32
    ds_read_b64_tr_b16 a[210:211], v28 offset:1120
    ds_read_b64_tr_b16 a[212:213], v28 offset:8736
    ds_read_b64_tr_b16 a[214:215], v28 offset:9824
    ds_read_b64_tr_b16 a[216:217], v28 offset:17440
    ds_read_b64_tr_b16 a[218:219], v28 offset:18528
    ds_read_b64_tr_b16 a[220:221], v28 offset:26144
    ds_read_b64_tr_b16 a[222:223], v28 offset:27232
    ds_read_b64_tr_b16 a[224:225], v29 offset:32
    ds_read_b64_tr_b16 a[226:227], v29 offset:1120
    ds_read_b64_tr_b16 a[228:229], v29 offset:8736
    ds_read_b64_tr_b16 a[230:231], v29 offset:9824
    ds_read_b64_tr_b16 a[232:233], v29 offset:17440
    ds_read_b64_tr_b16 a[234:235], v29 offset:18528
    ds_read_b64_tr_b16 a[236:237], v29 offset:26144
    ds_read_b64_tr_b16 a[238:239], v29 offset:27232
    ds_read_b64_tr_b16 a[240:241], v30 offset:32
    ds_read_b64_tr_b16 a[242:243], v30 offset:1120
    ds_read_b64_tr_b16 a[244:245], v30 offset:8736
    ds_read_b64_tr_b16 a[246:247], v30 offset:9824
    ds_read_b64_tr_b16 a[248:249], v30 offset:17440
    ds_read_b64_tr_b16 a[250:251], v30 offset:18528
    ds_read_b64_tr_b16 a[252:253], v30 offset:26144
    ds_read_b64_tr_b16 a[254:255], v30 offset:27232
    s_waitcnt lgkmcnt(0)
    s_barrier
    v_add_u32 v31, 0, v25
    global_load_dwordx4 v[32:35], v31, s[16:17]
    v_add_u32 v31, 32768, v25
    global_load_dwordx4 v[36:39], v31, s[16:17]
    v_add_u32 v31, 65536, v25
    global_load_dwordx4 v[40:43], v31, s[16:17]
    v_add_u32 v31, 98304, v25
    global_load_dwordx4 v[44:47], v31, s[16:17]
    v_add_u32 v31, 131072, v25
    global_load_dwordx4 v[48:51], v31, s[16:17]
    v_add_u32 v31, 163840, v25
    global_load_dwordx4 v[52:55], v31, s[16:17]
    v_add_u32 v31, 196608, v25
    global_load_dwordx4 v[56:59], v31, s[16:17]
    v_add_u32 v31, 229376, v25
    global_load_dwordx4 v[60:63], v31, s[16:17]
    s_waitcnt vmcnt(7)
    ds_write_b128 v26, v[32:35] offset:0
    s_waitcnt vmcnt(6)
    ds_write_b128 v26, v[36:39] offset:1088
    s_waitcnt vmcnt(5)
    ds_write_b128 v26, v[40:43] offset:2176
    s_waitcnt vmcnt(4)
    ds_write_b128 v26, v[44:47] offset:3264
    s_waitcnt vmcnt(3)
    ds_write_b128 v26, v[48:51] offset:4352
    s_waitcnt vmcnt(2)
    ds_write_b128 v26, v[52:55] offset:5440
    s_waitcnt vmcnt(1)
    ds_write_b128 v26, v[56:59] offset:6528
    s_waitcnt vmcnt(0)
    ds_write_b128 v26, v[60:63] offset:7616
    v_add_u32 v31, 262144, v25
    global_load_dwordx4 v[32:35], v31, s[16:17]
    v_add_u32 v31, 294912, v25
    global_load_dwordx4 v[36:39], v31, s[16:17]
    v_add_u32 v31, 327680, v25
    global_load_dwordx4 v[40:43], v31, s[16:17]
    v_add_u32 v31, 360448, v25
    global_load_dwordx4 v[44:47], v31, s[16:17]
    v_add_u32 v31, 393216, v25
    global_load_dwordx4 v[48:51], v31, s[16:17]
    v_add_u32 v31, 425984, v25
    global_load_dwordx4 v[52:55], v31, s[16:17]
    v_add_u32 v31, 458752, v25
    global_load_dwordx4 v[56:59], v31, s[16:17]
    v_add_u32 v31, 491520, v25
    global_load_dwordx4 v[60:63], v31, s[16:17]
    s_waitcnt vmcnt(7)
    ds_write_b128 v26, v[32:35] offset:8704
    s_waitcnt vmcnt(6)
    ds_write_b128 v26, v[36:39] offset:9792
    s_waitcnt vmcnt(5)
    ds_write_b128 v26, v[40:43] offset:10880
    s_waitcnt vmcnt(4)
    ds_write_b128 v26, v[44:47] offset:11968
    s_waitcnt vmcnt(3)
    ds_write_b128 v26, v[48:51] offset:13056
    s_waitcnt vmcnt(2)
    ds_write_b128 v26, v[52:55] offset:14144
    s_waitcnt vmcnt(1)
    ds_write_b128 v26, v[56:59] offset:15232
    s_waitcnt vmcnt(0)
    ds_write_b128 v26, v[60:63] offset:16320
    v_add_u32 v31, 524288, v25
    global_load_dwordx4 v[32:35], v31, s[16:17]
    v_add_u32 v31, 557056, v25
    global_load_dwordx4 v[36:39], v31, s[16:17]
    v_add_u32 v31, 589824, v25
    global_load_dwordx4 v[40:43], v31, s[16:17]
    v_add_u32 v31, 622592, v25
    global_load_dwordx4 v[44:47], v31, s[16:17]
    v_add_u32 v31, 655360, v25
    global_load_dwordx4 v[48:51], v31, s[16:17]
    v_add_u32 v31, 688128, v25
    global_load_dwordx4 v[52:55], v31, s[16:17]
    v_add_u32 v31, 720896, v25
    global_load_dwordx4 v[56:59], v31, s[16:17]
    v_add_u32 v31, 753664, v25
    global_load_dwordx4 v[60:63], v31, s[16:17]
    s_waitcnt vmcnt(7)
    ds_write_b128 v26, v[32:35] offset:17408
    s_waitcnt vmcnt(6)
    ds_write_b128 v26, v[36:39] offset:18496
    s_waitcnt vmcnt(5)
    ds_write_b128 v26, v[40:43] offset:19584
    s_waitcnt vmcnt(4)
    ds_write_b128 v26, v[44:47] offset:20672
    s_waitcnt vmcnt(3)
    ds_write_b128 v26, v[48:51] offset:21760
    s_waitcnt vmcnt(2)
    ds_write_b128 v26, v[52:55] offset:22848
    s_waitcnt vmcnt(1)
    ds_write_b128 v26, v[56:59] offset:23936
    s_waitcnt vmcnt(0)
    ds_write_b128 v26, v[60:63] offset:25024
    v_add_u32 v31, 786432, v25
    global_load_dwordx4 v[32:35], v31, s[16:17]
    v_add_u32 v31, 819200, v25
    global_load_dwordx4 v[36:39], v31, s[16:17]
    v_add_u32 v31, 851968, v25
    global_load_dwordx4 v[40:43], v31, s[16:17]
    v_add_u32 v31, 884736, v25
    global_load_dwordx4 v[44:47], v31, s[16:17]
    v_add_u32 v31, 917504, v25
    global_load_dwordx4 v[48:51], v31, s[16:17]
    v_add_u32 v31, 950272, v25
    global_load_dwordx4 v[52:55], v31, s[16:17]
    v_add_u32 v31, 983040, v25
    global_load_dwordx4 v[56:59], v31, s[16:17]
    v_add_u32 v31, 1015808, v25
    global_load_dwordx4 v[60:63], v31, s[16:17]
    s_waitcnt vmcnt(7)
    ds_write_b128 v26, v[32:35] offset:26112
    s_waitcnt vmcnt(6)
    ds_write_b128 v26, v[36:39] offset:27200
    s_waitcnt vmcnt(5)
    ds_write_b128 v26, v[40:43] offset:28288
    s_waitcnt vmcnt(4)
    ds_write_b128 v26, v[44:47] offset:29376
    s_waitcnt vmcnt(3)
    ds_write_b128 v26, v[48:51] offset:30464
    s_waitcnt vmcnt(2)
    ds_write_b128 v26, v[52:55] offset:31552
    s_waitcnt vmcnt(1)
    ds_write_b128 v26, v[56:59] offset:32640
    s_waitcnt vmcnt(0)
    ds_write_b128 v26, v[60:63] offset:33728
    s_waitcnt lgkmcnt(0)
    s_barrier
    ds_read_b64_tr_b16 v[128:129], v27 offset:0
    ds_read_b64_tr_b16 v[130:131], v27 offset:1088
    ds_read_b64_tr_b16 v[132:133], v27 offset:8704
    ds_read_b64_tr_b16 v[134:135], v27 offset:9792
    ds_read_b64_tr_b16 v[136:137], v27 offset:17408
    ds_read_b64_tr_b16 v[138:139], v27 offset:18496
    ds_read_b64_tr_b16 v[140:141], v27 offset:26112
    ds_read_b64_tr_b16 v[142:143], v27 offset:27200
    ds_read_b64_tr_b16 v[144:145], v28 offset:0
    ds_read_b64_tr_b16 v[146:147], v28 offset:1088
    ds_read_b64_tr_b16 v[148:149], v28 offset:8704
    ds_read_b64_tr_b16 v[150:151], v28 offset:9792
    ds_read_b64_tr_b16 v[152:153], v28 offset:17408
    ds_read_b64_tr_b16 v[154:155], v28 offset:18496
    ds_read_b64_tr_b16 v[156:157], v28 offset:26112
    ds_read_b64_tr_b16 v[158:159], v28 offset:27200
    ds_read_b64_tr_b16 v[160:161], v29 offset:0
    ds_read_b64_tr_b16 v[162:163], v29 offset:1088
    ds_read_b64_tr_b16 v[164:165], v29 offset:8704
    ds_read_b64_tr_b16 v[166:167], v29 offset:9792
    ds_read_b64_tr_b16 v[168:169], v29 offset:17408
    ds_read_b64_tr_b16 v[170:171], v29 offset:18496
    ds_read_b64_tr_b16 v[172:173], v29 offset:26112
    ds_read_b64_tr_b16 v[174:175], v29 offset:27200
    ds_read_b64_tr_b16 v[176:177], v30 offset:0
    ds_read_b64_tr_b16 v[178:179], v30 offset:1088
    ds_read_b64_tr_b16 v[180:181], v30 offset:8704
    ds_read_b64_tr_b16 v[182:183], v30 offset:9792
    ds_read_b64_tr_b16 v[184:185], v30 offset:17408
    ds_read_b64_tr_b16 v[186:187], v30 offset:18496
    ds_read_b64_tr_b16 v[188:189], v30 offset:26112
    ds_read_b64_tr_b16 v[190:191], v30 offset:27200
    ds_read_b64_tr_b16 v[192:193], v27 offset:32
    ds_read_b64_tr_b16 v[194:195], v27 offset:1120
    ds_read_b64_tr_b16 v[196:197], v27 offset:8736
    ds_read_b64_tr_b16 v[198:199], v27 offset:9824
    ds_read_b64_tr_b16 v[200:201], v27 offset:17440
    ds_read_b64_tr_b16 v[202:203], v27 offset:18528
    ds_read_b64_tr_b16 v[204:205], v27 offset:26144
    ds_read_b64_tr_b16 v[206:207], v27 offset:27232
    ds_read_b64_tr_b16 v[208:209], v28 offset:32
    ds_read_b64_tr_b16 v[210:211], v28 offset:1120
    ds_read_b64_tr_b16 v[212:213], v28 offset:8736
    ds_read_b64_tr_b16 v[214:215], v28 offset:9824
    ds_read_b64_tr_b16 v[216:217], v28 offset:17440
    ds_read_b64_tr_b16 v[218:219], v28 offset:18528
    ds_read_b64_tr_b16 v[220:221], v28 offset:26144
    ds_read_b64_tr_b16 v[222:223], v28 offset:27232
    ds_read_b64_tr_b16 v[224:225], v29 offset:32
    ds_read_b64_tr_b16 v[226:227], v29 offset:1120
    ds_read_b64_tr_b16 v[228:229], v29 offset:8736
    ds_read_b64_tr_b16 v[230:231], v29 offset:9824
    ds_read_b64_tr_b16 v[232:233], v29 offset:17440
    ds_read_b64_tr_b16 v[234:235], v29 offset:18528
    ds_read_b64_tr_b16 v[236:237], v29 offset:26144
    ds_read_b64_tr_b16 v[238:239], v29 offset:27232
    ds_read_b64_tr_b16 v[240:241], v30 offset:32
    ds_read_b64_tr_b16 v[242:243], v30 offset:1120
    ds_read_b64_tr_b16 v[244:245], v30 offset:8736
    ds_read_b64_tr_b16 v[246:247], v30 offset:9824
    ds_read_b64_tr_b16 v[248:249], v30 offset:17440
    ds_read_b64_tr_b16 v[250:251], v30 offset:18528
    ds_read_b64_tr_b16 v[252:253], v30 offset:26144
    ds_read_b64_tr_b16 v[254:255], v30 offset:27232
    s_waitcnt lgkmcnt(0)
    s_barrier
    v_add_u32 v124, 0, v2
    v_xor_b32 v124, v124, v1
    v_lshlrev_b32 v124, 4, v124
    v_lshl_add_u32 v124, v1, 10, v124
    v_add_u32 v3, 0, v124
    v_add_u32 v124, 4, v2
    v_xor_b32 v124, v124, v1
    v_lshlrev_b32 v124, 4, v124
    v_lshl_add_u32 v124, v1, 10, v124
    v_add_u32 v4, 0, v124
    v_add_u32 v124, 8, v2
    v_xor_b32 v124, v124, v1
    v_lshlrev_b32 v124, 4, v124
    v_lshl_add_u32 v124, v1, 10, v124
    v_add_u32 v5, 0, v124
    v_add_u32 v124, 12, v2
    v_xor_b32 v124, v124, v1
    v_lshlrev_b32 v124, 4, v124
    v_lshl_add_u32 v124, v1, 10, v124
    v_add_u32 v6, 0, v124
    v_mov_b32 v124, 32
    s_mov_b32 s90, 0
    s_nop 0
Lpoll_16:
    global_load_dword v125, v124, s[10:11] sc1
    s_waitcnt vmcnt(0)
    s_movk_i32 s23, 0x100
    v_cmp_gt_u32 s[40:41], s23, v125
    s_cmp_eq_u64 s[40:41], 0
    s_cbranch_scc1 Lpd_17
    s_add_u32 s90, s90, 1
    s_cmp_lt_u32 s90, 400000
    s_nop 0
    s_cbranch_scc1 Lpoll_16
    v_mov_b32 v126, 108
    v_mov_b32 v127, 267
    global_store_dword v126, v127, s[10:11]
    s_waitcnt vmcnt(0)
    s_endpgm
Lpd_17:
    s_getpc_b64 s[54:55]
LpcLtab_A:
    s_add_u32 s54, s54, Ltab_A - LpcLtab_A
    s_addc_u32 s55, s55, 0
    s_sub_u32 s23, s22, 1
    s_mul_i32 s23, s23, 256
    s_add_u32 s54, s54, s23
    s_addc_u32 s55, s55, 0
    s_mov_b32 s30, 0
    s_mul_i32 s53, s21, 24576
    s_lshl_b32 s23, s20, 10
    s_add_u32 s53, s53, s23
    s_add_u32 s53, s53, 50331648
    s_lshl_b32 s52, s21, 2
    s_add_u32 s52, s52, s20
LA_item:
    s_lshl_b32 s23, s30, 2
    s_load_dword s31, s[54:55], s23
    s_waitcnt lgkmcnt(0)
    s_cmp_ge_u32 s31, 64
    s_cbranch_scc1 LA_done
    s_and_b32 s32, s31, 31
    s_lshl_b32 s33, s32, 16
    s_lshl_b32 s31, s31, 1
    s_cmp_ge_u32 s31, 64
    s_cbranch_scc1 LA_l2
    v_lshrrev_b32 v24, 3, v0
    s_lshl_b32 s23, s20, 3
    v_add_u32 v24, s23, v24
    v_and_b32 v25, 7, v0
    v_lshlrev_b32 v26, 10, v24
    v_lshl_add_u32 v26, v25, 4, v26
    v_add_u32 v26, s33, v26
    v_add_u32 v27, 32768, v26
    global_load_dwordx4 v[92:95], v26, s[6:7] offset:0 sc1
    global_load_dwordx4 v[96:99], v26, s[6:7] offset:128 sc1
    global_load_dwordx4 v[100:103], v26, s[6:7] offset:256 sc1
    global_load_dwordx4 v[104:107], v26, s[6:7] offset:384 sc1
    global_load_dwordx4 v[108:111], v26, s[6:7] offset:512 sc1
    global_load_dwordx4 v[112:115], v26, s[6:7] offset:640 sc1
    global_load_dwordx4 v[116:119], v26, s[6:7] offset:768 sc1
    global_load_dwordx4 v[120:123], v26, s[6:7] offset:896 sc1
    global_load_dwordx4 v[28:31], v27, s[6:7] offset:0 sc1
    global_load_dwordx4 v[32:35], v27, s[6:7] offset:128 sc1
    global_load_dwordx4 v[36:39], v27, s[6:7] offset:256 sc1
    global_load_dwordx4 v[40:43], v27, s[6:7] offset:384 sc1
    global_load_dwordx4 v[44:47], v27, s[6:7] offset:512 sc1
    global_load_dwordx4 v[48:51], v27, s[6:7] offset:640 sc1
    global_load_dwordx4 v[52:55], v27, s[6:7] offset:768 sc1
    global_load_dwordx4 v[56:59], v27, s[6:7] offset:896 sc1
    v_and_b32 v27, 7, v24
    v_xor_b32 v27, v27, v25
    v_lshlrev_b32 v27, 4, v27
    v_lshl_add_u32 v27, v24, 10, v27
    v_bfe_u32 v25, v24, 3, 1
    v_lshl_add_u32 v27, v25, 7, v27
    v_add_u32 v27, 0, v27
    v_xor_b32 v25, 128, v27
    s_waitcnt vmcnt(15)
    v_lshlrev_b32 v60, 16, v92
    v_and_b32 v61, 0xffff0000, v92
    v_lshlrev_b32 v62, 16, v93
    v_and_b32 v63, 0xffff0000, v93
    v_lshlrev_b32 v64, 16, v94
    v_and_b32 v65, 0xffff0000, v94
    v_lshlrev_b32 v66, 16, v95
    v_and_b32 v67, 0xffff0000, v95
    s_waitcnt vmcnt(14)
    v_lshlrev_b32 v68, 16, v96
    v_and_b32 v69, 0xffff0000, v96
    v_lshlrev_b32 v70, 16, v97
    v_and_b32 v71, 0xffff0000, v97
    v_lshlrev_b32 v72, 16, v98
    v_and_b32 v73, 0xffff0000, v98
    v_lshlrev_b32 v74, 16, v99
    v_and_b32 v75, 0xffff0000, v99
    s_waitcnt vmcnt(13)
    v_lshlrev_b32 v76, 16, v100
    v_and_b32 v77, 0xffff0000, v100
    v_lshlrev_b32 v78, 16, v101
    v_and_b32 v79, 0xffff0000, v101
    v_lshlrev_b32 v80, 16, v102
    v_and_b32 v81, 0xffff0000, v102
    v_lshlrev_b32 v82, 16, v103
    v_and_b32 v83, 0xffff0000, v103
    s_waitcnt vmcnt(12)
    v_lshlrev_b32 v84, 16, v104
    v_and_b32 v85, 0xffff0000, v104
    v_lshlrev_b32 v86, 16, v105
    v_and_b32 v87, 0xffff0000, v105
    v_lshlrev_b32 v88, 16, v106
    v_and_b32 v89, 0xffff0000, v106
    v_lshlrev_b32 v90, 16, v107
    v_and_b32 v91, 0xffff0000, v107
    s_waitcnt vmcnt(11)
    v_lshlrev_b32 v92, 16, v108
    v_and_b32 v93, 0xffff0000, v108
    v_lshlrev_b32 v94, 16, v109
    v_and_b32 v95, 0xffff0000, v109
    v_lshlrev_b32 v96, 16, v110
    v_and_b32 v97, 0xffff0000, v110
    v_lshlrev_b32 v98, 16, v111
    v_and_b32 v99, 0xffff0000, v111
    s_waitcnt vmcnt(10)
    v_lshlrev_b32 v100, 16, v112
    v_and_b32 v101, 0xffff0000, v112
    v_lshlrev_b32 v102, 16, v113
    v_and_b32 v103, 0xffff0000, v113
    v_lshlrev_b32 v104, 16, v114
    v_and_b32 v105, 0xffff0000, v114
    v_lshlrev_b32 v106, 16, v115
    v_and_b32 v107, 0xffff0000, v115
    s_waitcnt vmcnt(9)
    v_lshlrev_b32 v108, 16, v116
    v_and_b32 v109, 0xffff0000, v116
    v_lshlrev_b32 v110, 16, v117
    v_and_b32 v111, 0xffff0000, v117
    v_lshlrev_b32 v112, 16, v118
    v_and_b32 v113, 0xffff0000, v118
    v_lshlrev_b32 v114, 16, v119
    v_and_b32 v115, 0xffff0000, v119
    s_waitcnt vmcnt(8)
    v_lshlrev_b32 v116, 16, v120
    v_and_b32 v117, 0xffff0000, v120
    v_lshlrev_b32 v118, 16, v121
    v_and_b32 v119, 0xffff0000, v121
    v_lshlrev_b32 v120, 16, v122
    v_and_b32 v121, 0xffff0000, v122
    v_lshlrev_b32 v122, 16, v123
    v_and_b32 v123, 0xffff0000, v123
    v_pk_add_f32 v[124:125], v[60:61], v[62:63]
    v_pk_add_f32 v[124:125], v[124:125], v[64:65]
    v_pk_add_f32 v[124:125], v[124:125], v[66:67]
    v_pk_add_f32 v[124:125], v[124:125], v[68:69]
    v_pk_add_f32 v[124:125], v[124:125], v[70:71]
    v_pk_add_f32 v[124:125], v[124:125], v[72:73]
    v_pk_add_f32 v[124:125], v[124:125], v[74:75]
    v_pk_add_f32 v[124:125], v[124:125], v[76:77]
    v_pk_add_f32 v[124:125], v[124:125], v[78:79]
    v_pk_add_f32 v[124:125], v[124:125], v[80:81]
    v_pk_add_f32 v[124:125], v[124:125], v[82:83]
    v_pk_add_f32 v[124:125], v[124:125], v[84:85]
    v_pk_add_f32 v[124:125], v[124:125], v[86:87]
    v_pk_add_f32 v[124:125], v[124:125], v[88:89]
    v_pk_add_f32 v[124:125], v[124:125], v[90:91]
    v_pk_add_f32 v[124:125], v[124:125], v[92:93]
    v_pk_add_f32 v[124:125], v[124:125], v[94:95]
    v_pk_add_f32 v[124:125], v[124:125], v[96:97]
    v_pk_add_f32 v[124:125], v[124:125], v[98:99]
    v_pk_add_f32 v[124:125], v[124:125], v[100:101]
    v_pk_add_f32 v[124:125], v[124:125], v[102:103]
    v_pk_add_f32 v[124:125], v[124:125], v[104:105]
    v_pk_add_f32 v[124:125], v[124:125], v[106:107]
    v_pk_add_f32 v[124:125], v[124:125], v[108:109]
    v_pk_add_f32 v[124:125], v[124:125], v[110:111]
    v_pk_add_f32 v[124:125], v[124:125], v[112:113]
    v_pk_add_f32 v[124:125], v[124:125], v[114:115]
    v_pk_add_f32 v[124:125], v[124:125], v[116:117]
    v_pk_add_f32 v[124:125], v[124:125], v[118:119]
    v_pk_add_f32 v[124:125], v[124:125], v[120:121]
    v_pk_add_f32 v[124:125], v[124:125], v[122:123]
    v_add_f32 v124, v124, v125
    s_nop 1
    v_add_f32_dpp v124, v124, v124 quad_perm:[1,0,3,2] row_mask:0xf bank_mask:0xf
    s_nop 1
    v_add_f32_dpp v124, v124, v124 quad_perm:[2,3,0,1] row_mask:0xf bank_mask:0xf
    s_nop 1
    v_add_f32_dpp v124, v124, v124 row_half_mirror row_mask:0xf bank_mask:0xf
    v_mul_f32 v124, 0xbb000000, v124
    v_mov_b32 v125, v124
    v_pk_add_f32 v[60:61], v[60:61], v[124:125]
    v_pk_add_f32 v[62:63], v[62:63], v[124:125]
    v_pk_add_f32 v[64:65], v[64:65], v[124:125]
    v_pk_add_f32 v[66:67], v[66:67], v[124:125]
    v_pk_add_f32 v[68:69], v[68:69], v[124:125]
    v_pk_add_f32 v[70:71], v[70:71], v[124:125]
    v_pk_add_f32 v[72:73], v[72:73], v[124:125]
    v_pk_add_f32 v[74:75], v[74:75], v[124:125]
    v_pk_add_f32 v[76:77], v[76:77], v[124:125]
    v_pk_add_f32 v[78:79], v[78:79], v[124:125]
    v_pk_add_f32 v[80:81], v[80:81], v[124:125]
    v_pk_add_f32 v[82:83], v[82:83], v[124:125]
    v_pk_add_f32 v[84:85], v[84:85], v[124:125]
    v_pk_add_f32 v[86:87], v[86:87], v[124:125]
    v_pk_add_f32 v[88:89], v[88:89], v[124:125]
    v_pk_add_f32 v[90:91], v[90:91], v[124:125]
    v_pk_add_f32 v[92:93], v[92:93], v[124:125]
    v_pk_add_f32 v[94:95], v[94:95], v[124:125]
    v_pk_add_f32 v[96:97], v[96:97], v[124:125]
    v_pk_add_f32 v[98:99], v[98:99], v[124:125]
    v_pk_add_f32 v[100:101], v[100:101], v[124:125]
    v_pk_add_f32 v[102:103], v[102:103], v[124:125]
    v_pk_add_f32 v[104:105], v[104:105], v[124:125]
    v_pk_add_f32 v[106:107], v[106:107], v[124:125]
    v_pk_add_f32 v[108:109], v[108:109], v[124:125]
    v_pk_add_f32 v[110:111], v[110:111], v[124:125]
    v_pk_add_f32 v[112:113], v[112:113], v[124:125]
    v_pk_add_f32 v[114:115], v[114:115], v[124:125]
    v_pk_add_f32 v[116:117], v[116:117], v[124:125]
    v_pk_add_f32 v[118:119], v[118:119], v[124:125]
    v_pk_add_f32 v[120:121], v[120:121], v[124:125]
    v_pk_add_f32 v[122:123], v[122:123], v[124:125]
    v_pk_mul_f32 v[124:125], v[60:61], v[60:61]
    v_pk_fma_f32 v[124:125], v[62:63], v[62:63], v[124:125]
    v_pk_fma_f32 v[124:125], v[64:65], v[64:65], v[124:125]
    v_pk_fma_f32 v[124:125], v[66:67], v[66:67], v[124:125]
    v_pk_fma_f32 v[124:125], v[68:69], v[68:69], v[124:125]
    v_pk_fma_f32 v[124:125], v[70:71], v[70:71], v[124:125]
    v_pk_fma_f32 v[124:125], v[72:73], v[72:73], v[124:125]
    v_pk_fma_f32 v[124:125], v[74:75], v[74:75], v[124:125]
    v_pk_fma_f32 v[124:125], v[76:77], v[76:77], v[124:125]
    v_pk_fma_f32 v[124:125], v[78:79], v[78:79], v[124:125]
    v_pk_fma_f32 v[124:125], v[80:81], v[80:81], v[124:125]
    v_pk_fma_f32 v[124:125], v[82:83], v[82:83], v[124:125]
    v_pk_fma_f32 v[124:125], v[84:85], v[84:85], v[124:125]
    v_pk_fma_f32 v[124:125], v[86:87], v[86:87], v[124:125]
    v_pk_fma_f32 v[124:125], v[88:89], v[88:89], v[124:125]
    v_pk_fma_f32 v[124:125], v[90:91], v[90:91], v[124:125]
    v_pk_fma_f32 v[124:125], v[92:93], v[92:93], v[124:125]
    v_pk_fma_f32 v[124:125], v[94:95], v[94:95], v[124:125]
    v_pk_fma_f32 v[124:125], v[96:97], v[96:97], v[124:125]
    v_pk_fma_f32 v[124:125], v[98:99], v[98:99], v[124:125]
    v_pk_fma_f32 v[124:125], v[100:101], v[100:101], v[124:125]
    v_pk_fma_f32 v[124:125], v[102:103], v[102:103], v[124:125]
    v_pk_fma_f32 v[124:125], v[104:105], v[104:105], v[124:125]
    v_pk_fma_f32 v[124:125], v[106:107], v[106:107], v[124:125]
    v_pk_fma_f32 v[124:125], v[108:109], v[108:109], v[124:125]
    v_pk_fma_f32 v[124:125], v[110:111], v[110:111], v[124:125]
    v_pk_fma_f32 v[124:125], v[112:113], v[112:113], v[124:125]
    v_pk_fma_f32 v[124:125], v[114:115], v[114:115], v[124:125]
    v_pk_fma_f32 v[124:125], v[116:117], v[116:117], v[124:125]
    v_pk_fma_f32 v[124:125], v[118:119], v[118:119], v[124:125]
    v_pk_fma_f32 v[124:125], v[120:121], v[120:121], v[124:125]
    v_pk_fma_f32 v[124:125], v[122:123], v[122:123], v[124:125]
    v_add_f32 v124, v124, v125
    s_nop 1
    v_add_f32_dpp v124, v124, v124 quad_perm:[1,0,3,2] row_mask:0xf bank_mask:0xf
    s_nop 1
    v_add_f32_dpp v124, v124, v124 quad_perm:[2,3,0,1] row_mask:0xf bank_mask:0xf
    s_nop 1
    v_add_f32_dpp v124, v124, v124 row_half_mirror row_mask:0xf bank_mask:0xf
    v_mov_b32 v125, 0x3727c5ac
    v_fmac_f32 v125, 0x3b000000, v124
    v_rsq_f32 v124, v125
    s_nop 0
    v_mov_b32 v125, v124
    v_pk_mul_f32 v[60:61], v[60:61], v[124:125]
    v_cvt_pk_bf16_f32 v60, v60, v61
    v_pk_mul_f32 v[62:63], v[62:63], v[124:125]
    v_cvt_pk_bf16_f32 v61, v62, v63
    v_pk_mul_f32 v[64:65], v[64:65], v[124:125]
    v_cvt_pk_bf16_f32 v62, v64, v65
    v_pk_mul_f32 v[66:67], v[66:67], v[124:125]
    v_cvt_pk_bf16_f32 v63, v66, v67
    ds_write_b128 v27, v[60:63] offset:0
    v_pk_mul_f32 v[68:69], v[68:69], v[124:125]
    v_cvt_pk_bf16_f32 v64, v68, v69
    v_pk_mul_f32 v[70:71], v[70:71], v[124:125]
    v_cvt_pk_bf16_f32 v65, v70, v71
    v_pk_mul_f32 v[72:73], v[72:73], v[124:125]
    v_cvt_pk_bf16_f32 v66, v72, v73
    v_pk_mul_f32 v[74:75], v[74:75], v[124:125]
    v_cvt_pk_bf16_f32 v67, v74, v75
    ds_write_b128 v25, v[64:67] offset:0
    v_pk_mul_f32 v[76:77], v[76:77], v[124:125]
    v_cvt_pk_bf16_f32 v68, v76, v77
    v_pk_mul_f32 v[78:79], v[78:79], v[124:125]
    v_cvt_pk_bf16_f32 v69, v78, v79
    v_pk_mul_f32 v[80:81], v[80:81], v[124:125]
    v_cvt_pk_bf16_f32 v70, v80, v81
    v_pk_mul_f32 v[82:83], v[82:83], v[124:125]
    v_cvt_pk_bf16_f32 v71, v82, v83
    ds_write_b128 v27, v[68:71] offset:256
    v_pk_mul_f32 v[84:85], v[84:85], v[124:125]
    v_cvt_pk_bf16_f32 v72, v84, v85
    v_pk_mul_f32 v[86:87], v[86:87], v[124:125]
    v_cvt_pk_bf16_f32 v73, v86, v87
    v_pk_mul_f32 v[88:89], v[88:89], v[124:125]
    v_cvt_pk_bf16_f32 v74, v88, v89
    v_pk_mul_f32 v[90:91], v[90:91], v[124:125]
    v_cvt_pk_bf16_f32 v75, v90, v91
    ds_write_b128 v25, v[72:75] offset:256
    v_pk_mul_f32 v[92:93], v[92:93], v[124:125]
    v_cvt_pk_bf16_f32 v76, v92, v93
    v_pk_mul_f32 v[94:95], v[94:95], v[124:125]
    v_cvt_pk_bf16_f32 v77, v94, v95
    v_pk_mul_f32 v[96:97], v[96:97], v[124:125]
    v_cvt_pk_bf16_f32 v78, v96, v97
    v_pk_mul_f32 v[98:99], v[98:99], v[124:125]
    v_cvt_pk_bf16_f32 v79, v98, v99
    ds_write_b128 v27, v[76:79] offset:512
    v_pk_mul_f32 v[100:101], v[100:101], v[124:125]
    v_cvt_pk_bf16_f32 v80, v100, v101
    v_pk_mul_f32 v[102:103], v[102:103], v[124:125]
    v_cvt_pk_bf16_f32 v81, v102, v103
    v_pk_mul_f32 v[104:105], v[104:105], v[124:125]
    v_cvt_pk_bf16_f32 v82, v104, v105
    v_pk_mul_f32 v[106:107], v[106:107], v[124:125]
    v_cvt_pk_bf16_f32 v83, v106, v107
    ds_write_b128 v25, v[80:83] offset:512
    v_pk_mul_f32 v[108:109], v[108:109], v[124:125]
    v_cvt_pk_bf16_f32 v84, v108, v109
    v_pk_mul_f32 v[110:111], v[110:111], v[124:125]
    v_cvt_pk_bf16_f32 v85, v110, v111
    v_pk_mul_f32 v[112:113], v[112:113], v[124:125]
    v_cvt_pk_bf16_f32 v86, v112, v113
    v_pk_mul_f32 v[114:115], v[114:115], v[124:125]
    v_cvt_pk_bf16_f32 v87, v114, v115
    ds_write_b128 v27, v[84:87] offset:768
    v_pk_mul_f32 v[116:117], v[116:117], v[124:125]
    v_cvt_pk_bf16_f32 v88, v116, v117
    v_pk_mul_f32 v[118:119], v[118:119], v[124:125]
    v_cvt_pk_bf16_f32 v89, v118, v119
    v_pk_mul_f32 v[120:121], v[120:121], v[124:125]
    v_cvt_pk_bf16_f32 v90, v120, v121
    v_pk_mul_f32 v[122:123], v[122:123], v[124:125]
    v_cvt_pk_bf16_f32 v91, v122, v123
    ds_write_b128 v25, v[88:91] offset:768
    s_waitcnt vmcnt(7)
    v_lshlrev_b32 v60, 16, v28
    v_and_b32 v61, 0xffff0000, v28
    v_lshlrev_b32 v62, 16, v29
    v_and_b32 v63, 0xffff0000, v29
    v_lshlrev_b32 v64, 16, v30
    v_and_b32 v65, 0xffff0000, v30
    v_lshlrev_b32 v66, 16, v31
    v_and_b32 v67, 0xffff0000, v31
    s_waitcnt vmcnt(6)
    v_lshlrev_b32 v68, 16, v32
    v_and_b32 v69, 0xffff0000, v32
    v_lshlrev_b32 v70, 16, v33
    v_and_b32 v71, 0xffff0000, v33
    v_lshlrev_b32 v72, 16, v34
    v_and_b32 v73, 0xffff0000, v34
    v_lshlrev_b32 v74, 16, v35
    v_and_b32 v75, 0xffff0000, v35
    s_waitcnt vmcnt(5)
    v_lshlrev_b32 v76, 16, v36
    v_and_b32 v77, 0xffff0000, v36
    v_lshlrev_b32 v78, 16, v37
    v_and_b32 v79, 0xffff0000, v37
    v_lshlrev_b32 v80, 16, v38
    v_and_b32 v81, 0xffff0000, v38
    v_lshlrev_b32 v82, 16, v39
    v_and_b32 v83, 0xffff0000, v39
    s_waitcnt vmcnt(4)
    v_lshlrev_b32 v84, 16, v40
    v_and_b32 v85, 0xffff0000, v40
    v_lshlrev_b32 v86, 16, v41
    v_and_b32 v87, 0xffff0000, v41
    v_lshlrev_b32 v88, 16, v42
    v_and_b32 v89, 0xffff0000, v42
    v_lshlrev_b32 v90, 16, v43
    v_and_b32 v91, 0xffff0000, v43
    s_waitcnt vmcnt(3)
    v_lshlrev_b32 v92, 16, v44
    v_and_b32 v93, 0xffff0000, v44
    v_lshlrev_b32 v94, 16, v45
    v_and_b32 v95, 0xffff0000, v45
    v_lshlrev_b32 v96, 16, v46
    v_and_b32 v97, 0xffff0000, v46
    v_lshlrev_b32 v98, 16, v47
    v_and_b32 v99, 0xffff0000, v47
    s_waitcnt vmcnt(2)
    v_lshlrev_b32 v100, 16, v48
    v_and_b32 v101, 0xffff0000, v48
    v_lshlrev_b32 v102, 16, v49
    v_and_b32 v103, 0xffff0000, v49
    v_lshlrev_b32 v104, 16, v50
    v_and_b32 v105, 0xffff0000, v50
    v_lshlrev_b32 v106, 16, v51
    v_and_b32 v107, 0xffff0000, v51
    s_waitcnt vmcnt(1)
    v_lshlrev_b32 v108, 16, v52
    v_and_b32 v109, 0xffff0000, v52
    v_lshlrev_b32 v110, 16, v53
    v_and_b32 v111, 0xffff0000, v53
    v_lshlrev_b32 v112, 16, v54
    v_and_b32 v113, 0xffff0000, v54
    v_lshlrev_b32 v114, 16, v55
    v_and_b32 v115, 0xffff0000, v55
    s_waitcnt vmcnt(0)
    v_lshlrev_b32 v116, 16, v56
    v_and_b32 v117, 0xffff0000, v56
    v_lshlrev_b32 v118, 16, v57
    v_and_b32 v119, 0xffff0000, v57
    v_lshlrev_b32 v120, 16, v58
    v_and_b32 v121, 0xffff0000, v58
    v_lshlrev_b32 v122, 16, v59
    v_and_b32 v123, 0xffff0000, v59
    v_pk_add_f32 v[124:125], v[60:61], v[62:63]
    v_pk_add_f32 v[124:125], v[124:125], v[64:65]
    v_pk_add_f32 v[124:125], v[124:125], v[66:67]
    v_pk_add_f32 v[124:125], v[124:125], v[68:69]
    v_pk_add_f32 v[124:125], v[124:125], v[70:71]
    v_pk_add_f32 v[124:125], v[124:125], v[72:73]
    v_pk_add_f32 v[124:125], v[124:125], v[74:75]
    v_pk_add_f32 v[124:125], v[124:125], v[76:77]
    v_pk_add_f32 v[124:125], v[124:125], v[78:79]
    v_pk_add_f32 v[124:125], v[124:125], v[80:81]
    v_pk_add_f32 v[124:125], v[124:125], v[82:83]
    v_pk_add_f32 v[124:125], v[124:125], v[84:85]
    v_pk_add_f32 v[124:125], v[124:125], v[86:87]
    v_pk_add_f32 v[124:125], v[124:125], v[88:89]
    v_pk_add_f32 v[124:125], v[124:125], v[90:91]
    v_pk_add_f32 v[124:125], v[124:125], v[92:93]
    v_pk_add_f32 v[124:125], v[124:125], v[94:95]
    v_pk_add_f32 v[124:125], v[124:125], v[96:97]
    v_pk_add_f32 v[124:125], v[124:125], v[98:99]
    v_pk_add_f32 v[124:125], v[124:125], v[100:101]
    v_pk_add_f32 v[124:125], v[124:125], v[102:103]
    v_pk_add_f32 v[124:125], v[124:125], v[104:105]
    v_pk_add_f32 v[124:125], v[124:125], v[106:107]
    v_pk_add_f32 v[124:125], v[124:125], v[108:109]
    v_pk_add_f32 v[124:125], v[124:125], v[110:111]
    v_pk_add_f32 v[124:125], v[124:125], v[112:113]
    v_pk_add_f32 v[124:125], v[124:125], v[114:115]
    v_pk_add_f32 v[124:125], v[124:125], v[116:117]
    v_pk_add_f32 v[124:125], v[124:125], v[118:119]
    v_pk_add_f32 v[124:125], v[124:125], v[120:121]
    v_pk_add_f32 v[124:125], v[124:125], v[122:123]
    v_add_f32 v124, v124, v125
    s_nop 1
    v_add_f32_dpp v124, v124, v124 quad_perm:[1,0,3,2] row_mask:0xf bank_mask:0xf
    s_nop 1
    v_add_f32_dpp v124, v124, v124 quad_perm:[2,3,0,1] row_mask:0xf bank_mask:0xf
    s_nop 1
    v_add_f32_dpp v124, v124, v124 row_half_mirror row_mask:0xf bank_mask:0xf
    v_mul_f32 v124, 0xbb000000, v124
    v_mov_b32 v125, v124
    v_pk_add_f32 v[60:61], v[60:61], v[124:125]
    v_pk_add_f32 v[62:63], v[62:63], v[124:125]
    v_pk_add_f32 v[64:65], v[64:65], v[124:125]
    v_pk_add_f32 v[66:67], v[66:67], v[124:125]
    v_pk_add_f32 v[68:69], v[68:69], v[124:125]
    v_pk_add_f32 v[70:71], v[70:71], v[124:125]
    v_pk_add_f32 v[72:73], v[72:73], v[124:125]
    v_pk_add_f32 v[74:75], v[74:75], v[124:125]
    v_pk_add_f32 v[76:77], v[76:77], v[124:125]
    v_pk_add_f32 v[78:79], v[78:79], v[124:125]
    v_pk_add_f32 v[80:81], v[80:81], v[124:125]
    v_pk_add_f32 v[82:83], v[82:83], v[124:125]
    v_pk_add_f32 v[84:85], v[84:85], v[124:125]
    v_pk_add_f32 v[86:87], v[86:87], v[124:125]
    v_pk_add_f32 v[88:89], v[88:89], v[124:125]
    v_pk_add_f32 v[90:91], v[90:91], v[124:125]
    v_pk_add_f32 v[92:93], v[92:93], v[124:125]
    v_pk_add_f32 v[94:95], v[94:95], v[124:125]
    v_pk_add_f32 v[96:97], v[96:97], v[124:125]
    v_pk_add_f32 v[98:99], v[98:99], v[124:125]
    v_pk_add_f32 v[100:101], v[100:101], v[124:125]
    v_pk_add_f32 v[102:103], v[102:103], v[124:125]
    v_pk_add_f32 v[104:105], v[104:105], v[124:125]
    v_pk_add_f32 v[106:107], v[106:107], v[124:125]
    v_pk_add_f32 v[108:109], v[108:109], v[124:125]
    v_pk_add_f32 v[110:111], v[110:111], v[124:125]
    v_pk_add_f32 v[112:113], v[112:113], v[124:125]
    v_pk_add_f32 v[114:115], v[114:115], v[124:125]
    v_pk_add_f32 v[116:117], v[116:117], v[124:125]
    v_pk_add_f32 v[118:119], v[118:119], v[124:125]
    v_pk_add_f32 v[120:121], v[120:121], v[124:125]
    v_pk_add_f32 v[122:123], v[122:123], v[124:125]
    v_pk_mul_f32 v[124:125], v[60:61], v[60:61]
    v_pk_fma_f32 v[124:125], v[62:63], v[62:63], v[124:125]
    v_pk_fma_f32 v[124:125], v[64:65], v[64:65], v[124:125]
    v_pk_fma_f32 v[124:125], v[66:67], v[66:67], v[124:125]
    v_pk_fma_f32 v[124:125], v[68:69], v[68:69], v[124:125]
    v_pk_fma_f32 v[124:125], v[70:71], v[70:71], v[124:125]
    v_pk_fma_f32 v[124:125], v[72:73], v[72:73], v[124:125]
    v_pk_fma_f32 v[124:125], v[74:75], v[74:75], v[124:125]
    v_pk_fma_f32 v[124:125], v[76:77], v[76:77], v[124:125]
    v_pk_fma_f32 v[124:125], v[78:79], v[78:79], v[124:125]
    v_pk_fma_f32 v[124:125], v[80:81], v[80:81], v[124:125]
    v_pk_fma_f32 v[124:125], v[82:83], v[82:83], v[124:125]
    v_pk_fma_f32 v[124:125], v[84:85], v[84:85], v[124:125]
    v_pk_fma_f32 v[124:125], v[86:87], v[86:87], v[124:125]
    v_pk_fma_f32 v[124:125], v[88:89], v[88:89], v[124:125]
    v_pk_fma_f32 v[124:125], v[90:91], v[90:91], v[124:125]
    v_pk_fma_f32 v[124:125], v[92:93], v[92:93], v[124:125]
    v_pk_fma_f32 v[124:125], v[94:95], v[94:95], v[124:125]
    v_pk_fma_f32 v[124:125], v[96:97], v[96:97], v[124:125]
    v_pk_fma_f32 v[124:125], v[98:99], v[98:99], v[124:125]
    v_pk_fma_f32 v[124:125], v[100:101], v[100:101], v[124:125]
    v_pk_fma_f32 v[124:125], v[102:103], v[102:103], v[124:125]
    v_pk_fma_f32 v[124:125], v[104:105], v[104:105], v[124:125]
    v_pk_fma_f32 v[124:125], v[106:107], v[106:107], v[124:125]
    v_pk_fma_f32 v[124:125], v[108:109], v[108:109], v[124:125]
    v_pk_fma_f32 v[124:125], v[110:111], v[110:111], v[124:125]
    v_pk_fma_f32 v[124:125], v[112:113], v[112:113], v[124:125]
    v_pk_fma_f32 v[124:125], v[114:115], v[114:115], v[124:125]
    v_pk_fma_f32 v[124:125], v[116:117], v[116:117], v[124:125]
    v_pk_fma_f32 v[124:125], v[118:119], v[118:119], v[124:125]
    v_pk_fma_f32 v[124:125], v[120:121], v[120:121], v[124:125]
    v_pk_fma_f32 v[124:125], v[122:123], v[122:123], v[124:125]
    v_add_f32 v124, v124, v125
    s_nop 1
    v_add_f32_dpp v124, v124, v124 quad_perm:[1,0,3,2] row_mask:0xf bank_mask:0xf
    s_nop 1
    v_add_f32_dpp v124, v124, v124 quad_perm:[2,3,0,1] row_mask:0xf bank_mask:0xf
    s_nop 1
    v_add_f32_dpp v124, v124, v124 row_half_mirror row_mask:0xf bank_mask:0xf
    v_mov_b32 v125, 0x3727c5ac
    v_fmac_f32 v125, 0x3b000000, v124
    v_rsq_f32 v124, v125
    s_nop 0
    v_mov_b32 v125, v124
    v_pk_mul_f32 v[60:61], v[60:61], v[124:125]
    v_cvt_pk_bf16_f32 v60, v60, v61
    v_pk_mul_f32 v[62:63], v[62:63], v[124:125]
    v_cvt_pk_bf16_f32 v61, v62, v63
    v_pk_mul_f32 v[64:65], v[64:65], v[124:125]
    v_cvt_pk_bf16_f32 v62, v64, v65
    v_pk_mul_f32 v[66:67], v[66:67], v[124:125]
    v_cvt_pk_bf16_f32 v63, v66, v67
    ds_write_b128 v27, v[60:63] offset:32768
    v_pk_mul_f32 v[68:69], v[68:69], v[124:125]
    v_cvt_pk_bf16_f32 v64, v68, v69
    v_pk_mul_f32 v[70:71], v[70:71], v[124:125]
    v_cvt_pk_bf16_f32 v65, v70, v71
    v_pk_mul_f32 v[72:73], v[72:73], v[124:125]
    v_cvt_pk_bf16_f32 v66, v72, v73
    v_pk_mul_f32 v[74:75], v[74:75], v[124:125]
    v_cvt_pk_bf16_f32 v67, v74, v75
    ds_write_b128 v25, v[64:67] offset:32768
    v_pk_mul_f32 v[76:77], v[76:77], v[124:125]
    v_cvt_pk_bf16_f32 v68, v76, v77
    v_pk_mul_f32 v[78:79], v[78:79], v[124:125]
    v_cvt_pk_bf16_f32 v69, v78, v79
    v_pk_mul_f32 v[80:81], v[80:81], v[124:125]
    v_cvt_pk_bf16_f32 v70, v80, v81
    v_pk_mul_f32 v[82:83], v[82:83], v[124:125]
    v_cvt_pk_bf16_f32 v71, v82, v83
    ds_write_b128 v27, v[68:71] offset:33024
    v_pk_mul_f32 v[84:85], v[84:85], v[124:125]
    v_cvt_pk_bf16_f32 v72, v84, v85
    v_pk_mul_f32 v[86:87], v[86:87], v[124:125]
    v_cvt_pk_bf16_f32 v73, v86, v87
    v_pk_mul_f32 v[88:89], v[88:89], v[124:125]
    v_cvt_pk_bf16_f32 v74, v88, v89
    v_pk_mul_f32 v[90:91], v[90:91], v[124:125]
    v_cvt_pk_bf16_f32 v75, v90, v91
    ds_write_b128 v25, v[72:75] offset:33024
    v_pk_mul_f32 v[92:93], v[92:93], v[124:125]
    v_cvt_pk_bf16_f32 v76, v92, v93
    v_pk_mul_f32 v[94:95], v[94:95], v[124:125]
    v_cvt_pk_bf16_f32 v77, v94, v95
    v_pk_mul_f32 v[96:97], v[96:97], v[124:125]
    v_cvt_pk_bf16_f32 v78, v96, v97
    v_pk_mul_f32 v[98:99], v[98:99], v[124:125]
    v_cvt_pk_bf16_f32 v79, v98, v99
    ds_write_b128 v27, v[76:79] offset:33280
    v_pk_mul_f32 v[100:101], v[100:101], v[124:125]
    v_cvt_pk_bf16_f32 v80, v100, v101
    v_pk_mul_f32 v[102:103], v[102:103], v[124:125]
    v_cvt_pk_bf16_f32 v81, v102, v103
    v_pk_mul_f32 v[104:105], v[104:105], v[124:125]
    v_cvt_pk_bf16_f32 v82, v104, v105
    v_pk_mul_f32 v[106:107], v[106:107], v[124:125]
    v_cvt_pk_bf16_f32 v83, v106, v107
    ds_write_b128 v25, v[80:83] offset:33280
    v_pk_mul_f32 v[108:109], v[108:109], v[124:125]
    v_cvt_pk_bf16_f32 v84, v108, v109
    v_pk_mul_f32 v[110:111], v[110:111], v[124:125]
    v_cvt_pk_bf16_f32 v85, v110, v111
    v_pk_mul_f32 v[112:113], v[112:113], v[124:125]
    v_cvt_pk_bf16_f32 v86, v112, v113
    v_pk_mul_f32 v[114:115], v[114:115], v[124:125]
    v_cvt_pk_bf16_f32 v87, v114, v115
    ds_write_b128 v27, v[84:87] offset:33536
    v_pk_mul_f32 v[116:117], v[116:117], v[124:125]
    v_cvt_pk_bf16_f32 v88, v116, v117
    v_pk_mul_f32 v[118:119], v[118:119], v[124:125]
    v_cvt_pk_bf16_f32 v89, v118, v119
    v_pk_mul_f32 v[120:121], v[120:121], v[124:125]
    v_cvt_pk_bf16_f32 v90, v120, v121
    v_pk_mul_f32 v[122:123], v[122:123], v[124:125]
    v_cvt_pk_bf16_f32 v91, v122, v123
    ds_write_b128 v25, v[88:91] offset:33536
    s_nop 1
    s_branch LA_ln_done
LA_l2:
    s_lshl_b32 s23, s32, 9
    s_add_u32 s23, s23, 163840
    v_lshlrev_b32 v124, 3, v0
    v_add_u32 v124, s23, v124
    s_mov_b32 s90, 0
    s_nop 0
Lpoll_18:
    global_load_dwordx2 v[24:25], v124, s[4:5] sc1
    s_waitcnt vmcnt(0)
    v_and_b32 v24, v24, v25
    v_cmp_ne_u32 s[40:41], 1, v24
    s_cmp_eq_u64 s[40:41], 0
    s_cbranch_scc1 Lpd_19
    s_add_u32 s90, s90, 1
    s_cmp_lt_u32 s90, 400000
    s_nop 0
    s_cbranch_scc1 Lpoll_18
    v_mov_b32 v126, 80
    v_mov_b32 v127, 260
    global_store_dword v126, v127, s[10:11]
    s_waitcnt vmcnt(0)
    s_endpgm
Lpd_19:
    s_add_u32 s33, s33, 31457280
    v_lshrrev_b32 v24, 3, v0
    s_lshl_b32 s23, s20, 3
    v_add_u32 v24, s23, v24
    v_and_b32 v25, 7, v0
    v_lshlrev_b32 v26, 10, v24
    v_lshl_add_u32 v26, v25, 4, v26
    v_add_u32 v26, s33, v26
    v_add_u32 v27, 32768, v26
    global_load_dwordx4 v[92:95], v26, s[4:5] offset:0 sc1
    global_load_dwordx4 v[96:99], v26, s[4:5] offset:128 sc1
    global_load_dwordx4 v[100:103], v26, s[4:5] offset:256 sc1
    global_load_dwordx4 v[104:107], v26, s[4:5] offset:384 sc1
    global_load_dwordx4 v[108:111], v26, s[4:5] offset:512 sc1
    global_load_dwordx4 v[112:115], v26, s[4:5] offset:640 sc1
    global_load_dwordx4 v[116:119], v26, s[4:5] offset:768 sc1
    global_load_dwordx4 v[120:123], v26, s[4:5] offset:896 sc1
    global_load_dwordx4 v[28:31], v27, s[4:5] offset:0 sc1
    global_load_dwordx4 v[32:35], v27, s[4:5] offset:128 sc1
    global_load_dwordx4 v[36:39], v27, s[4:5] offset:256 sc1
    global_load_dwordx4 v[40:43], v27, s[4:5] offset:384 sc1
    global_load_dwordx4 v[44:47], v27, s[4:5] offset:512 sc1
    global_load_dwordx4 v[48:51], v27, s[4:5] offset:640 sc1
    global_load_dwordx4 v[52:55], v27, s[4:5] offset:768 sc1
    global_load_dwordx4 v[56:59], v27, s[4:5] offset:896 sc1
    v_and_b32 v27, 7, v24
    v_xor_b32 v27, v27, v25
    v_lshlrev_b32 v27, 4, v27
    v_lshl_add_u32 v27, v24, 10, v27
    v_bfe_u32 v25, v24, 3, 1
    v_lshl_add_u32 v27, v25, 7, v27
    v_add_u32 v27, 0, v27
    v_xor_b32 v25, 128, v27
    s_waitcnt vmcnt(15)
    v_lshlrev_b32 v60, 16, v92
    v_and_b32 v61, 0xffff0000, v92
    v_lshlrev_b32 v62, 16, v93
    v_and_b32 v63, 0xffff0000, v93
    v_lshlrev_b32 v64, 16, v94
    v_and_b32 v65, 0xffff0000, v94
    v_lshlrev_b32 v66, 16, v95
    v_and_b32 v67, 0xffff0000, v95
    s_waitcnt vmcnt(14)
    v_lshlrev_b32 v68, 16, v96
    v_and_b32 v69, 0xffff0000, v96
    v_lshlrev_b32 v70, 16, v97
    v_and_b32 v71, 0xffff0000, v97
    v_lshlrev_b32 v72, 16, v98
    v_and_b32 v73, 0xffff0000, v98
    v_lshlrev_b32 v74, 16, v99
    v_and_b32 v75, 0xffff0000, v99
    s_waitcnt vmcnt(13)
    v_lshlrev_b32 v76, 16, v100
    v_and_b32 v77, 0xffff0000, v100
    v_lshlrev_b32 v78, 16, v101
    v_and_b32 v79, 0xffff0000, v101
    v_lshlrev_b32 v80, 16, v102
    v_and_b32 v81, 0xffff0000, v102
    v_lshlrev_b32 v82, 16, v103
    v_and_b32 v83, 0xffff0000, v103
    s_waitcnt vmcnt(12)
    v_lshlrev_b32 v84, 16, v104
    v_and_b32 v85, 0xffff0000, v104
    v_lshlrev_b32 v86, 16, v105
    v_and_b32 v87, 0xffff0000, v105
    v_lshlrev_b32 v88, 16, v106
    v_and_b32 v89, 0xffff0000, v106
    v_lshlrev_b32 v90, 16, v107
    v_and_b32 v91, 0xffff0000, v107
    s_waitcnt vmcnt(11)
    v_lshlrev_b32 v92, 16, v108
    v_and_b32 v93, 0xffff0000, v108
    v_lshlrev_b32 v94, 16, v109
    v_and_b32 v95, 0xffff0000, v109
    v_lshlrev_b32 v96, 16, v110
    v_and_b32 v97, 0xffff0000, v110
    v_lshlrev_b32 v98, 16, v111
    v_and_b32 v99, 0xffff0000, v111
    s_waitcnt vmcnt(10)
    v_lshlrev_b32 v100, 16, v112
    v_and_b32 v101, 0xffff0000, v112
    v_lshlrev_b32 v102, 16, v113
    v_and_b32 v103, 0xffff0000, v113
    v_lshlrev_b32 v104, 16, v114
    v_and_b32 v105, 0xffff0000, v114
    v_lshlrev_b32 v106, 16, v115
    v_and_b32 v107, 0xffff0000, v115
    s_waitcnt vmcnt(9)
    v_lshlrev_b32 v108, 16, v116
    v_and_b32 v109, 0xffff0000, v116
    v_lshlrev_b32 v110, 16, v117
    v_and_b32 v111, 0xffff0000, v117
    v_lshlrev_b32 v112, 16, v118
    v_and_b32 v113, 0xffff0000, v118
    v_lshlrev_b32 v114, 16, v119
    v_and_b32 v115, 0xffff0000, v119
    s_waitcnt vmcnt(8)
    v_lshlrev_b32 v116, 16, v120
    v_and_b32 v117, 0xffff0000, v120
    v_lshlrev_b32 v118, 16, v121
    v_and_b32 v119, 0xffff0000, v121
    v_lshlrev_b32 v120, 16, v122
    v_and_b32 v121, 0xffff0000, v122
    v_lshlrev_b32 v122, 16, v123
    v_and_b32 v123, 0xffff0000, v123
    v_pk_add_f32 v[124:125], v[60:61], v[62:63]
    v_pk_add_f32 v[124:125], v[124:125], v[64:65]
    v_pk_add_f32 v[124:125], v[124:125], v[66:67]
    v_pk_add_f32 v[124:125], v[124:125], v[68:69]
    v_pk_add_f32 v[124:125], v[124:125], v[70:71]
    v_pk_add_f32 v[124:125], v[124:125], v[72:73]
    v_pk_add_f32 v[124:125], v[124:125], v[74:75]
    v_pk_add_f32 v[124:125], v[124:125], v[76:77]
    v_pk_add_f32 v[124:125], v[124:125], v[78:79]
    v_pk_add_f32 v[124:125], v[124:125], v[80:81]
    v_pk_add_f32 v[124:125], v[124:125], v[82:83]
    v_pk_add_f32 v[124:125], v[124:125], v[84:85]
    v_pk_add_f32 v[124:125], v[124:125], v[86:87]
    v_pk_add_f32 v[124:125], v[124:125], v[88:89]
    v_pk_add_f32 v[124:125], v[124:125], v[90:91]
    v_pk_add_f32 v[124:125], v[124:125], v[92:93]
    v_pk_add_f32 v[124:125], v[124:125], v[94:95]
    v_pk_add_f32 v[124:125], v[124:125], v[96:97]
    v_pk_add_f32 v[124:125], v[124:125], v[98:99]
    v_pk_add_f32 v[124:125], v[124:125], v[100:101]
    v_pk_add_f32 v[124:125], v[124:125], v[102:103]
    v_pk_add_f32 v[124:125], v[124:125], v[104:105]
    v_pk_add_f32 v[124:125], v[124:125], v[106:107]
    v_pk_add_f32 v[124:125], v[124:125], v[108:109]
    v_pk_add_f32 v[124:125], v[124:125], v[110:111]
    v_pk_add_f32 v[124:125], v[124:125], v[112:113]
    v_pk_add_f32 v[124:125], v[124:125], v[114:115]
    v_pk_add_f32 v[124:125], v[124:125], v[116:117]
    v_pk_add_f32 v[124:125], v[124:125], v[118:119]
    v_pk_add_f32 v[124:125], v[124:125], v[120:121]
    v_pk_add_f32 v[124:125], v[124:125], v[122:123]
    v_add_f32 v124, v124, v125
    s_nop 1
    v_add_f32_dpp v124, v124, v124 quad_perm:[1,0,3,2] row_mask:0xf bank_mask:0xf
    s_nop 1
    v_add_f32_dpp v124, v124, v124 quad_perm:[2,3,0,1] row_mask:0xf bank_mask:0xf
    s_nop 1
    v_add_f32_dpp v124, v124, v124 row_half_mirror row_mask:0xf bank_mask:0xf
    v_mul_f32 v124, 0xbb000000, v124
    v_mov_b32 v125, v124
    v_pk_add_f32 v[60:61], v[60:61], v[124:125]
    v_pk_add_f32 v[62:63], v[62:63], v[124:125]
    v_pk_add_f32 v[64:65], v[64:65], v[124:125]
    v_pk_add_f32 v[66:67], v[66:67], v[124:125]
    v_pk_add_f32 v[68:69], v[68:69], v[124:125]
    v_pk_add_f32 v[70:71], v[70:71], v[124:125]
    v_pk_add_f32 v[72:73], v[72:73], v[124:125]
    v_pk_add_f32 v[74:75], v[74:75], v[124:125]
    v_pk_add_f32 v[76:77], v[76:77], v[124:125]
    v_pk_add_f32 v[78:79], v[78:79], v[124:125]
    v_pk_add_f32 v[80:81], v[80:81], v[124:125]
    v_pk_add_f32 v[82:83], v[82:83], v[124:125]
    v_pk_add_f32 v[84:85], v[84:85], v[124:125]
    v_pk_add_f32 v[86:87], v[86:87], v[124:125]
    v_pk_add_f32 v[88:89], v[88:89], v[124:125]
    v_pk_add_f32 v[90:91], v[90:91], v[124:125]
    v_pk_add_f32 v[92:93], v[92:93], v[124:125]
    v_pk_add_f32 v[94:95], v[94:95], v[124:125]
    v_pk_add_f32 v[96:97], v[96:97], v[124:125]
    v_pk_add_f32 v[98:99], v[98:99], v[124:125]
    v_pk_add_f32 v[100:101], v[100:101], v[124:125]
    v_pk_add_f32 v[102:103], v[102:103], v[124:125]
    v_pk_add_f32 v[104:105], v[104:105], v[124:125]
    v_pk_add_f32 v[106:107], v[106:107], v[124:125]
    v_pk_add_f32 v[108:109], v[108:109], v[124:125]
    v_pk_add_f32 v[110:111], v[110:111], v[124:125]
    v_pk_add_f32 v[112:113], v[112:113], v[124:125]
    v_pk_add_f32 v[114:115], v[114:115], v[124:125]
    v_pk_add_f32 v[116:117], v[116:117], v[124:125]
    v_pk_add_f32 v[118:119], v[118:119], v[124:125]
    v_pk_add_f32 v[120:121], v[120:121], v[124:125]
    v_pk_add_f32 v[122:123], v[122:123], v[124:125]
    v_pk_mul_f32 v[124:125], v[60:61], v[60:61]
    v_pk_fma_f32 v[124:125], v[62:63], v[62:63], v[124:125]
    v_pk_fma_f32 v[124:125], v[64:65], v[64:65], v[124:125]
    v_pk_fma_f32 v[124:125], v[66:67], v[66:67], v[124:125]
    v_pk_fma_f32 v[124:125], v[68:69], v[68:69], v[124:125]
    v_pk_fma_f32 v[124:125], v[70:71], v[70:71], v[124:125]
    v_pk_fma_f32 v[124:125], v[72:73], v[72:73], v[124:125]
    v_pk_fma_f32 v[124:125], v[74:75], v[74:75], v[124:125]
    v_pk_fma_f32 v[124:125], v[76:77], v[76:77], v[124:125]
    v_pk_fma_f32 v[124:125], v[78:79], v[78:79], v[124:125]
    v_pk_fma_f32 v[124:125], v[80:81], v[80:81], v[124:125]
    v_pk_fma_f32 v[124:125], v[82:83], v[82:83], v[124:125]
    v_pk_fma_f32 v[124:125], v[84:85], v[84:85], v[124:125]
    v_pk_fma_f32 v[124:125], v[86:87], v[86:87], v[124:125]
    v_pk_fma_f32 v[124:125], v[88:89], v[88:89], v[124:125]
    v_pk_fma_f32 v[124:125], v[90:91], v[90:91], v[124:125]
    v_pk_fma_f32 v[124:125], v[92:93], v[92:93], v[124:125]
    v_pk_fma_f32 v[124:125], v[94:95], v[94:95], v[124:125]
    v_pk_fma_f32 v[124:125], v[96:97], v[96:97], v[124:125]
    v_pk_fma_f32 v[124:125], v[98:99], v[98:99], v[124:125]
    v_pk_fma_f32 v[124:125], v[100:101], v[100:101], v[124:125]
    v_pk_fma_f32 v[124:125], v[102:103], v[102:103], v[124:125]
    v_pk_fma_f32 v[124:125], v[104:105], v[104:105], v[124:125]
    v_pk_fma_f32 v[124:125], v[106:107], v[106:107], v[124:125]
    v_pk_fma_f32 v[124:125], v[108:109], v[108:109], v[124:125]
    v_pk_fma_f32 v[124:125], v[110:111], v[110:111], v[124:125]
    v_pk_fma_f32 v[124:125], v[112:113], v[112:113], v[124:125]
    v_pk_fma_f32 v[124:125], v[114:115], v[114:115], v[124:125]
    v_pk_fma_f32 v[124:125], v[116:117], v[116:117], v[124:125]
    v_pk_fma_f32 v[124:125], v[118:119], v[118:119], v[124:125]
    v_pk_fma_f32 v[124:125], v[120:121], v[120:121], v[124:125]
    v_pk_fma_f32 v[124:125], v[122:123], v[122:123], v[124:125]
    v_add_f32 v124, v124, v125
    s_nop 1
    v_add_f32_dpp v124, v124, v124 quad_perm:[1,0,3,2] row_mask:0xf bank_mask:0xf
    s_nop 1
    v_add_f32_dpp v124, v124, v124 quad_perm:[2,3,0,1] row_mask:0xf bank_mask:0xf
    s_nop 1
    v_add_f32_dpp v124, v124, v124 row_half_mirror row_mask:0xf bank_mask:0xf
    v_mov_b32 v125, 0x3727c5ac
    v_fmac_f32 v125, 0x3b000000, v124
    v_rsq_f32 v124, v125
    s_nop 0
    v_mov_b32 v125, v124
    v_pk_mul_f32 v[60:61], v[60:61], v[124:125]
    v_cvt_pk_bf16_f32 v60, v60, v61
    v_pk_mul_f32 v[62:63], v[62:63], v[124:125]
    v_cvt_pk_bf16_f32 v61, v62, v63
    v_pk_mul_f32 v[64:65], v[64:65], v[124:125]
    v_cvt_pk_bf16_f32 v62, v64, v65
    v_pk_mul_f32 v[66:67], v[66:67], v[124:125]
    v_cvt_pk_bf16_f32 v63, v66, v67
    ds_write_b128 v27, v[60:63] offset:0
    v_pk_mul_f32 v[68:69], v[68:69], v[124:125]
    v_cvt_pk_bf16_f32 v64, v68, v69
    v_pk_mul_f32 v[70:71], v[70:71], v[124:125]
    v_cvt_pk_bf16_f32 v65, v70, v71
    v_pk_mul_f32 v[72:73], v[72:73], v[124:125]
    v_cvt_pk_bf16_f32 v66, v72, v73
    v_pk_mul_f32 v[74:75], v[74:75], v[124:125]
    v_cvt_pk_bf16_f32 v67, v74, v75
    ds_write_b128 v25, v[64:67] offset:0
    v_pk_mul_f32 v[76:77], v[76:77], v[124:125]
    v_cvt_pk_bf16_f32 v68, v76, v77
    v_pk_mul_f32 v[78:79], v[78:79], v[124:125]
    v_cvt_pk_bf16_f32 v69, v78, v79
    v_pk_mul_f32 v[80:81], v[80:81], v[124:125]
    v_cvt_pk_bf16_f32 v70, v80, v81
    v_pk_mul_f32 v[82:83], v[82:83], v[124:125]
    v_cvt_pk_bf16_f32 v71, v82, v83
    ds_write_b128 v27, v[68:71] offset:256
    v_pk_mul_f32 v[84:85], v[84:85], v[124:125]
    v_cvt_pk_bf16_f32 v72, v84, v85
    v_pk_mul_f32 v[86:87], v[86:87], v[124:125]
    v_cvt_pk_bf16_f32 v73, v86, v87
    v_pk_mul_f32 v[88:89], v[88:89], v[124:125]
    v_cvt_pk_bf16_f32 v74, v88, v89
    v_pk_mul_f32 v[90:91], v[90:91], v[124:125]
    v_cvt_pk_bf16_f32 v75, v90, v91
    ds_write_b128 v25, v[72:75] offset:256
    v_pk_mul_f32 v[92:93], v[92:93], v[124:125]
    v_cvt_pk_bf16_f32 v76, v92, v93
    v_pk_mul_f32 v[94:95], v[94:95], v[124:125]
    v_cvt_pk_bf16_f32 v77, v94, v95
    v_pk_mul_f32 v[96:97], v[96:97], v[124:125]
    v_cvt_pk_bf16_f32 v78, v96, v97
    v_pk_mul_f32 v[98:99], v[98:99], v[124:125]
    v_cvt_pk_bf16_f32 v79, v98, v99
    ds_write_b128 v27, v[76:79] offset:512
    v_pk_mul_f32 v[100:101], v[100:101], v[124:125]
    v_cvt_pk_bf16_f32 v80, v100, v101
    v_pk_mul_f32 v[102:103], v[102:103], v[124:125]
    v_cvt_pk_bf16_f32 v81, v102, v103
    v_pk_mul_f32 v[104:105], v[104:105], v[124:125]
    v_cvt_pk_bf16_f32 v82, v104, v105
    v_pk_mul_f32 v[106:107], v[106:107], v[124:125]
    v_cvt_pk_bf16_f32 v83, v106, v107
    ds_write_b128 v25, v[80:83] offset:512
    v_pk_mul_f32 v[108:109], v[108:109], v[124:125]
    v_cvt_pk_bf16_f32 v84, v108, v109
    v_pk_mul_f32 v[110:111], v[110:111], v[124:125]
    v_cvt_pk_bf16_f32 v85, v110, v111
    v_pk_mul_f32 v[112:113], v[112:113], v[124:125]
    v_cvt_pk_bf16_f32 v86, v112, v113
    v_pk_mul_f32 v[114:115], v[114:115], v[124:125]
    v_cvt_pk_bf16_f32 v87, v114, v115
    ds_write_b128 v27, v[84:87] offset:768
    v_pk_mul_f32 v[116:117], v[116:117], v[124:125]
    v_cvt_pk_bf16_f32 v88, v116, v117
    v_pk_mul_f32 v[118:119], v[118:119], v[124:125]
    v_cvt_pk_bf16_f32 v89, v118, v119
    v_pk_mul_f32 v[120:121], v[120:121], v[124:125]
    v_cvt_pk_bf16_f32 v90, v120, v121
    v_pk_mul_f32 v[122:123], v[122:123], v[124:125]
    v_cvt_pk_bf16_f32 v91, v122, v123
    ds_write_b128 v25, v[88:91] offset:768
    s_waitcnt vmcnt(7)
    v_lshlrev_b32 v60, 16, v28
    v_and_b32 v61, 0xffff0000, v28
    v_lshlrev_b32 v62, 16, v29
    v_and_b32 v63, 0xffff0000, v29
    v_lshlrev_b32 v64, 16, v30
    v_and_b32 v65, 0xffff0000, v30
    v_lshlrev_b32 v66, 16, v31
    v_and_b32 v67, 0xffff0000, v31
    s_waitcnt vmcnt(6)
    v_lshlrev_b32 v68, 16, v32
    v_and_b32 v69, 0xffff0000, v32
    v_lshlrev_b32 v70, 16, v33
    v_and_b32 v71, 0xffff0000, v33
    v_lshlrev_b32 v72, 16, v34
    v_and_b32 v73, 0xffff0000, v34
    v_lshlrev_b32 v74, 16, v35
    v_and_b32 v75, 0xffff0000, v35
    s_waitcnt vmcnt(5)
    v_lshlrev_b32 v76, 16, v36
    v_and_b32 v77, 0xffff0000, v36
    v_lshlrev_b32 v78, 16, v37
    v_and_b32 v79, 0xffff0000, v37
    v_lshlrev_b32 v80, 16, v38
    v_and_b32 v81, 0xffff0000, v38
    v_lshlrev_b32 v82, 16, v39
    v_and_b32 v83, 0xffff0000, v39
    s_waitcnt vmcnt(4)
    v_lshlrev_b32 v84, 16, v40
    v_and_b32 v85, 0xffff0000, v40
    v_lshlrev_b32 v86, 16, v41
    v_and_b32 v87, 0xffff0000, v41
    v_lshlrev_b32 v88, 16, v42
    v_and_b32 v89, 0xffff0000, v42
    v_lshlrev_b32 v90, 16, v43
    v_and_b32 v91, 0xffff0000, v43
    s_waitcnt vmcnt(3)
    v_lshlrev_b32 v92, 16, v44
    v_and_b32 v93, 0xffff0000, v44
    v_lshlrev_b32 v94, 16, v45
    v_and_b32 v95, 0xffff0000, v45
    v_lshlrev_b32 v96, 16, v46
    v_and_b32 v97, 0xffff0000, v46
    v_lshlrev_b32 v98, 16, v47
    v_and_b32 v99, 0xffff0000, v47
    s_waitcnt vmcnt(2)
    v_lshlrev_b32 v100, 16, v48
    v_and_b32 v101, 0xffff0000, v48
    v_lshlrev_b32 v102, 16, v49
    v_and_b32 v103, 0xffff0000, v49
    v_lshlrev_b32 v104, 16, v50
    v_and_b32 v105, 0xffff0000, v50
    v_lshlrev_b32 v106, 16, v51
    v_and_b32 v107, 0xffff0000, v51
    s_waitcnt vmcnt(1)
    v_lshlrev_b32 v108, 16, v52
    v_and_b32 v109, 0xffff0000, v52
    v_lshlrev_b32 v110, 16, v53
    v_and_b32 v111, 0xffff0000, v53
    v_lshlrev_b32 v112, 16, v54
    v_and_b32 v113, 0xffff0000, v54
    v_lshlrev_b32 v114, 16, v55
    v_and_b32 v115, 0xffff0000, v55
    s_waitcnt vmcnt(0)
    v_lshlrev_b32 v116, 16, v56
    v_and_b32 v117, 0xffff0000, v56
    v_lshlrev_b32 v118, 16, v57
    v_and_b32 v119, 0xffff0000, v57
    v_lshlrev_b32 v120, 16, v58
    v_and_b32 v121, 0xffff0000, v58
    v_lshlrev_b32 v122, 16, v59
    v_and_b32 v123, 0xffff0000, v59
    v_pk_add_f32 v[124:125], v[60:61], v[62:63]
    v_pk_add_f32 v[124:125], v[124:125], v[64:65]
    v_pk_add_f32 v[124:125], v[124:125], v[66:67]
    v_pk_add_f32 v[124:125], v[124:125], v[68:69]
    v_pk_add_f32 v[124:125], v[124:125], v[70:71]
    v_pk_add_f32 v[124:125], v[124:125], v[72:73]
    v_pk_add_f32 v[124:125], v[124:125], v[74:75]
    v_pk_add_f32 v[124:125], v[124:125], v[76:77]
    v_pk_add_f32 v[124:125], v[124:125], v[78:79]
    v_pk_add_f32 v[124:125], v[124:125], v[80:81]
    v_pk_add_f32 v[124:125], v[124:125], v[82:83]
    v_pk_add_f32 v[124:125], v[124:125], v[84:85]
    v_pk_add_f32 v[124:125], v[124:125], v[86:87]
    v_pk_add_f32 v[124:125], v[124:125], v[88:89]
    v_pk_add_f32 v[124:125], v[124:125], v[90:91]
    v_pk_add_f32 v[124:125], v[124:125], v[92:93]
    v_pk_add_f32 v[124:125], v[124:125], v[94:95]
    v_pk_add_f32 v[124:125], v[124:125], v[96:97]
    v_pk_add_f32 v[124:125], v[124:125], v[98:99]
    v_pk_add_f32 v[124:125], v[124:125], v[100:101]
    v_pk_add_f32 v[124:125], v[124:125], v[102:103]
    v_pk_add_f32 v[124:125], v[124:125], v[104:105]
    v_pk_add_f32 v[124:125], v[124:125], v[106:107]
    v_pk_add_f32 v[124:125], v[124:125], v[108:109]
    v_pk_add_f32 v[124:125], v[124:125], v[110:111]
    v_pk_add_f32 v[124:125], v[124:125], v[112:113]
    v_pk_add_f32 v[124:125], v[124:125], v[114:115]
    v_pk_add_f32 v[124:125], v[124:125], v[116:117]
    v_pk_add_f32 v[124:125], v[124:125], v[118:119]
    v_pk_add_f32 v[124:125], v[124:125], v[120:121]
    v_pk_add_f32 v[124:125], v[124:125], v[122:123]
    v_add_f32 v124, v124, v125
    s_nop 1
    v_add_f32_dpp v124, v124, v124 quad_perm:[1,0,3,2] row_mask:0xf bank_mask:0xf
    s_nop 1
    v_add_f32_dpp v124, v124, v124 quad_perm:[2,3,0,1] row_mask:0xf bank_mask:0xf
    s_nop 1
    v_add_f32_dpp v124, v124, v124 row_half_mirror row_mask:0xf bank_mask:0xf
    v_mul_f32 v124, 0xbb000000, v124
    v_mov_b32 v125, v124
    v_pk_add_f32 v[60:61], v[60:61], v[124:125]
    v_pk_add_f32 v[62:63], v[62:63], v[124:125]
    v_pk_add_f32 v[64:65], v[64:65], v[124:125]
    v_pk_add_f32 v[66:67], v[66:67], v[124:125]
    v_pk_add_f32 v[68:69], v[68:69], v[124:125]
    v_pk_add_f32 v[70:71], v[70:71], v[124:125]
    v_pk_add_f32 v[72:73], v[72:73], v[124:125]
    v_pk_add_f32 v[74:75], v[74:75], v[124:125]
    v_pk_add_f32 v[76:77], v[76:77], v[124:125]
    v_pk_add_f32 v[78:79], v[78:79], v[124:125]
    v_pk_add_f32 v[80:81], v[80:81], v[124:125]
    v_pk_add_f32 v[82:83], v[82:83], v[124:125]
    v_pk_add_f32 v[84:85], v[84:85], v[124:125]
    v_pk_add_f32 v[86:87], v[86:87], v[124:125]
    v_pk_add_f32 v[88:89], v[88:89], v[124:125]
    v_pk_add_f32 v[90:91], v[90:91], v[124:125]
    v_pk_add_f32 v[92:93], v[92:93], v[124:125]
    v_pk_add_f32 v[94:95], v[94:95], v[124:125]
    v_pk_add_f32 v[96:97], v[96:97], v[124:125]
    v_pk_add_f32 v[98:99], v[98:99], v[124:125]
    v_pk_add_f32 v[100:101], v[100:101], v[124:125]
    v_pk_add_f32 v[102:103], v[102:103], v[124:125]
    v_pk_add_f32 v[104:105], v[104:105], v[124:125]
    v_pk_add_f32 v[106:107], v[106:107], v[124:125]
    v_pk_add_f32 v[108:109], v[108:109], v[124:125]
    v_pk_add_f32 v[110:111], v[110:111], v[124:125]
    v_pk_add_f32 v[112:113], v[112:113], v[124:125]
    v_pk_add_f32 v[114:115], v[114:115], v[124:125]
    v_pk_add_f32 v[116:117], v[116:117], v[124:125]
    v_pk_add_f32 v[118:119], v[118:119], v[124:125]
    v_pk_add_f32 v[120:121], v[120:121], v[124:125]
    v_pk_add_f32 v[122:123], v[122:123], v[124:125]
    v_pk_mul_f32 v[124:125], v[60:61], v[60:61]
    v_pk_fma_f32 v[124:125], v[62:63], v[62:63], v[124:125]
    v_pk_fma_f32 v[124:125], v[64:65], v[64:65], v[124:125]
    v_pk_fma_f32 v[124:125], v[66:67], v[66:67], v[124:125]
    v_pk_fma_f32 v[124:125], v[68:69], v[68:69], v[124:125]
    v_pk_fma_f32 v[124:125], v[70:71], v[70:71], v[124:125]
    v_pk_fma_f32 v[124:125], v[72:73], v[72:73], v[124:125]
    v_pk_fma_f32 v[124:125], v[74:75], v[74:75], v[124:125]
    v_pk_fma_f32 v[124:125], v[76:77], v[76:77], v[124:125]
    v_pk_fma_f32 v[124:125], v[78:79], v[78:79], v[124:125]
    v_pk_fma_f32 v[124:125], v[80:81], v[80:81], v[124:125]
    v_pk_fma_f32 v[124:125], v[82:83], v[82:83], v[124:125]
    v_pk_fma_f32 v[124:125], v[84:85], v[84:85], v[124:125]
    v_pk_fma_f32 v[124:125], v[86:87], v[86:87], v[124:125]
    v_pk_fma_f32 v[124:125], v[88:89], v[88:89], v[124:125]
    v_pk_fma_f32 v[124:125], v[90:91], v[90:91], v[124:125]
    v_pk_fma_f32 v[124:125], v[92:93], v[92:93], v[124:125]
    v_pk_fma_f32 v[124:125], v[94:95], v[94:95], v[124:125]
    v_pk_fma_f32 v[124:125], v[96:97], v[96:97], v[124:125]
    v_pk_fma_f32 v[124:125], v[98:99], v[98:99], v[124:125]
    v_pk_fma_f32 v[124:125], v[100:101], v[100:101], v[124:125]
    v_pk_fma_f32 v[124:125], v[102:103], v[102:103], v[124:125]
    v_pk_fma_f32 v[124:125], v[104:105], v[104:105], v[124:125]
    v_pk_fma_f32 v[124:125], v[106:107], v[106:107], v[124:125]
    v_pk_fma_f32 v[124:125], v[108:109], v[108:109], v[124:125]
    v_pk_fma_f32 v[124:125], v[110:111], v[110:111], v[124:125]
    v_pk_fma_f32 v[124:125], v[112:113], v[112:113], v[124:125]
    v_pk_fma_f32 v[124:125], v[114:115], v[114:115], v[124:125]
    v_pk_fma_f32 v[124:125], v[116:117], v[116:117], v[124:125]
    v_pk_fma_f32 v[124:125], v[118:119], v[118:119], v[124:125]
    v_pk_fma_f32 v[124:125], v[120:121], v[120:121], v[124:125]
    v_pk_fma_f32 v[124:125], v[122:123], v[122:123], v[124:125]
    v_add_f32 v124, v124, v125
    s_nop 1
    v_add_f32_dpp v124, v124, v124 quad_perm:[1,0,3,2] row_mask:0xf bank_mask:0xf
    s_nop 1
    v_add_f32_dpp v124, v124, v124 quad_perm:[2,3,0,1] row_mask:0xf bank_mask:0xf
    s_nop 1
    v_add_f32_dpp v124, v124, v124 row_half_mirror row_mask:0xf bank_mask:0xf
    v_mov_b32 v125, 0x3727c5ac
    v_fmac_f32 v125, 0x3b000000, v124
    v_rsq_f32 v124, v125
    s_nop 0
    v_mov_b32 v125, v124
    v_pk_mul_f32 v[60:61], v[60:61], v[124:125]
    v_cvt_pk_bf16_f32 v60, v60, v61
    v_pk_mul_f32 v[62:63], v[62:63], v[124:125]
    v_cvt_pk_bf16_f32 v61, v62, v63
    v_pk_mul_f32 v[64:65], v[64:65], v[124:125]
    v_cvt_pk_bf16_f32 v62, v64, v65
    v_pk_mul_f32 v[66:67], v[66:67], v[124:125]
    v_cvt_pk_bf16_f32 v63, v66, v67
    ds_write_b128 v27, v[60:63] offset:32768
    v_pk_mul_f32 v[68:69], v[68:69], v[124:125]
    v_cvt_pk_bf16_f32 v64, v68, v69
    v_pk_mul_f32 v[70:71], v[70:71], v[124:125]
    v_cvt_pk_bf16_f32 v65, v70, v71
    v_pk_mul_f32 v[72:73], v[72:73], v[124:125]
    v_cvt_pk_bf16_f32 v66, v72, v73
    v_pk_mul_f32 v[74:75], v[74:75], v[124:125]
    v_cvt_pk_bf16_f32 v67, v74, v75
    ds_write_b128 v25, v[64:67] offset:32768
    v_pk_mul_f32 v[76:77], v[76:77], v[124:125]
    v_cvt_pk_bf16_f32 v68, v76, v77
    v_pk_mul_f32 v[78:79], v[78:79], v[124:125]
    v_cvt_pk_bf16_f32 v69, v78, v79
    v_pk_mul_f32 v[80:81], v[80:81], v[124:125]
    v_cvt_pk_bf16_f32 v70, v80, v81
    v_pk_mul_f32 v[82:83], v[82:83], v[124:125]
    v_cvt_pk_bf16_f32 v71, v82, v83
    ds_write_b128 v27, v[68:71] offset:33024
    v_pk_mul_f32 v[84:85], v[84:85], v[124:125]
    v_cvt_pk_bf16_f32 v72, v84, v85
    v_pk_mul_f32 v[86:87], v[86:87], v[124:125]
    v_cvt_pk_bf16_f32 v73, v86, v87
    v_pk_mul_f32 v[88:89], v[88:89], v[124:125]
    v_cvt_pk_bf16_f32 v74, v88, v89
    v_pk_mul_f32 v[90:91], v[90:91], v[124:125]
    v_cvt_pk_bf16_f32 v75, v90, v91
    ds_write_b128 v25, v[72:75] offset:33024
    v_pk_mul_f32 v[92:93], v[92:93], v[124:125]
    v_cvt_pk_bf16_f32 v76, v92, v93
    v_pk_mul_f32 v[94:95], v[94:95], v[124:125]
    v_cvt_pk_bf16_f32 v77, v94, v95
    v_pk_mul_f32 v[96:97], v[96:97], v[124:125]
    v_cvt_pk_bf16_f32 v78, v96, v97
    v_pk_mul_f32 v[98:99], v[98:99], v[124:125]
    v_cvt_pk_bf16_f32 v79, v98, v99
    ds_write_b128 v27, v[76:79] offset:33280
    v_pk_mul_f32 v[100:101], v[100:101], v[124:125]
    v_cvt_pk_bf16_f32 v80, v100, v101
    v_pk_mul_f32 v[102:103], v[102:103], v[124:125]
    v_cvt_pk_bf16_f32 v81, v102, v103
    v_pk_mul_f32 v[104:105], v[104:105], v[124:125]
    v_cvt_pk_bf16_f32 v82, v104, v105
    v_pk_mul_f32 v[106:107], v[106:107], v[124:125]
    v_cvt_pk_bf16_f32 v83, v106, v107
    ds_write_b128 v25, v[80:83] offset:33280
    v_pk_mul_f32 v[108:109], v[108:109], v[124:125]
    v_cvt_pk_bf16_f32 v84, v108, v109
    v_pk_mul_f32 v[110:111], v[110:111], v[124:125]
    v_cvt_pk_bf16_f32 v85, v110, v111
    v_pk_mul_f32 v[112:113], v[112:113], v[124:125]
    v_cvt_pk_bf16_f32 v86, v112, v113
    v_pk_mul_f32 v[114:115], v[114:115], v[124:125]
    v_cvt_pk_bf16_f32 v87, v114, v115
    ds_write_b128 v27, v[84:87] offset:33536
    v_pk_mul_f32 v[116:117], v[116:117], v[124:125]
    v_cvt_pk_bf16_f32 v88, v116, v117
    v_pk_mul_f32 v[118:119], v[118:119], v[124:125]
    v_cvt_pk_bf16_f32 v89, v118, v119
    v_pk_mul_f32 v[120:121], v[120:121], v[124:125]
    v_cvt_pk_bf16_f32 v90, v120, v121
    v_pk_mul_f32 v[122:123], v[122:123], v[124:125]
    v_cvt_pk_bf16_f32 v91, v122, v123
    ds_write_b128 v25, v[88:91] offset:33536
    s_nop 1
LA_ln_done:
    s_waitcnt lgkmcnt(0)
    s_barrier
    ds_read_b128 v[72:75], v3 offset:0
    ds_read_b128 v[76:79], v3 offset:16384
    ds_read_b128 v[80:83], v4 offset:0
    ds_read_b128 v[84:87], v4 offset:16384
    ds_read_b128 v[88:91], v5 offset:0
    ds_read_b128 v[92:95], v5 offset:16384
    ds_read_b128 v[96:99], v6 offset:0
    ds_read_b128 v[100:103], v6 offset:16384
    s_waitcnt lgkmcnt(6)
    v_mfma_f32_16x16x32_bf16 v[24:27], a[0:3], v[72:75], 0
    v_mfma_f32_16x16x32_bf16 v[28:31], a[64:67], v[72:75], 0
    v_mfma_f32_16x16x32_bf16 v[40:43], a[128:131], v[72:75], 0
    v_mfma_f32_16x16x32_bf16 v[44:47], a[192:195], v[72:75], 0
    v_mfma_f32_16x16x32_bf16 v[56:59], v[72:75], v[128:131], 0
    v_mfma_f32_16x16x32_bf16 v[60:63], v[72:75], v[192:195], 0
    v_mfma_f32_16x16x32_bf16 v[32:35], a[0:3], v[76:79], 0
    v_mfma_f32_16x16x32_bf16 v[36:39], a[64:67], v[76:79], 0
    v_mfma_f32_16x16x32_bf16 v[48:51], a[128:131], v[76:79], 0
    v_mfma_f32_16x16x32_bf16 v[52:55], a[192:195], v[76:79], 0
    v_mfma_f32_16x16x32_bf16 v[64:67], v[76:79], v[128:131], 0
    v_mfma_f32_16x16x32_bf16 v[68:71], v[76:79], v[192:195], 0
    ds_read_b128 v[72:75], v3 offset:256
    ds_read_b128 v[76:79], v3 offset:16640
    s_waitcnt lgkmcnt(6)
    v_mfma_f32_16x16x32_bf16 v[24:27], a[4:7], v[80:83], v[24:27]
    v_mfma_f32_16x16x32_bf16 v[28:31], a[68:71], v[80:83], v[28:31]
    v_mfma_f32_16x16x32_bf16 v[40:43], a[132:135], v[80:83], v[40:43]
    v_mfma_f32_16x16x32_bf16 v[44:47], a[196:199], v[80:83], v[44:47]
    v_mfma_f32_16x16x32_bf16 v[56:59], v[80:83], v[132:135], v[56:59]
    v_mfma_f32_16x16x32_bf16 v[60:63], v[80:83], v[196:199], v[60:63]
    v_mfma_f32_16x16x32_bf16 v[32:35], a[4:7], v[84:87], v[32:35]
    v_mfma_f32_16x16x32_bf16 v[36:39], a[68:71], v[84:87], v[36:39]
    v_mfma_f32_16x16x32_bf16 v[48:51], a[132:135], v[84:87], v[48:51]
    v_mfma_f32_16x16x32_bf16 v[52:55], a[196:199], v[84:87], v[52:55]
    v_mfma_f32_16x16x32_bf16 v[64:67], v[84:87], v[132:135], v[64:67]
    v_mfma_f32_16x16x32_bf16 v[68:71], v[84:87], v[196:199], v[68:71]
    ds_read_b128 v[80:83], v4 offset:256
    ds_read_b128 v[84:87], v4 offset:16640
    s_waitcnt lgkmcnt(6)
    v_mfma_f32_16x16x32_bf16 v[24:27], a[8:11], v[88:91], v[24:27]
    v_mfma_f32_16x16x32_bf16 v[28:31], a[72:75], v[88:91], v[28:31]
    v_mfma_f32_16x16x32_bf16 v[40:43], a[136:139], v[88:91], v[40:43]
    v_mfma_f32_16x16x32_bf16 v[44:47], a[200:203], v[88:91], v[44:47]
    v_mfma_f32_16x16x32_bf16 v[56:59], v[88:91], v[136:139], v[56:59]
    v_mfma_f32_16x16x32_bf16 v[60:63], v[88:91], v[200:203], v[60:63]
    v_mfma_f32_16x16x32_bf16 v[32:35], a[8:11], v[92:95], v[32:35]
    v_mfma_f32_16x16x32_bf16 v[36:39], a[72:75], v[92:95], v[36:39]
    v_mfma_f32_16x16x32_bf16 v[48:51], a[136:139], v[92:95], v[48:51]
    v_mfma_f32_16x16x32_bf16 v[52:55], a[200:203], v[92:95], v[52:55]
    v_mfma_f32_16x16x32_bf16 v[64:67], v[92:95], v[136:139], v[64:67]
    v_mfma_f32_16x16x32_bf16 v[68:71], v[92:95], v[200:203], v[68:71]
    ds_read_b128 v[88:91], v5 offset:256
    ds_read_b128 v[92:95], v5 offset:16640
    s_waitcnt lgkmcnt(6)
    v_mfma_f32_16x16x32_bf16 v[24:27], a[12:15], v[96:99], v[24:27]
    v_mfma_f32_16x16x32_bf16 v[28:31], a[76:79], v[96:99], v[28:31]
    v_mfma_f32_16x16x32_bf16 v[40:43], a[140:143], v[96:99], v[40:43]
    v_mfma_f32_16x16x32_bf16 v[44:47], a[204:207], v[96:99], v[44:47]
    v_mfma_f32_16x16x32_bf16 v[56:59], v[96:99], v[140:143], v[56:59]
    v_mfma_f32_16x16x32_bf16 v[60:63], v[96:99], v[204:207], v[60:63]
    v_mfma_f32_16x16x32_bf16 v[32:35], a[12:15], v[100:103], v[32:35]
    v_mfma_f32_16x16x32_bf16 v[36:39], a[76:79], v[100:103], v[36:39]
    v_mfma_f32_16x16x32_bf16 v[48:51], a[140:143], v[100:103], v[48:51]
    v_mfma_f32_16x16x32_bf16 v[52:55], a[204:207], v[100:103], v[52:55]
    v_mfma_f32_16x16x32_bf16 v[64:67], v[100:103], v[140:143], v[64:67]
    v_mfma_f32_16x16x32_bf16 v[68:71], v[100:103], v[204:207], v[68:71]
    ds_read_b128 v[96:99], v6 offset:256
    ds_read_b128 v[100:103], v6 offset:16640
    s_waitcnt lgkmcnt(6)
    v_mfma_f32_16x16x32_bf16 v[24:27], a[16:19], v[72:75], v[24:27]
    v_mfma_f32_16x16x32_bf16 v[28:31], a[80:83], v[72:75], v[28:31]
    v_mfma_f32_16x16x32_bf16 v[40:43], a[144:147], v[72:75], v[40:43]
    v_mfma_f32_16x16x32_bf16 v[44:47], a[208:211], v[72:75], v[44:47]
    v_mfma_f32_16x16x32_bf16 v[56:59], v[72:75], v[144:147], v[56:59]
    v_mfma_f32_16x16x32_bf16 v[60:63], v[72:75], v[208:211], v[60:63]
    v_mfma_f32_16x16x32_bf16 v[32:35], a[16:19], v[76:79], v[32:35]
    v_mfma_f32_16x16x32_bf16 v[36:39], a[80:83], v[76:79], v[36:39]
    v_mfma_f32_16x16x32_bf16 v[48:51], a[144:147], v[76:79], v[48:51]
    v_mfma_f32_16x16x32_bf16 v[52:55], a[208:211], v[76:79], v[52:55]
    v_mfma_f32_16x16x32_bf16 v[64:67], v[76:79], v[144:147], v[64:67]
    v_mfma_f32_16x16x32_bf16 v[68:71], v[76:79], v[208:211], v[68:71]
    ds_read_b128 v[72:75], v3 offset:512
    ds_read_b128 v[76:79], v3 offset:16896
    s_waitcnt lgkmcnt(6)
    v_mfma_f32_16x16x32_bf16 v[24:27], a[20:23], v[80:83], v[24:27]
    v_mfma_f32_16x16x32_bf16 v[28:31], a[84:87], v[80:83], v[28:31]
    v_mfma_f32_16x16x32_bf16 v[40:43], a[148:151], v[80:83], v[40:43]
    v_mfma_f32_16x16x32_bf16 v[44:47], a[212:215], v[80:83], v[44:47]
    v_mfma_f32_16x16x32_bf16 v[56:59], v[80:83], v[148:151], v[56:59]
    v_mfma_f32_16x16x32_bf16 v[60:63], v[80:83], v[212:215], v[60:63]
    v_mfma_f32_16x16x32_bf16 v[32:35], a[20:23], v[84:87], v[32:35]
    v_mfma_f32_16x16x32_bf16 v[36:39], a[84:87], v[84:87], v[36:39]
    v_mfma_f32_16x16x32_bf16 v[48:51], a[148:151], v[84:87], v[48:51]
    v_mfma_f32_16x16x32_bf16 v[52:55], a[212:215], v[84:87], v[52:55]
    v_mfma_f32_16x16x32_bf16 v[64:67], v[84:87], v[148:151], v[64:67]
    v_mfma_f32_16x16x32_bf16 v[68:71], v[84:87], v[212:215], v[68:71]
    ds_read_b128 v[80:83], v4 offset:512
    ds_read_b128 v[84:87], v4 offset:16896
    s_waitcnt lgkmcnt(6)
    v_mfma_f32_16x16x32_bf16 v[24:27], a[24:27], v[88:91], v[24:27]
    v_mfma_f32_16x16x32_bf16 v[28:31], a[88:91], v[88:91], v[28:31]
    v_mfma_f32_16x16x32_bf16 v[40:43], a[152:155], v[88:91], v[40:43]
    v_mfma_f32_16x16x32_bf16 v[44:47], a[216:219], v[88:91], v[44:47]
    v_mfma_f32_16x16x32_bf16 v[56:59], v[88:91], v[152:155], v[56:59]
    v_mfma_f32_16x16x32_bf16 v[60:63], v[88:91], v[216:219], v[60:63]
    v_mfma_f32_16x16x32_bf16 v[32:35], a[24:27], v[92:95], v[32:35]
    v_mfma_f32_16x16x32_bf16 v[36:39], a[88:91], v[92:95], v[36:39]
    v_mfma_f32_16x16x32_bf16 v[48:51], a[152:155], v[92:95], v[48:51]
    v_mfma_f32_16x16x32_bf16 v[52:55], a[216:219], v[92:95], v[52:55]
    v_mfma_f32_16x16x32_bf16 v[64:67], v[92:95], v[152:155], v[64:67]
    v_mfma_f32_16x16x32_bf16 v[68:71], v[92:95], v[216:219], v[68:71]
    ds_read_b128 v[88:91], v5 offset:512
    ds_read_b128 v[92:95], v5 offset:16896
    s_waitcnt lgkmcnt(6)
    v_mfma_f32_16x16x32_bf16 v[24:27], a[28:31], v[96:99], v[24:27]
    v_mfma_f32_16x16x32_bf16 v[28:31], a[92:95], v[96:99], v[28:31]
    v_mfma_f32_16x16x32_bf16 v[40:43], a[156:159], v[96:99], v[40:43]
    v_mfma_f32_16x16x32_bf16 v[44:47], a[220:223], v[96:99], v[44:47]
    v_mfma_f32_16x16x32_bf16 v[56:59], v[96:99], v[156:159], v[56:59]
    v_mfma_f32_16x16x32_bf16 v[60:63], v[96:99], v[220:223], v[60:63]
    v_mfma_f32_16x16x32_bf16 v[32:35], a[28:31], v[100:103], v[32:35]
    v_mfma_f32_16x16x32_bf16 v[36:39], a[92:95], v[100:103], v[36:39]
    v_mfma_f32_16x16x32_bf16 v[48:51], a[156:159], v[100:103], v[48:51]
    v_mfma_f32_16x16x32_bf16 v[52:55], a[220:223], v[100:103], v[52:55]
    v_mfma_f32_16x16x32_bf16 v[64:67], v[100:103], v[156:159], v[64:67]
    v_mfma_f32_16x16x32_bf16 v[68:71], v[100:103], v[220:223], v[68:71]
    ds_read_b128 v[96:99], v6 offset:512
    ds_read_b128 v[100:103], v6 offset:16896
    s_waitcnt lgkmcnt(6)
    v_mfma_f32_16x16x32_bf16 v[24:27], a[32:35], v[72:75], v[24:27]
    v_mfma_f32_16x16x32_bf16 v[28:31], a[96:99], v[72:75], v[28:31]
    v_mfma_f32_16x16x32_bf16 v[40:43], a[160:163], v[72:75], v[40:43]
    v_mfma_f32_16x16x32_bf16 v[44:47], a[224:227], v[72:75], v[44:47]
    v_mfma_f32_16x16x32_bf16 v[56:59], v[72:75], v[160:163], v[56:59]
    v_mfma_f32_16x16x32_bf16 v[60:63], v[72:75], v[224:227], v[60:63]
    v_mfma_f32_16x16x32_bf16 v[32:35], a[32:35], v[76:79], v[32:35]
    v_mfma_f32_16x16x32_bf16 v[36:39], a[96:99], v[76:79], v[36:39]
    v_mfma_f32_16x16x32_bf16 v[48:51], a[160:163], v[76:79], v[48:51]
    v_mfma_f32_16x16x32_bf16 v[52:55], a[224:227], v[76:79], v[52:55]
    v_mfma_f32_16x16x32_bf16 v[64:67], v[76:79], v[160:163], v[64:67]
    v_mfma_f32_16x16x32_bf16 v[68:71], v[76:79], v[224:227], v[68:71]
    ds_read_b128 v[72:75], v3 offset:768
    ds_read_b128 v[76:79], v3 offset:17152
    s_waitcnt lgkmcnt(6)
    v_mfma_f32_16x16x32_bf16 v[24:27], a[36:39], v[80:83], v[24:27]
    v_mfma_f32_16x16x32_bf16 v[28:31], a[100:103], v[80:83], v[28:31]
    v_mfma_f32_16x16x32_bf16 v[40:43], a[164:167], v[80:83], v[40:43]
    v_mfma_f32_16x16x32_bf16 v[44:47], a[228:231], v[80:83], v[44:47]
    v_mfma_f32_16x16x32_bf16 v[56:59], v[80:83], v[164:167], v[56:59]
    v_mfma_f32_16x16x32_bf16 v[60:63], v[80:83], v[228:231], v[60:63]
    v_mfma_f32_16x16x32_bf16 v[32:35], a[36:39], v[84:87], v[32:35]
    v_mfma_f32_16x16x32_bf16 v[36:39], a[100:103], v[84:87], v[36:39]
    v_mfma_f32_16x16x32_bf16 v[48:51], a[164:167], v[84:87], v[48:51]
    v_mfma_f32_16x16x32_bf16 v[52:55], a[228:231], v[84:87], v[52:55]
    v_mfma_f32_16x16x32_bf16 v[64:67], v[84:87], v[164:167], v[64:67]
    v_mfma_f32_16x16x32_bf16 v[68:71], v[84:87], v[228:231], v[68:71]
    ds_read_b128 v[80:83], v4 offset:768
    ds_read_b128 v[84:87], v4 offset:17152
    s_waitcnt lgkmcnt(6)
    v_mfma_f32_16x16x32_bf16 v[24:27], a[40:43], v[88:91], v[24:27]
    v_mfma_f32_16x16x32_bf16 v[28:31], a[104:107], v[88:91], v[28:31]
    v_mfma_f32_16x16x32_bf16 v[40:43], a[168:171], v[88:91], v[40:43]
    v_mfma_f32_16x16x32_bf16 v[44:47], a[232:235], v[88:91], v[44:47]
    v_mfma_f32_16x16x32_bf16 v[56:59], v[88:91], v[168:171], v[56:59]
    v_mfma_f32_16x16x32_bf16 v[60:63], v[88:91], v[232:235], v[60:63]
    v_mfma_f32_16x16x32_bf16 v[32:35], a[40:43], v[92:95], v[32:35]
    v_mfma_f32_16x16x32_bf16 v[36:39], a[104:107], v[92:95], v[36:39]
    v_mfma_f32_16x16x32_bf16 v[48:51], a[168:171], v[92:95], v[48:51]
    v_mfma_f32_16x16x32_bf16 v[52:55], a[232:235], v[92:95], v[52:55]
    v_mfma_f32_16x16x32_bf16 v[64:67], v[92:95], v[168:171], v[64:67]
    v_mfma_f32_16x16x32_bf16 v[68:71], v[92:95], v[232:235], v[68:71]
    ds_read_b128 v[88:91], v5 offset:768
    ds_read_b128 v[92:95], v5 offset:17152
    s_waitcnt lgkmcnt(6)
    v_mfma_f32_16x16x32_bf16 v[24:27], a[44:47], v[96:99], v[24:27]
    v_mfma_f32_16x16x32_bf16 v[28:31], a[108:111], v[96:99], v[28:31]
    v_mfma_f32_16x16x32_bf16 v[40:43], a[172:175], v[96:99], v[40:43]
    v_mfma_f32_16x16x32_bf16 v[44:47], a[236:239], v[96:99], v[44:47]
    v_mfma_f32_16x16x32_bf16 v[56:59], v[96:99], v[172:175], v[56:59]
    v_mfma_f32_16x16x32_bf16 v[60:63], v[96:99], v[236:239], v[60:63]
    v_mfma_f32_16x16x32_bf16 v[32:35], a[44:47], v[100:103], v[32:35]
    v_mfma_f32_16x16x32_bf16 v[36:39], a[108:111], v[100:103], v[36:39]
    v_mfma_f32_16x16x32_bf16 v[48:51], a[172:175], v[100:103], v[48:51]
    v_mfma_f32_16x16x32_bf16 v[52:55], a[236:239], v[100:103], v[52:55]
    v_mfma_f32_16x16x32_bf16 v[64:67], v[100:103], v[172:175], v[64:67]
    v_mfma_f32_16x16x32_bf16 v[68:71], v[100:103], v[236:239], v[68:71]
    ds_read_b128 v[96:99], v6 offset:768
    ds_read_b128 v[100:103], v6 offset:17152
    s_waitcnt lgkmcnt(6)
    v_mfma_f32_16x16x32_bf16 v[24:27], a[48:51], v[72:75], v[24:27]
    v_mfma_f32_16x16x32_bf16 v[28:31], a[112:115], v[72:75], v[28:31]
    v_mfma_f32_16x16x32_bf16 v[40:43], a[176:179], v[72:75], v[40:43]
    v_mfma_f32_16x16x32_bf16 v[44:47], a[240:243], v[72:75], v[44:47]
    v_mfma_f32_16x16x32_bf16 v[56:59], v[72:75], v[176:179], v[56:59]
    v_mfma_f32_16x16x32_bf16 v[60:63], v[72:75], v[240:243], v[60:63]
    v_mfma_f32_16x16x32_bf16 v[32:35], a[48:51], v[76:79], v[32:35]
    v_mfma_f32_16x16x32_bf16 v[36:39], a[112:115], v[76:79], v[36:39]
    v_mfma_f32_16x16x32_bf16 v[48:51], a[176:179], v[76:79], v[48:51]
    v_mfma_f32_16x16x32_bf16 v[52:55], a[240:243], v[76:79], v[52:55]
    v_mfma_f32_16x16x32_bf16 v[64:67], v[76:79], v[176:179], v[64:67]
    v_mfma_f32_16x16x32_bf16 v[68:71], v[76:79], v[240:243], v[68:71]
    s_waitcnt lgkmcnt(4)
    v_mfma_f32_16x16x32_bf16 v[24:27], a[52:55], v[80:83], v[24:27]
    v_mfma_f32_16x16x32_bf16 v[28:31], a[116:119], v[80:83], v[28:31]
    v_mfma_f32_16x16x32_bf16 v[40:43], a[180:183], v[80:83], v[40:43]
    v_mfma_f32_16x16x32_bf16 v[44:47], a[244:247], v[80:83], v[44:47]
    v_mfma_f32_16x16x32_bf16 v[56:59], v[80:83], v[180:183], v[56:59]
    v_mfma_f32_16x16x32_bf16 v[60:63], v[80:83], v[244:247], v[60:63]
    v_mfma_f32_16x16x32_bf16 v[32:35], a[52:55], v[84:87], v[32:35]
    v_mfma_f32_16x16x32_bf16 v[36:39], a[116:119], v[84:87], v[36:39]
    v_mfma_f32_16x16x32_bf16 v[48:51], a[180:183], v[84:87], v[48:51]
    v_mfma_f32_16x16x32_bf16 v[52:55], a[244:247], v[84:87], v[52:55]
    v_mfma_f32_16x16x32_bf16 v[64:67], v[84:87], v[180:183], v[64:67]
    v_mfma_f32_16x16x32_bf16 v[68:71], v[84:87], v[244:247], v[68:71]
    s_waitcnt lgkmcnt(2)
    v_mfma_f32_16x16x32_bf16 v[24:27], a[56:59], v[88:91], v[24:27]
    v_mfma_f32_16x16x32_bf16 v[28:31], a[120:123], v[88:91], v[28:31]
    v_mfma_f32_16x16x32_bf16 v[40:43], a[184:187], v[88:91], v[40:43]
    v_mfma_f32_16x16x32_bf16 v[44:47], a[248:251], v[88:91], v[44:47]
    v_mfma_f32_16x16x32_bf16 v[56:59], v[88:91], v[184:187], v[56:59]
    v_mfma_f32_16x16x32_bf16 v[60:63], v[88:91], v[248:251], v[60:63]
    v_mfma_f32_16x16x32_bf16 v[32:35], a[56:59], v[92:95], v[32:35]
    v_mfma_f32_16x16x32_bf16 v[36:39], a[120:123], v[92:95], v[36:39]
    v_mfma_f32_16x16x32_bf16 v[48:51], a[184:187], v[92:95], v[48:51]
    v_mfma_f32_16x16x32_bf16 v[52:55], a[248:251], v[92:95], v[52:55]
    v_mfma_f32_16x16x32_bf16 v[64:67], v[92:95], v[184:187], v[64:67]
    v_mfma_f32_16x16x32_bf16 v[68:71], v[92:95], v[248:251], v[68:71]
    s_waitcnt lgkmcnt(0)
    v_mfma_f32_16x16x32_bf16 v[24:27], a[60:63], v[96:99], v[24:27]
    v_mfma_f32_16x16x32_bf16 v[28:31], a[124:127], v[96:99], v[28:31]
    v_mfma_f32_16x16x32_bf16 v[40:43], a[188:191], v[96:99], v[40:43]
    v_mfma_f32_16x16x32_bf16 v[44:47], a[252:255], v[96:99], v[44:47]
    v_mfma_f32_16x16x32_bf16 v[56:59], v[96:99], v[188:191], v[56:59]
    v_mfma_f32_16x16x32_bf16 v[60:63], v[96:99], v[252:255], v[60:63]
    v_mfma_f32_16x16x32_bf16 v[32:35], a[60:63], v[100:103], v[32:35]
    v_mfma_f32_16x16x32_bf16 v[36:39], a[124:127], v[100:103], v[36:39]
    v_mfma_f32_16x16x32_bf16 v[48:51], a[188:191], v[100:103], v[48:51]
    v_mfma_f32_16x16x32_bf16 v[52:55], a[252:255], v[100:103], v[52:55]
    v_mfma_f32_16x16x32_bf16 v[64:67], v[100:103], v[188:191], v[64:67]
    v_mfma_f32_16x16x32_bf16 v[68:71], v[100:103], v[252:255], v[68:71]
    s_add_u32 s23, s31, 0
    s_mul_i32 s23, s23, 786432
    s_add_u32 s23, s23, s53
    v_add_u32 v22, s23, v7
    v_cvt_pk_bf16_f32 v104, v24, v25
    v_cvt_pk_bf16_f32 v105, v26, v27
    v_cvt_pk_bf16_f32 v106, v28, v29
    v_cvt_pk_bf16_f32 v107, v30, v31
    v_add_u32 v23, 0, v22
    global_store_dwordx4 v23, v[104:107], s[4:5] sc1
    v_cvt_pk_bf16_f32 v108, v32, v33
    v_cvt_pk_bf16_f32 v109, v34, v35
    v_cvt_pk_bf16_f32 v110, v36, v37
    v_cvt_pk_bf16_f32 v111, v38, v39
    v_add_u32 v23, 4096, v22
    global_store_dwordx4 v23, v[108:111], s[4:5] sc1
    v_cvt_pk_bf16_f32 v112, v40, v41
    v_cvt_pk_bf16_f32 v113, v42, v43
    v_cvt_pk_bf16_f32 v114, v44, v45
    v_cvt_pk_bf16_f32 v115, v46, v47
    v_add_u32 v23, 8192, v22
    global_store_dwordx4 v23, v[112:115], s[4:5] sc1
    v_cvt_pk_bf16_f32 v116, v48, v49
    v_cvt_pk_bf16_f32 v117, v50, v51
    v_cvt_pk_bf16_f32 v118, v52, v53
    v_cvt_pk_bf16_f32 v119, v54, v55
    v_add_u32 v23, 12288, v22
    global_store_dwordx4 v23, v[116:119], s[4:5] sc1
    s_lshl_b32 s24, s20, 10
    v_add_u32 v22, s24, v22
    v_add_u32 v22, 16384, v22
    v_cvt_pk_bf16_f32 v120, v56, v57
    v_cvt_pk_bf16_f32 v121, v58, v59
    v_cvt_pk_bf16_f32 v122, v64, v65
    v_cvt_pk_bf16_f32 v123, v66, v67
    global_store_dwordx4 v22, v[120:123], s[4:5] offset:0 sc1
    v_cvt_pk_bf16_f32 v8, v60, v61
    v_cvt_pk_bf16_f32 v9, v62, v63
    v_cvt_pk_bf16_f32 v10, v68, v69
    v_cvt_pk_bf16_f32 v11, v70, v71
    global_store_dwordx4 v22, v[8:11], s[4:5] offset:1024 sc1
    ds_read_b128 v[72:75], v3 offset:32768
    ds_read_b128 v[76:79], v3 offset:49152
    ds_read_b128 v[80:83], v4 offset:32768
    ds_read_b128 v[84:87], v4 offset:49152
    ds_read_b128 v[88:91], v5 offset:32768
    ds_read_b128 v[92:95], v5 offset:49152
    ds_read_b128 v[96:99], v6 offset:32768
    ds_read_b128 v[100:103], v6 offset:49152
    s_waitcnt lgkmcnt(6)
    v_mfma_f32_16x16x32_bf16 v[24:27], a[0:3], v[72:75], 0
    v_mfma_f32_16x16x32_bf16 v[28:31], a[64:67], v[72:75], 0
    v_mfma_f32_16x16x32_bf16 v[40:43], a[128:131], v[72:75], 0
    v_mfma_f32_16x16x32_bf16 v[44:47], a[192:195], v[72:75], 0
    v_mfma_f32_16x16x32_bf16 v[56:59], v[72:75], v[128:131], 0
    v_mfma_f32_16x16x32_bf16 v[60:63], v[72:75], v[192:195], 0
    v_mfma_f32_16x16x32_bf16 v[32:35], a[0:3], v[76:79], 0
    v_mfma_f32_16x16x32_bf16 v[36:39], a[64:67], v[76:79], 0
    v_mfma_f32_16x16x32_bf16 v[48:51], a[128:131], v[76:79], 0
    v_mfma_f32_16x16x32_bf16 v[52:55], a[192:195], v[76:79], 0
    v_mfma_f32_16x16x32_bf16 v[64:67], v[76:79], v[128:131], 0
    v_mfma_f32_16x16x32_bf16 v[68:71], v[76:79], v[192:195], 0
    ds_read_b128 v[72:75], v3 offset:33024
    ds_read_b128 v[76:79], v3 offset:49408
    s_waitcnt lgkmcnt(6)
    v_mfma_f32_16x16x32_bf16 v[24:27], a[4:7], v[80:83], v[24:27]
    v_mfma_f32_16x16x32_bf16 v[28:31], a[68:71], v[80:83], v[28:31]
    v_mfma_f32_16x16x32_bf16 v[40:43], a[132:135], v[80:83], v[40:43]
    v_mfma_f32_16x16x32_bf16 v[44:47], a[196:199], v[80:83], v[44:47]
    v_mfma_f32_16x16x32_bf16 v[56:59], v[80:83], v[132:135], v[56:59]
    v_mfma_f32_16x16x32_bf16 v[60:63], v[80:83], v[196:199], v[60:63]
    v_mfma_f32_16x16x32_bf16 v[32:35], a[4:7], v[84:87], v[32:35]
    v_mfma_f32_16x16x32_bf16 v[36:39], a[68:71], v[84:87], v[36:39]
    v_mfma_f32_16x16x32_bf16 v[48:51], a[132:135], v[84:87], v[48:51]
    v_mfma_f32_16x16x32_bf16 v[52:55], a[196:199], v[84:87], v[52:55]
    v_mfma_f32_16x16x32_bf16 v[64:67], v[84:87], v[132:135], v[64:67]
    v_mfma_f32_16x16x32_bf16 v[68:71], v[84:87], v[196:199], v[68:71]
    ds_read_b128 v[80:83], v4 offset:33024
    ds_read_b128 v[84:87], v4 offset:49408
    s_waitcnt lgkmcnt(6)
    v_mfma_f32_16x16x32_bf16 v[24:27], a[8:11], v[88:91], v[24:27]
    v_mfma_f32_16x16x32_bf16 v[28:31], a[72:75], v[88:91], v[28:31]
    v_mfma_f32_16x16x32_bf16 v[40:43], a[136:139], v[88:91], v[40:43]
    v_mfma_f32_16x16x32_bf16 v[44:47], a[200:203], v[88:91], v[44:47]
    v_mfma_f32_16x16x32_bf16 v[56:59], v[88:91], v[136:139], v[56:59]
    v_mfma_f32_16x16x32_bf16 v[60:63], v[88:91], v[200:203], v[60:63]
    v_mfma_f32_16x16x32_bf16 v[32:35], a[8:11], v[92:95], v[32:35]
    v_mfma_f32_16x16x32_bf16 v[36:39], a[72:75], v[92:95], v[36:39]
    v_mfma_f32_16x16x32_bf16 v[48:51], a[136:139], v[92:95], v[48:51]
    v_mfma_f32_16x16x32_bf16 v[52:55], a[200:203], v[92:95], v[52:55]
    v_mfma_f32_16x16x32_bf16 v[64:67], v[92:95], v[136:139], v[64:67]
    v_mfma_f32_16x16x32_bf16 v[68:71], v[92:95], v[200:203], v[68:71]
    ds_read_b128 v[88:91], v5 offset:33024
    ds_read_b128 v[92:95], v5 offset:49408
    s_waitcnt vmcnt(0)
    s_add_u32 s23, s31, 0
    s_lshl_b32 s23, s23, 7
    s_add_u32 s23, s23, s52
    s_lshl_b32 s23, s23, 2
    v_mov_b32 v124, s23
    v_mov_b32 v125, 1
    global_store_dword v124, v125, s[4:5] offset:0 sc1
    s_waitcnt lgkmcnt(6)
    v_mfma_f32_16x16x32_bf16 v[24:27], a[12:15], v[96:99], v[24:27]
    v_mfma_f32_16x16x32_bf16 v[28:31], a[76:79], v[96:99], v[28:31]
    v_mfma_f32_16x16x32_bf16 v[40:43], a[140:143], v[96:99], v[40:43]
    v_mfma_f32_16x16x32_bf16 v[44:47], a[204:207], v[96:99], v[44:47]
    v_mfma_f32_16x16x32_bf16 v[56:59], v[96:99], v[140:143], v[56:59]
    v_mfma_f32_16x16x32_bf16 v[60:63], v[96:99], v[204:207], v[60:63]
    v_mfma_f32_16x16x32_bf16 v[32:35], a[12:15], v[100:103], v[32:35]
    v_mfma_f32_16x16x32_bf16 v[36:39], a[76:79], v[100:103], v[36:39]
    v_mfma_f32_16x16x32_bf16 v[48:51], a[140:143], v[100:103], v[48:51]
    v_mfma_f32_16x16x32_bf16 v[52:55], a[204:207], v[100:103], v[52:55]
    v_mfma_f32_16x16x32_bf16 v[64:67], v[100:103], v[140:143], v[64:67]
    v_mfma_f32_16x16x32_bf16 v[68:71], v[100:103], v[204:207], v[68:71]
    ds_read_b128 v[96:99], v6 offset:33024
    ds_read_b128 v[100:103], v6 offset:49408
    s_waitcnt lgkmcnt(6)
    v_mfma_f32_16x16x32_bf16 v[24:27], a[16:19], v[72:75], v[24:27]
    v_mfma_f32_16x16x32_bf16 v[28:31], a[80:83], v[72:75], v[28:31]
    v_mfma_f32_16x16x32_bf16 v[40:43], a[144:147], v[72:75], v[40:43]
    v_mfma_f32_16x16x32_bf16 v[44:47], a[208:211], v[72:75], v[44:47]
    v_mfma_f32_16x16x32_bf16 v[56:59], v[72:75], v[144:147], v[56:59]
    v_mfma_f32_16x16x32_bf16 v[60:63], v[72:75], v[208:211], v[60:63]
    v_mfma_f32_16x16x32_bf16 v[32:35], a[16:19], v[76:79], v[32:35]
    v_mfma_f32_16x16x32_bf16 v[36:39], a[80:83], v[76:79], v[36:39]
    v_mfma_f32_16x16x32_bf16 v[48:51], a[144:147], v[76:79], v[48:51]
    v_mfma_f32_16x16x32_bf16 v[52:55], a[208:211], v[76:79], v[52:55]
    v_mfma_f32_16x16x32_bf16 v[64:67], v[76:79], v[144:147], v[64:67]
    v_mfma_f32_16x16x32_bf16 v[68:71], v[76:79], v[208:211], v[68:71]
    ds_read_b128 v[72:75], v3 offset:33280
    ds_read_b128 v[76:79], v3 offset:49664
    s_waitcnt lgkmcnt(6)
    v_mfma_f32_16x16x32_bf16 v[24:27], a[20:23], v[80:83], v[24:27]
    v_mfma_f32_16x16x32_bf16 v[28:31], a[84:87], v[80:83], v[28:31]
    v_mfma_f32_16x16x32_bf16 v[40:43], a[148:151], v[80:83], v[40:43]
    v_mfma_f32_16x16x32_bf16 v[44:47], a[212:215], v[80:83], v[44:47]
    v_mfma_f32_16x16x32_bf16 v[56:59], v[80:83], v[148:151], v[56:59]
    v_mfma_f32_16x16x32_bf16 v[60:63], v[80:83], v[212:215], v[60:63]
    v_mfma_f32_16x16x32_bf16 v[32:35], a[20:23], v[84:87], v[32:35]
    v_mfma_f32_16x16x32_bf16 v[36:39], a[84:87], v[84:87], v[36:39]
    v_mfma_f32_16x16x32_bf16 v[48:51], a[148:151], v[84:87], v[48:51]
    v_mfma_f32_16x16x32_bf16 v[52:55], a[212:215], v[84:87], v[52:55]
    v_mfma_f32_16x16x32_bf16 v[64:67], v[84:87], v[148:151], v[64:67]
    v_mfma_f32_16x16x32_bf16 v[68:71], v[84:87], v[212:215], v[68:71]
    ds_read_b128 v[80:83], v4 offset:33280
    ds_read_b128 v[84:87], v4 offset:49664
    s_waitcnt lgkmcnt(6)
    v_mfma_f32_16x16x32_bf16 v[24:27], a[24:27], v[88:91], v[24:27]
    v_mfma_f32_16x16x32_bf16 v[28:31], a[88:91], v[88:91], v[28:31]
    v_mfma_f32_16x16x32_bf16 v[40:43], a[152:155], v[88:91], v[40:43]
    v_mfma_f32_16x16x32_bf16 v[44:47], a[216:219], v[88:91], v[44:47]
    v_mfma_f32_16x16x32_bf16 v[56:59], v[88:91], v[152:155], v[56:59]
    v_mfma_f32_16x16x32_bf16 v[60:63], v[88:91], v[216:219], v[60:63]
    v_mfma_f32_16x16x32_bf16 v[32:35], a[24:27], v[92:95], v[32:35]
    v_mfma_f32_16x16x32_bf16 v[36:39], a[88:91], v[92:95], v[36:39]
    v_mfma_f32_16x16x32_bf16 v[48:51], a[152:155], v[92:95], v[48:51]
    v_mfma_f32_16x16x32_bf16 v[52:55], a[216:219], v[92:95], v[52:55]
    v_mfma_f32_16x16x32_bf16 v[64:67], v[92:95], v[152:155], v[64:67]
    v_mfma_f32_16x16x32_bf16 v[68:71], v[92:95], v[216:219], v[68:71]
    ds_read_b128 v[88:91], v5 offset:33280
    ds_read_b128 v[92:95], v5 offset:49664
    s_waitcnt lgkmcnt(6)
    v_mfma_f32_16x16x32_bf16 v[24:27], a[28:31], v[96:99], v[24:27]
    v_mfma_f32_16x16x32_bf16 v[28:31], a[92:95], v[96:99], v[28:31]
    v_mfma_f32_16x16x32_bf16 v[40:43], a[156:159], v[96:99], v[40:43]
    v_mfma_f32_16x16x32_bf16 v[44:47], a[220:223], v[96:99], v[44:47]
    v_mfma_f32_16x16x32_bf16 v[56:59], v[96:99], v[156:159], v[56:59]
    v_mfma_f32_16x16x32_bf16 v[60:63], v[96:99], v[220:223], v[60:63]
    v_mfma_f32_16x16x32_bf16 v[32:35], a[28:31], v[100:103], v[32:35]
    v_mfma_f32_16x16x32_bf16 v[36:39], a[92:95], v[100:103], v[36:39]
    v_mfma_f32_16x16x32_bf16 v[48:51], a[156:159], v[100:103], v[48:51]
    v_mfma_f32_16x16x32_bf16 v[52:55], a[220:223], v[100:103], v[52:55]
    v_mfma_f32_16x16x32_bf16 v[64:67], v[100:103], v[156:159], v[64:67]
    v_mfma_f32_16x16x32_bf16 v[68:71], v[100:103], v[220:223], v[68:71]
    ds_read_b128 v[96:99], v6 offset:33280
    ds_read_b128 v[100:103], v6 offset:49664
    s_waitcnt lgkmcnt(6)
    v_mfma_f32_16x16x32_bf16 v[24:27], a[32:35], v[72:75], v[24:27]
    v_mfma_f32_16x16x32_bf16 v[28:31], a[96:99], v[72:75], v[28:31]
    v_mfma_f32_16x16x32_bf16 v[40:43], a[160:163], v[72:75], v[40:43]
    v_mfma_f32_16x16x32_bf16 v[44:47], a[224:227], v[72:75], v[44:47]
    v_mfma_f32_16x16x32_bf16 v[56:59], v[72:75], v[160:163], v[56:59]
    v_mfma_f32_16x16x32_bf16 v[60:63], v[72:75], v[224:227], v[60:63]
    v_mfma_f32_16x16x32_bf16 v[32:35], a[32:35], v[76:79], v[32:35]
    v_mfma_f32_16x16x32_bf16 v[36:39], a[96:99], v[76:79], v[36:39]
    v_mfma_f32_16x16x32_bf16 v[48:51], a[160:163], v[76:79], v[48:51]
    v_mfma_f32_16x16x32_bf16 v[52:55], a[224:227], v[76:79], v[52:55]
    v_mfma_f32_16x16x32_bf16 v[64:67], v[76:79], v[160:163], v[64:67]
    v_mfma_f32_16x16x32_bf16 v[68:71], v[76:79], v[224:227], v[68:71]
    ds_read_b128 v[72:75], v3 offset:33536
    ds_read_b128 v[76:79], v3 offset:49920
    s_waitcnt lgkmcnt(6)
    v_mfma_f32_16x16x32_bf16 v[24:27], a[36:39], v[80:83], v[24:27]
    v_mfma_f32_16x16x32_bf16 v[28:31], a[100:103], v[80:83], v[28:31]
    v_mfma_f32_16x16x32_bf16 v[40:43], a[164:167], v[80:83], v[40:43]
    v_mfma_f32_16x16x32_bf16 v[44:47], a[228:231], v[80:83], v[44:47]
    v_mfma_f32_16x16x32_bf16 v[56:59], v[80:83], v[164:167], v[56:59]
    v_mfma_f32_16x16x32_bf16 v[60:63], v[80:83], v[228:231], v[60:63]
    v_mfma_f32_16x16x32_bf16 v[32:35], a[36:39], v[84:87], v[32:35]
    v_mfma_f32_16x16x32_bf16 v[36:39], a[100:103], v[84:87], v[36:39]
    v_mfma_f32_16x16x32_bf16 v[48:51], a[164:167], v[84:87], v[48:51]
    v_mfma_f32_16x16x32_bf16 v[52:55], a[228:231], v[84:87], v[52:55]
    v_mfma_f32_16x16x32_bf16 v[64:67], v[84:87], v[164:167], v[64:67]
    v_mfma_f32_16x16x32_bf16 v[68:71], v[84:87], v[228:231], v[68:71]
    ds_read_b128 v[80:83], v4 offset:33536
    ds_read_b128 v[84:87], v4 offset:49920
    s_waitcnt lgkmcnt(6)
    v_mfma_f32_16x16x32_bf16 v[24:27], a[40:43], v[88:91], v[24:27]
    v_mfma_f32_16x16x32_bf16 v[28:31], a[104:107], v[88:91], v[28:31]
    v_mfma_f32_16x16x32_bf16 v[40:43], a[168:171], v[88:91], v[40:43]
    v_mfma_f32_16x16x32_bf16 v[44:47], a[232:235], v[88:91], v[44:47]
    v_mfma_f32_16x16x32_bf16 v[56:59], v[88:91], v[168:171], v[56:59]
    v_mfma_f32_16x16x32_bf16 v[60:63], v[88:91], v[232:235], v[60:63]
    v_mfma_f32_16x16x32_bf16 v[32:35], a[40:43], v[92:95], v[32:35]
    v_mfma_f32_16x16x32_bf16 v[36:39], a[104:107], v[92:95], v[36:39]
    v_mfma_f32_16x16x32_bf16 v[48:51], a[168:171], v[92:95], v[48:51]
    v_mfma_f32_16x16x32_bf16 v[52:55], a[232:235], v[92:95], v[52:55]
    v_mfma_f32_16x16x32_bf16 v[64:67], v[92:95], v[168:171], v[64:67]
    v_mfma_f32_16x16x32_bf16 v[68:71], v[92:95], v[232:235], v[68:71]
    ds_read_b128 v[88:91], v5 offset:33536
    ds_read_b128 v[92:95], v5 offset:49920
    s_waitcnt lgkmcnt(6)
    v_mfma_f32_16x16x32_bf16 v[24:27], a[44:47], v[96:99], v[24:27]
    v_mfma_f32_16x16x32_bf16 v[28:31], a[108:111], v[96:99], v[28:31]
    v_mfma_f32_16x16x32_bf16 v[40:43], a[172:175], v[96:99], v[40:43]
    v_mfma_f32_16x16x32_bf16 v[44:47], a[236:239], v[96:99], v[44:47]
    v_mfma_f32_16x16x32_bf16 v[56:59], v[96:99], v[172:175], v[56:59]
    v_mfma_f32_16x16x32_bf16 v[60:63], v[96:99], v[236:239], v[60:63]
    v_mfma_f32_16x16x32_bf16 v[32:35], a[44:47], v[100:103], v[32:35]
    v_mfma_f32_16x16x32_bf16 v[36:39], a[108:111], v[100:103], v[36:39]
    v_mfma_f32_16x16x32_bf16 v[48:51], a[172:175], v[100:103], v[48:51]
    v_mfma_f32_16x16x32_bf16 v[52:55], a[236:239], v[100:103], v[52:55]
    v_mfma_f32_16x16x32_bf16 v[64:67], v[100:103], v[172:175], v[64:67]
    v_mfma_f32_16x16x32_bf16 v[68:71], v[100:103], v[236:239], v[68:71]
    ds_read_b128 v[96:99], v6 offset:33536
    ds_read_b128 v[100:103], v6 offset:49920
    s_waitcnt lgkmcnt(6)
    v_mfma_f32_16x16x32_bf16 v[24:27], a[48:51], v[72:75], v[24:27]
    v_mfma_f32_16x16x32_bf16 v[28:31], a[112:115], v[72:75], v[28:31]
    v_mfma_f32_16x16x32_bf16 v[40:43], a[176:179], v[72:75], v[40:43]
    v_mfma_f32_16x16x32_bf16 v[44:47], a[240:243], v[72:75], v[44:47]
    v_mfma_f32_16x16x32_bf16 v[56:59], v[72:75], v[176:179], v[56:59]
    v_mfma_f32_16x16x32_bf16 v[60:63], v[72:75], v[240:243], v[60:63]
    v_mfma_f32_16x16x32_bf16 v[32:35], a[48:51], v[76:79], v[32:35]
    v_mfma_f32_16x16x32_bf16 v[36:39], a[112:115], v[76:79], v[36:39]
    v_mfma_f32_16x16x32_bf16 v[48:51], a[176:179], v[76:79], v[48:51]
    v_mfma_f32_16x16x32_bf16 v[52:55], a[240:243], v[76:79], v[52:55]
    v_mfma_f32_16x16x32_bf16 v[64:67], v[76:79], v[176:179], v[64:67]
    v_mfma_f32_16x16x32_bf16 v[68:71], v[76:79], v[240:243], v[68:71]
    s_waitcnt lgkmcnt(4)
    v_mfma_f32_16x16x32_bf16 v[24:27], a[52:55], v[80:83], v[24:27]
    v_mfma_f32_16x16x32_bf16 v[28:31], a[116:119], v[80:83], v[28:31]
    v_mfma_f32_16x16x32_bf16 v[40:43], a[180:183], v[80:83], v[40:43]
    v_mfma_f32_16x16x32_bf16 v[44:47], a[244:247], v[80:83], v[44:47]
    v_mfma_f32_16x16x32_bf16 v[56:59], v[80:83], v[180:183], v[56:59]
    v_mfma_f32_16x16x32_bf16 v[60:63], v[80:83], v[244:247], v[60:63]
    v_mfma_f32_16x16x32_bf16 v[32:35], a[52:55], v[84:87], v[32:35]
    v_mfma_f32_16x16x32_bf16 v[36:39], a[116:119], v[84:87], v[36:39]
    v_mfma_f32_16x16x32_bf16 v[48:51], a[180:183], v[84:87], v[48:51]
    v_mfma_f32_16x16x32_bf16 v[52:55], a[244:247], v[84:87], v[52:55]
    v_mfma_f32_16x16x32_bf16 v[64:67], v[84:87], v[180:183], v[64:67]
    v_mfma_f32_16x16x32_bf16 v[68:71], v[84:87], v[244:247], v[68:71]
    s_waitcnt lgkmcnt(2)
    v_mfma_f32_16x16x32_bf16 v[24:27], a[56:59], v[88:91], v[24:27]
    v_mfma_f32_16x16x32_bf16 v[28:31], a[120:123], v[88:91], v[28:31]
    v_mfma_f32_16x16x32_bf16 v[40:43], a[184:187], v[88:91], v[40:43]
    v_mfma_f32_16x16x32_bf16 v[44:47], a[248:251], v[88:91], v[44:47]
    v_mfma_f32_16x16x32_bf16 v[56:59], v[88:91], v[184:187], v[56:59]
    v_mfma_f32_16x16x32_bf16 v[60:63], v[88:91], v[248:251], v[60:63]
    v_mfma_f32_16x16x32_bf16 v[32:35], a[56:59], v[92:95], v[32:35]
    v_mfma_f32_16x16x32_bf16 v[36:39], a[120:123], v[92:95], v[36:39]
    v_mfma_f32_16x16x32_bf16 v[48:51], a[184:187], v[92:95], v[48:51]
    v_mfma_f32_16x16x32_bf16 v[52:55], a[248:251], v[92:95], v[52:55]
    v_mfma_f32_16x16x32_bf16 v[64:67], v[92:95], v[184:187], v[64:67]
    v_mfma_f32_16x16x32_bf16 v[68:71], v[92:95], v[248:251], v[68:71]
    s_waitcnt lgkmcnt(0)
    v_mfma_f32_16x16x32_bf16 v[24:27], a[60:63], v[96:99], v[24:27]
    v_mfma_f32_16x16x32_bf16 v[28:31], a[124:127], v[96:99], v[28:31]
    v_mfma_f32_16x16x32_bf16 v[40:43], a[188:191], v[96:99], v[40:43]
    v_mfma_f32_16x16x32_bf16 v[44:47], a[252:255], v[96:99], v[44:47]
    v_mfma_f32_16x16x32_bf16 v[56:59], v[96:99], v[188:191], v[56:59]
    v_mfma_f32_16x16x32_bf16 v[60:63], v[96:99], v[252:255], v[60:63]
    v_mfma_f32_16x16x32_bf16 v[32:35], a[60:63], v[100:103], v[32:35]
    v_mfma_f32_16x16x32_bf16 v[36:39], a[124:127], v[100:103], v[36:39]
    v_mfma_f32_16x16x32_bf16 v[48:51], a[188:191], v[100:103], v[48:51]
    v_mfma_f32_16x16x32_bf16 v[52:55], a[252:255], v[100:103], v[52:55]
    v_mfma_f32_16x16x32_bf16 v[64:67], v[100:103], v[188:191], v[64:67]
    v_mfma_f32_16x16x32_bf16 v[68:71], v[100:103], v[252:255], v[68:71]
    s_add_u32 s23, s31, 1
    s_mul_i32 s23, s23, 786432
    s_add_u32 s23, s23, s53
    v_add_u32 v22, s23, v7
    v_cvt_pk_bf16_f32 v104, v24, v25
    v_cvt_pk_bf16_f32 v105, v26, v27
    v_cvt_pk_bf16_f32 v106, v28, v29
    v_cvt_pk_bf16_f32 v107, v30, v31
    v_add_u32 v23, 0, v22
    global_store_dwordx4 v23, v[104:107], s[4:5] sc1
    v_cvt_pk_bf16_f32 v108, v32, v33
    v_cvt_pk_bf16_f32 v109, v34, v35
    v_cvt_pk_bf16_f32 v110, v36, v37
    v_cvt_pk_bf16_f32 v111, v38, v39
    v_add_u32 v23, 4096, v22
    global_store_dwordx4 v23, v[108:111], s[4:5] sc1
    v_cvt_pk_bf16_f32 v112, v40, v41
    v_cvt_pk_bf16_f32 v113, v42, v43
    v_cvt_pk_bf16_f32 v114, v44, v45
    v_cvt_pk_bf16_f32 v115, v46, v47
    v_add_u32 v23, 8192, v22
    global_store_dwordx4 v23, v[112:115], s[4:5] sc1
    v_cvt_pk_bf16_f32 v116, v48, v49
    v_cvt_pk_bf16_f32 v117, v50, v51
    v_cvt_pk_bf16_f32 v118, v52, v53
    v_cvt_pk_bf16_f32 v119, v54, v55
    v_add_u32 v23, 12288, v22
    global_store_dwordx4 v23, v[116:119], s[4:5] sc1
    s_lshl_b32 s24, s20, 10
    v_add_u32 v22, s24, v22
    v_add_u32 v22, 16384, v22
    v_cvt_pk_bf16_f32 v120, v56, v57
    v_cvt_pk_bf16_f32 v121, v58, v59
    v_cvt_pk_bf16_f32 v122, v64, v65
    v_cvt_pk_bf16_f32 v123, v66, v67
    global_store_dwordx4 v22, v[120:123], s[4:5] offset:0 sc1
    v_cvt_pk_bf16_f32 v8, v60, v61
    v_cvt_pk_bf16_f32 v9, v62, v63
    v_cvt_pk_bf16_f32 v10, v68, v69
    v_cvt_pk_bf16_f32 v11, v70, v71
    global_store_dwordx4 v22, v[8:11], s[4:5] offset:1024 sc1
    s_waitcnt vmcnt(0)
    s_add_u32 s23, s31, 1
    s_lshl_b32 s23, s23, 7
    s_add_u32 s23, s23, s52
    s_lshl_b32 s23, s23, 2
    v_mov_b32 v124, s23
    v_mov_b32 v125, 1
    global_store_dword v124, v125, s[4:5] offset:0 sc1
    s_add_u32 s30, s30, 1
    s_barrier
    s_branch LA_item
LA_done:
    s_waitcnt vmcnt(0)
    s_endpgm
LroleB:
    s_load_dwordx2 s[18:19], s[0:1], 40
    s_waitcnt lgkmcnt(0)
    v_and_b32 v1, 15, v0
    v_lshrrev_b32 v2, 4, v0
    v_lshlrev_b32 v7, 4, v0
    s_lshl_b32 s23, s21, 17
    s_lshl_b32 s24, s20, 15
    s_add_u32 s23, s23, s24
    v_add_u32 v24, s23, v7
    s_mul_i32 s24, s20, 33280
    v_add_u32 v25, s24, v7
    v_add_u32 v26, 0, v24
    v_add_u32 v27, 4096, v24
    global_load_dwordx4 v[32:35], v26, s[18:19] offset:0
    global_load_dwordx4 v[36:39], v26, s[18:19] offset:1024
    global_load_dwordx4 v[40:43], v26, s[18:19] offset:2048
    global_load_dwordx4 v[44:47], v26, s[18:19] offset:3072
    global_load_dwordx4 v[48:51], v27, s[18:19] offset:0
    global_load_dwordx4 v[52:55], v27, s[18:19] offset:1024
    global_load_dwordx4 v[56:59], v27, s[18:19] offset:2048
    global_load_dwordx4 v[60:63], v27, s[18:19] offset:3072
    s_waitcnt vmcnt(7)
    ds_write_b128 v25, v[32:35] offset:0
    s_waitcnt vmcnt(6)
    ds_write_b128 v25, v[36:39] offset:1040
    s_waitcnt vmcnt(5)
    ds_write_b128 v25, v[40:43] offset:2080
    s_waitcnt vmcnt(4)
    ds_write_b128 v25, v[44:47] offset:3120
    s_waitcnt vmcnt(3)
    ds_write_b128 v25, v[48:51] offset:4160
    s_waitcnt vmcnt(2)
    ds_write_b128 v25, v[52:55] offset:5200
    s_waitcnt vmcnt(1)
    ds_write_b128 v25, v[56:59] offset:6240
    s_waitcnt vmcnt(0)
    ds_write_b128 v25, v[60:63] offset:7280
    v_add_u32 v26, 8192, v24
    v_add_u32 v27, 12288, v24
    global_load_dwordx4 v[32:35], v26, s[18:19] offset:0
    global_load_dwordx4 v[36:39], v26, s[18:19] offset:1024
    global_load_dwordx4 v[40:43], v26, s[18:19] offset:2048
    global_load_dwordx4 v[44:47], v26, s[18:19] offset:3072
    global_load_dwordx4 v[48:51], v27, s[18:19] offset:0
    global_load_dwordx4 v[52:55], v27, s[18:19] offset:1024
    global_load_dwordx4 v[56:59], v27, s[18:19] offset:2048
    global_load_dwordx4 v[60:63], v27, s[18:19] offset:3072
    s_waitcnt vmcnt(7)
    ds_write_b128 v25, v[32:35] offset:8320
    s_waitcnt vmcnt(6)
    ds_write_b128 v25, v[36:39] offset:9360
    s_waitcnt vmcnt(5)
    ds_write_b128 v25, v[40:43] offset:10400
    s_waitcnt vmcnt(4)
    ds_write_b128 v25, v[44:47] offset:11440
    s_waitcnt vmcnt(3)
    ds_write_b128 v25, v[48:51] offset:12480
    s_waitcnt vmcnt(2)
    ds_write_b128 v25, v[52:55] offset:13520
    s_waitcnt vmcnt(1)
    ds_write_b128 v25, v[56:59] offset:14560
    s_waitcnt vmcnt(0)
    ds_write_b128 v25, v[60:63] offset:15600
    v_add_u32 v26, 16384, v24
    v_add_u32 v27, 20480, v24
    global_load_dwordx4 v[32:35], v26, s[18:19] offset:0
    global_load_dwordx4 v[36:39], v26, s[18:19] offset:1024
    global_load_dwordx4 v[40:43], v26, s[18:19] offset:2048
    global_load_dwordx4 v[44:47], v26, s[18:19] offset:3072
    global_load_dwordx4 v[48:51], v27, s[18:19] offset:0
    global_load_dwordx4 v[52:55], v27, s[18:19] offset:1024
    global_load_dwordx4 v[56:59], v27, s[18:19] offset:2048
    global_load_dwordx4 v[60:63], v27, s[18:19] offset:3072
    s_waitcnt vmcnt(7)
    ds_write_b128 v25, v[32:35] offset:16640
    s_waitcnt vmcnt(6)
    ds_write_b128 v25, v[36:39] offset:17680
    s_waitcnt vmcnt(5)
    ds_write_b128 v25, v[40:43] offset:18720
    s_waitcnt vmcnt(4)
    ds_write_b128 v25, v[44:47] offset:19760
    s_waitcnt vmcnt(3)
    ds_write_b128 v25, v[48:51] offset:20800
    s_waitcnt vmcnt(2)
    ds_write_b128 v25, v[52:55] offset:21840
    s_waitcnt vmcnt(1)
    ds_write_b128 v25, v[56:59] offset:22880
    s_waitcnt vmcnt(0)
    ds_write_b128 v25, v[60:63] offset:23920
    v_add_u32 v26, 24576, v24
    v_add_u32 v27, 28672, v24
    global_load_dwordx4 v[32:35], v26, s[18:19] offset:0
    global_load_dwordx4 v[36:39], v26, s[18:19] offset:1024
    global_load_dwordx4 v[40:43], v26, s[18:19] offset:2048
    global_load_dwordx4 v[44:47], v26, s[18:19] offset:3072
    global_load_dwordx4 v[48:51], v27, s[18:19] offset:0
    global_load_dwordx4 v[52:55], v27, s[18:19] offset:1024
    global_load_dwordx4 v[56:59], v27, s[18:19] offset:2048
    global_load_dwordx4 v[60:63], v27, s[18:19] offset:3072
    s_waitcnt vmcnt(7)
    ds_write_b128 v25, v[32:35] offset:24960
    s_waitcnt vmcnt(6)
    ds_write_b128 v25, v[36:39] offset:26000
    s_waitcnt vmcnt(5)
    ds_write_b128 v25, v[40:43] offset:27040
    s_waitcnt vmcnt(4)
    ds_write_b128 v25, v[44:47] offset:28080
    s_waitcnt vmcnt(3)
    ds_write_b128 v25, v[48:51] offset:29120
    s_waitcnt vmcnt(2)
    ds_write_b128 v25, v[52:55] offset:30160
    s_waitcnt vmcnt(1)
    ds_write_b128 v25, v[56:59] offset:31200
    s_waitcnt vmcnt(0)
    ds_write_b128 v25, v[60:63] offset:32240
    s_waitcnt lgkmcnt(0)
    s_barrier
    v_lshrrev_b32 v26, 2, v1
    v_lshl_add_u32 v26, v2, 2, v26
    v_mul_u32_u24 v26, 1040, v26
    v_and_b32 v27, 3, v1
    v_lshl_add_u32 v26, v27, 3, v26
    s_lshl_b32 s24, s20, 8
    v_add_u32 v26, s24, v26
    v_add_u32 v27, 66560, v26
    ds_read_b64_tr_b16 v[128:129], v26 offset:0
    ds_read_b64_tr_b16 v[130:131], v26 offset:16640
    ds_read_b64_tr_b16 v[132:133], v26 offset:33280
    ds_read_b64_tr_b16 v[134:135], v26 offset:49920
    ds_read_b64_tr_b16 v[136:137], v27 offset:0
    ds_read_b64_tr_b16 v[138:139], v27 offset:16640
    ds_read_b64_tr_b16 v[140:141], v27 offset:33280
    ds_read_b64_tr_b16 v[142:143], v27 offset:49920
    ds_read_b64_tr_b16 v[144:145], v26 offset:32
    ds_read_b64_tr_b16 v[146:147], v26 offset:16672
    ds_read_b64_tr_b16 v[148:149], v26 offset:33312
    ds_read_b64_tr_b16 v[150:151], v26 offset:49952
    ds_read_b64_tr_b16 v[152:153], v27 offset:32
    ds_read_b64_tr_b16 v[154:155], v27 offset:16672
    ds_read_b64_tr_b16 v[156:157], v27 offset:33312
    ds_read_b64_tr_b16 v[158:159], v27 offset:49952
    ds_read_b64_tr_b16 v[160:161], v26 offset:64
    ds_read_b64_tr_b16 v[162:163], v26 offset:16704
    ds_read_b64_tr_b16 v[164:165], v26 offset:33344
    ds_read_b64_tr_b16 v[166:167], v26 offset:49984
    ds_read_b64_tr_b16 v[168:169], v27 offset:64
    ds_read_b64_tr_b16 v[170:171], v27 offset:16704
    ds_read_b64_tr_b16 v[172:173], v27 offset:33344
    ds_read_b64_tr_b16 v[174:175], v27 offset:49984
    ds_read_b64_tr_b16 v[176:177], v26 offset:96
    ds_read_b64_tr_b16 v[178:179], v26 offset:16736
    ds_read_b64_tr_b16 v[180:181], v26 offset:33376
    ds_read_b64_tr_b16 v[182:183], v26 offset:50016
    ds_read_b64_tr_b16 v[184:185], v27 offset:96
    ds_read_b64_tr_b16 v[186:187], v27 offset:16736
    ds_read_b64_tr_b16 v[188:189], v27 offset:33376
    ds_read_b64_tr_b16 v[190:191], v27 offset:50016
    ds_read_b64_tr_b16 v[192:193], v26 offset:128
    ds_read_b64_tr_b16 v[194:195], v26 offset:16768
    ds_read_b64_tr_b16 v[196:197], v26 offset:33408
    ds_read_b64_tr_b16 v[198:199], v26 offset:50048
    ds_read_b64_tr_b16 v[200:201], v27 offset:128
    ds_read_b64_tr_b16 v[202:203], v27 offset:16768
    ds_read_b64_tr_b16 v[204:205], v27 offset:33408
    ds_read_b64_tr_b16 v[206:207], v27 offset:50048
    ds_read_b64_tr_b16 v[208:209], v26 offset:160
    ds_read_b64_tr_b16 v[210:211], v26 offset:16800
    ds_read_b64_tr_b16 v[212:213], v26 offset:33440
    ds_read_b64_tr_b16 v[214:215], v26 offset:50080
    ds_read_b64_tr_b16 v[216:217], v27 offset:160
    ds_read_b64_tr_b16 v[218:219], v27 offset:16800
    ds_read_b64_tr_b16 v[220:221], v27 offset:33440
    ds_read_b64_tr_b16 v[222:223], v27 offset:50080
    ds_read_b64_tr_b16 v[224:225], v26 offset:192
    ds_read_b64_tr_b16 v[226:227], v26 offset:16832
    ds_read_b64_tr_b16 v[228:229], v26 offset:33472
    ds_read_b64_tr_b16 v[230:231], v26 offset:50112
    ds_read_b64_tr_b16 v[232:233], v27 offset:192
    ds_read_b64_tr_b16 v[234:235], v27 offset:16832
    ds_read_b64_tr_b16 v[236:237], v27 offset:33472
    ds_read_b64_tr_b16 v[238:239], v27 offset:50112
    ds_read_b64_tr_b16 v[240:241], v26 offset:224
    ds_read_b64_tr_b16 v[242:243], v26 offset:16864
    ds_read_b64_tr_b16 v[244:245], v26 offset:33504
    ds_read_b64_tr_b16 v[246:247], v26 offset:50144
    ds_read_b64_tr_b16 v[248:249], v27 offset:224
    ds_read_b64_tr_b16 v[250:251], v27 offset:16864
    ds_read_b64_tr_b16 v[252:253], v27 offset:33504
    ds_read_b64_tr_b16 v[254:255], v27 offset:50144
    s_waitcnt lgkmcnt(0)
    s_barrier
    s_sub_u32 s61, s22, 3
    s_mov_b32 s56, s61
    s_lshl_b32 s52, s21, 2
    s_add_u32 s52, s52, s20
    s_lshl_b32 s23, s56, 21
    s_add_u32 s23, s23, 33554432
    s_lshl_b32 s24, s20, 19
    s_add_u32 s24, s24, s23
    s_lshl_b32 s25, s21, 11
    s_add_u32 s24, s24, s25
    v_add_u32 v11, s24, v7
    s_lshl_b32 s24, s21, 16
    s_add_u32 s24, s24, s23
    s_lshr_b32 s25, s20, 1
    s_lshl_b32 s25, s25, 10
    s_add_u32 s24, s24, s25
    s_and_b32 s25, s20, 1
    s_lshl_b32 s25, s25, 9
    s_add_u32 s24, s24, s25
    v_lshrrev_b32 v24, 5, v0
    v_and_b32 v25, 31, v0
    v_lshlrev_b32 v25, 4, v25
    v_lshl_add_u32 v25, v24, 11, v25
    v_add_u32 v12, s24, v25
    s_lshr_b32 s25, s20, 1
    s_lshl_b32 s25, s25, 5
    v_lshl_add_u32 v26, v24, 4, v1
    v_add_u32 v26, s25, v26
    v_lshlrev_b32 v26, 10, v26
    v_and_b32 v27, 1, v2
    s_and_b32 s25, s20, 1
    s_lshl_b32 s25, s25, 4
    s_lshl_b32 s24, s21, 5
    s_add_u32 s25, s25, s24
    v_lshl_add_u32 v26, v27, 3, v26
    v_add_u32 v13, s25, v26
    v_cmp_eq_u32 s[58:59], 1, v24
    s_lshl_b32 s23, s56, 7
    s_add_u32 s57, s23, 180224
    s_lshl_b32 s23, s56, 9
    s_add_u32 s60, s23, 184320
    s_and_b32 s23, s20, 1
    s_lshl_b32 s23, s23, 4
    v_add_u32 v14, s23, v1
    v_lshlrev_b32 v24, 2, v2
    v_sub_u32 v14, v14, v24
    v_lshrrev_b32 v24, 1, v2
    v_cmp_eq_u32 s[46:47], s61, v24
    s_lshl_b32 s23, s20, 12
    v_add_u32 v20, s23, v7
    v_mov_b32 v124, 32
    s_mov_b32 s90, 0
    s_nop 0
Lpoll_20:
    global_load_dword v125, v124, s[10:11] sc1
    s_waitcnt vmcnt(0)
    s_movk_i32 s23, 0x100
    v_cmp_gt_u32 s[40:41], s23, v125
    s_cmp_eq_u64 s[40:41], 0
    s_cbranch_scc1 Lpd_21
    s_add_u32 s90, s90, 1
    s_cmp_lt_u32 s90, 400000
    s_nop 0
    s_cbranch_scc1 Lpoll_20
    v_mov_b32 v126, 108
    v_mov_b32 v127, 267
    global_store_dword v126, v127, s[10:11]
    s_waitcnt vmcnt(0)
    s_endpgm
Lpd_21:
    s_mov_b32 s34, 1
LB_item:
    s_sub_u32 s35, s34, 1
    s_lshl_b32 s36, s35, 1
    s_lshr_b32 s23, s20, 1
    s_add_u32 s36, s36, s23
    s_mul_i32 s37, s61, 11
    s_add_u32 s37, s37, s36
    s_lshl_b32 s38, s61, 6
    s_add_u32 s38, s38, s36
    s_lshl_b32 s23, s38, 9
    s_lshl_b32 s24, s21, 4
    s_add_u32 s23, s23, s24
    s_lshl_b32 s25, s37, 9
    s_add_u32 s25, s25, s24
    s_add_u32 s25, s25, 65536
    v_mov_b32 v124, s23
    v_mov_b32 v125, s25
    s_mov_b32 s90, 0
    s_nop 0
Lpoll_22:
    global_load_dwordx4 v[24:27], v124, s[4:5] offset:0 sc1
    global_load_dwordx4 v[28:31], v125, s[4:5] sc1
    s_waitcnt vmcnt(0)
    v_and_b32 v24, v24, v25
    v_and_b32 v26, v26, v27
    v_and_b32 v28, v28, v29
    v_and_b32 v30, v30, v31
    v_and_b32 v24, v24, v26
    v_and_b32 v28, v28, v30
    v_and_b32 v24, v24, v28
    v_cmp_ne_u32 s[40:41], 1, v24
    s_cmp_eq_u64 s[40:41], 0
    s_cbranch_scc1 Lpd_23
    s_add_u32 s90, s90, 1
    s_cmp_lt_u32 s90, 400000
    s_nop 0
    s_cbranch_scc1 Lpoll_22
    v_mov_b32 v126, 84
    v_mov_b32 v127, 261
    global_store_dword v126, v127, s[10:11]
    s_waitcnt vmcnt(0)
    s_endpgm
Lpd_23:
    v_lshlrev_b32 v124, 3, v0
    v_add_u32 v124, s60, v124
    global_load_dwordx2 v[16:17], v124, s[4:5] sc1
    s_lshl_b32 s23, s35, 16
    v_add_u32 v124, s23, v13
    s_cmp_eq_u32 s61, 0
    s_cbranch_scc0 Lres_24
    global_load_dwordx2 v[22:23], v124, s[6:7] sc1
    s_branch Lres_25
Lres_24:
    v_add_u32 v125, 31457280, v124
    global_load_dwordx2 v[22:23], v125, s[4:5] sc1
Lres_25:
    s_mul_i32 s23, s38, 786432
    s_mul_i32 s24, s21, 24576
    s_add_u32 s23, s23, s24
    s_add_u32 s23, s23, 50331648
    v_add_u32 v124, s23, v7
    s_and_b32 s24, s20, 1
    s_lshl_b32 s24, s24, 12
    v_add_u32 v125, s24, v124
    global_load_dwordx4 v[24:27], v125, s[4:5] offset:0 sc1
    global_load_dwordx4 v[28:31], v125, s[4:5] offset:1024 sc1
    global_load_dwordx4 v[32:35], v125, s[4:5] offset:2048 sc1
    global_load_dwordx4 v[36:39], v125, s[4:5] offset:3072 sc1
    v_add_u32 v125, 8192, v124
    global_load_dwordx4 v[40:43], v125, s[4:5] offset:0 sc1
    global_load_dwordx4 v[44:47], v125, s[4:5] offset:1024 sc1
    global_load_dwordx4 v[48:51], v125, s[4:5] offset:2048 sc1
    global_load_dwordx4 v[52:55], v125, s[4:5] offset:3072 sc1
    v_add_u32 v125, 12288, v124
    global_load_dwordx4 v[56:59], v125, s[4:5] offset:0 sc1
    global_load_dwordx4 v[60:63], v125, s[4:5] offset:1024 sc1
    global_load_dwordx4 v[64:67], v125, s[4:5] offset:2048 sc1
    global_load_dwordx4 v[68:71], v125, s[4:5] offset:3072 sc1
    s_lshl_b32 s23, s37, 5
    s_add_u32 s23, s23, s21
    s_lshl_b32 s23, s23, 13
    s_add_u32 s23, s23, 2097152
    v_add_u32 v126, s23, v7
    global_load_dwordx4 v[72:75], v126, s[4:5] offset:0 sc1
    global_load_dwordx4 v[76:79], v126, s[4:5] offset:1024 sc1
    global_load_dwordx4 v[80:83], v126, s[4:5] offset:2048 sc1
    global_load_dwordx4 v[84:87], v126, s[4:5] offset:3072 sc1
    v_add_u32 v125, 16384, v124
    global_load_dwordx4 a[0:3], v125, s[4:5] offset:0 sc1
    global_load_dwordx4 a[4:7], v125, s[4:5] offset:1024 sc1
    global_load_dwordx4 a[8:11], v125, s[4:5] offset:2048 sc1
    global_load_dwordx4 a[12:15], v125, s[4:5] offset:3072 sc1
    v_add_u32 v125, 20480, v124
    global_load_dwordx4 a[16:19], v125, s[4:5] offset:0 sc1
    global_load_dwordx4 a[20:23], v125, s[4:5] offset:1024 sc1
    global_load_dwordx4 a[24:27], v125, s[4:5] offset:2048 sc1
    global_load_dwordx4 a[28:31], v125, s[4:5] offset:3072 sc1
    v_add_u32 v126, 4096, v126
    global_load_dwordx4 a[32:35], v126, s[4:5] offset:0 sc1
    global_load_dwordx4 a[36:39], v126, s[4:5] offset:1024 sc1
    global_load_dwordx4 a[40:43], v126, s[4:5] offset:2048 sc1
    global_load_dwordx4 a[44:47], v126, s[4:5] offset:3072 sc1
    s_waitcnt vmcnt(12)
    v_mfma_f32_16x16x32_bf16 v[88:91], v[40:43], v[24:27], 0
    v_mfma_f32_16x16x32_bf16 v[92:95], v[56:59], v[24:27], 0
    v_mfma_f32_16x16x32_bf16 v[96:99], v[72:75], v[24:27], 0
    v_mfma_f32_16x16x32_bf16 v[88:91], v[44:47], v[28:31], v[88:91]
    v_mfma_f32_16x16x32_bf16 v[92:95], v[60:63], v[28:31], v[92:95]
    v_mfma_f32_16x16x32_bf16 v[96:99], v[76:79], v[28:31], v[96:99]
    v_mfma_f32_16x16x32_bf16 v[88:91], v[48:51], v[32:35], v[88:91]
    v_mfma_f32_16x16x32_bf16 v[92:95], v[64:67], v[32:35], v[92:95]
    v_mfma_f32_16x16x32_bf16 v[96:99], v[80:83], v[32:35], v[96:99]
    v_mfma_f32_16x16x32_bf16 v[88:91], v[52:55], v[36:39], v[88:91]
    v_mfma_f32_16x16x32_bf16 v[92:95], v[68:71], v[36:39], v[92:95]
    v_mfma_f32_16x16x32_bf16 v[96:99], v[84:87], v[36:39], v[96:99]
    v_mov_b32 v124, 0xf149f2ca
    v_cmp_le_i32 vcc, 0, v14
    s_nop 3
    v_cndmask_b32 v88, v124, v88, vcc
    v_cmp_le_i32 vcc, 1, v14
    s_nop 1
    v_cndmask_b32 v89, v124, v89, vcc
    v_cmp_le_i32 vcc, 2, v14
    s_nop 1
    v_cndmask_b32 v90, v124, v90, vcc
    v_cmp_le_i32 vcc, 3, v14
    s_nop 1
    v_cndmask_b32 v91, v124, v91, vcc
    v_cmp_le_i32 vcc, 16, v14
    s_nop 1
    v_cndmask_b32 v92, v124, v92, vcc
    v_cmp_le_i32 vcc, 17, v14
    s_nop 1
    v_cndmask_b32 v93, v124, v93, vcc
    v_cmp_le_i32 vcc, 18, v14
    s_nop 1
    v_cndmask_b32 v94, v124, v94, vcc
    v_cmp_le_i32 vcc, 19, v14
    s_nop 1
    v_cndmask_b32 v95, v124, v95, vcc
    v_cndmask_b32 v96, v124, v96, s[46:47]
    v_cndmask_b32 v97, v124, v97, s[46:47]
    v_cndmask_b32 v98, v124, v98, s[46:47]
    v_cndmask_b32 v99, v124, v99, s[46:47]
    v_max3_f32 v124, v88, v89, v90
    v_max3_f32 v124, v124, v91, v92
    v_max3_f32 v124, v124, v93, v94
    v_max3_f32 v124, v124, v95, v96
    v_max3_f32 v124, v124, v97, v98
    v_max_f32 v124, v124, v99
    v_mov_b32 v125, v124
    s_nop 1
    v_permlane16_swap_b32 v124, v125
    v_max_f32 v124, v124, v125
    v_mov_b32 v125, v124
    s_nop 1
    v_permlane32_swap_b32 v124, v125
    v_max_f32 v124, v124, v125
    s_mov_b32 s23, 1040356334
    v_sub_f32 v88, v88, v124
    v_sub_f32 v89, v89, v124
    v_sub_f32 v90, v90, v124
    v_sub_f32 v91, v91, v124
    v_sub_f32 v92, v92, v124
    v_sub_f32 v93, v93, v124
    v_sub_f32 v94, v94, v124
    v_sub_f32 v95, v95, v124
    v_sub_f32 v96, v96, v124
    v_sub_f32 v97, v97, v124
    v_sub_f32 v98, v98, v124
    v_sub_f32 v99, v99, v124
    v_mul_f32 v88, s23, v88
    v_mul_f32 v89, s23, v89
    v_mul_f32 v90, s23, v90
    v_mul_f32 v91, s23, v91
    v_mul_f32 v92, s23, v92
    v_mul_f32 v93, s23, v93
    v_mul_f32 v94, s23, v94
    v_mul_f32 v95, s23, v95
    v_mul_f32 v96, s23, v96
    v_mul_f32 v97, s23, v97
    v_mul_f32 v98, s23, v98
    v_mul_f32 v99, s23, v99
    v_exp_f32 v88, v88
    v_exp_f32 v89, v89
    v_exp_f32 v90, v90
    v_exp_f32 v91, v91
    v_exp_f32 v92, v92
    v_exp_f32 v93, v93
    v_exp_f32 v94, v94
    v_exp_f32 v95, v95
    v_exp_f32 v96, v96
    v_exp_f32 v97, v97
    v_exp_f32 v98, v98
    v_exp_f32 v99, v99
    v_add_f32 v124, v88, v89
    v_add_f32 v124, v124, v90
    v_add_f32 v124, v124, v91
    v_add_f32 v124, v124, v92
    v_add_f32 v124, v124, v93
    v_add_f32 v124, v124, v94
    v_add_f32 v124, v124, v95
    v_add_f32 v124, v124, v96
    v_add_f32 v124, v124, v97
    v_add_f32 v124, v124, v98
    v_add_f32 v124, v124, v99
    v_mov_b32 v125, v124
    s_nop 1
    v_permlane16_swap_b32 v124, v125
    v_add_f32 v124, v124, v125
    v_mov_b32 v125, v124
    s_nop 1
    v_permlane32_swap_b32 v124, v125
    v_add_f32 v124, v124, v125
    v_rcp_f32 v124, v124
    s_nop 0
    v_mul_f32 v88, v88, v124
    v_mul_f32 v89, v89, v124
    v_mul_f32 v90, v90, v124
    v_mul_f32 v91, v91, v124
    v_mul_f32 v92, v92, v124
    v_mul_f32 v93, v93, v124
    v_mul_f32 v94, v94, v124
    v_mul_f32 v95, v95, v124
    v_mul_f32 v96, v96, v124
    v_mul_f32 v97, v97, v124
    v_mul_f32 v98, v98, v124
    v_mul_f32 v99, v99, v124
    v_cvt_pk_bf16_f32 v100, v88, v89
    v_cvt_pk_bf16_f32 v101, v90, v91
    v_cvt_pk_bf16_f32 v102, v92, v93
    v_cvt_pk_bf16_f32 v103, v94, v95
    v_cvt_pk_bf16_f32 v104, v96, v97
    v_cvt_pk_bf16_f32 v105, v98, v99
    s_waitcnt vmcnt(0)
    v_mfma_f32_16x16x32_bf16 v[24:27], a[0:3], v[100:103], 0
    v_mfma_f32_16x16x32_bf16 v[28:31], a[4:7], v[100:103], 0
    v_mfma_f32_16x16x32_bf16 v[32:35], a[8:11], v[100:103], 0
    v_mfma_f32_16x16x32_bf16 v[36:39], a[12:15], v[100:103], 0
    v_mfma_f32_16x16x32_bf16 v[40:43], a[16:19], v[100:103], 0
    v_mfma_f32_16x16x32_bf16 v[44:47], a[20:23], v[100:103], 0
    v_mfma_f32_16x16x32_bf16 v[48:51], a[24:27], v[100:103], 0
    v_mfma_f32_16x16x32_bf16 v[52:55], a[28:31], v[100:103], 0
    s_nop 0
    v_mfma_f32_16x16x16_bf16 v[24:27], a[32:33], v[104:105], v[24:27]
    v_mfma_f32_16x16x16_bf16 v[28:31], a[34:35], v[104:105], v[28:31]
    v_mfma_f32_16x16x16_bf16 v[32:35], a[36:37], v[104:105], v[32:35]
    v_mfma_f32_16x16x16_bf16 v[36:39], a[38:39], v[104:105], v[36:39]
    v_mfma_f32_16x16x16_bf16 v[40:43], a[40:41], v[104:105], v[40:43]
    v_mfma_f32_16x16x16_bf16 v[44:47], a[42:43], v[104:105], v[44:47]
    v_mfma_f32_16x16x16_bf16 v[48:51], a[44:45], v[104:105], v[48:51]
    v_mfma_f32_16x16x16_bf16 v[52:55], a[46:47], v[104:105], v[52:55]
    s_nop 0
    v_cvt_pk_bf16_f32 v56, v24, v25
    v_cvt_pk_bf16_f32 v57, v26, v27
    v_cvt_pk_bf16_f32 v58, v28, v29
    v_cvt_pk_bf16_f32 v59, v30, v31
    ds_write_b128 v20, v[56:59] offset:0
    v_cvt_pk_bf16_f32 v60, v32, v33
    v_cvt_pk_bf16_f32 v61, v34, v35
    v_cvt_pk_bf16_f32 v62, v36, v37
    v_cvt_pk_bf16_f32 v63, v38, v39
    ds_write_b128 v20, v[60:63] offset:1024
    v_cvt_pk_bf16_f32 v64, v40, v41
    v_cvt_pk_bf16_f32 v65, v42, v43
    v_cvt_pk_bf16_f32 v66, v44, v45
    v_cvt_pk_bf16_f32 v67, v46, v47
    ds_write_b128 v20, v[64:67] offset:2048
    v_cvt_pk_bf16_f32 v68, v48, v49
    v_cvt_pk_bf16_f32 v69, v50, v51
    v_cvt_pk_bf16_f32 v70, v52, v53
    v_cvt_pk_bf16_f32 v71, v54, v55
    ds_write_b128 v20, v[68:71] offset:3072
    s_waitcnt lgkmcnt(0)
    s_barrier
    ds_read_b128 v[24:27], v7 offset:0
    ds_read_b128 v[28:31], v7 offset:1024
    ds_read_b128 v[32:35], v7 offset:2048
    ds_read_b128 v[36:39], v7 offset:3072
    ds_read_b128 v[40:43], v7 offset:4096
    ds_read_b128 v[44:47], v7 offset:5120
    ds_read_b128 v[48:51], v7 offset:6144
    ds_read_b128 v[52:55], v7 offset:7168
    ds_read_b128 v[56:59], v7 offset:8192
    ds_read_b128 v[60:63], v7 offset:9216
    ds_read_b128 v[64:67], v7 offset:10240
    ds_read_b128 v[68:71], v7 offset:11264
    ds_read_b128 v[72:75], v7 offset:12288
    ds_read_b128 v[76:79], v7 offset:13312
    ds_read_b128 v[80:83], v7 offset:14336
    ds_read_b128 v[84:87], v7 offset:15360
    s_sub_u32 s23, s34, 1
    v_min_u32 v16, v16, v17
    v_cmp_gt_u32 s[40:41], s23, v16
    s_cmp_eq_u64 s[40:41], 0
    s_cbranch_scc1 Ldok_26
    v_lshlrev_b32 v124, 3, v0
    v_add_u32 v124, s60, v124
    s_mov_b32 s90, 0
    s_nop 0
Lpoll_27:
    global_load_dwordx2 v[126:127], v124, s[4:5] sc1
    s_waitcnt vmcnt(0)
    v_min_u32 v126, v126, v127
    v_cmp_gt_u32 s[40:41], s23, v126
    s_cmp_eq_u64 s[40:41], 0
    s_cbranch_scc1 Lpd_28
    s_add_u32 s90, s90, 1
    s_cmp_lt_u32 s90, 400000
    s_nop 0
    s_cbranch_scc1 Lpoll_27
    v_mov_b32 v126, 88
    v_mov_b32 v127, 262
    global_store_dword v126, v127, s[10:11]
    s_waitcnt vmcnt(0)
    s_endpgm
Lpd_28:
Ldok_26:
    s_waitcnt lgkmcnt(0)
    v_mfma_f32_16x16x32_bf16 v[88:91], v[128:131], v[24:27], 0
    v_mfma_f32_16x16x32_bf16 v[92:95], v[128:131], v[40:43], 0
    v_mfma_f32_16x16x32_bf16 v[96:99], v[128:131], v[56:59], 0
    v_mfma_f32_16x16x32_bf16 v[100:103], v[128:131], v[72:75], 0
    v_mfma_f32_16x16x32_bf16 v[88:91], v[132:135], v[28:31], v[88:91]
    v_mfma_f32_16x16x32_bf16 v[92:95], v[132:135], v[44:47], v[92:95]
    v_mfma_f32_16x16x32_bf16 v[96:99], v[132:135], v[60:63], v[96:99]
    v_mfma_f32_16x16x32_bf16 v[100:103], v[132:135], v[76:79], v[100:103]
    v_mfma_f32_16x16x32_bf16 v[88:91], v[136:139], v[32:35], v[88:91]
    v_mfma_f32_16x16x32_bf16 v[92:95], v[136:139], v[48:51], v[92:95]
    v_mfma_f32_16x16x32_bf16 v[96:99], v[136:139], v[64:67], v[96:99]
    v_mfma_f32_16x16x32_bf16 v[100:103], v[136:139], v[80:83], v[100:103]
    v_mfma_f32_16x16x32_bf16 v[88:91], v[140:143], v[36:39], v[88:91]
    v_mfma_f32_16x16x32_bf16 v[92:95], v[140:143], v[52:55], v[92:95]
    v_mfma_f32_16x16x32_bf16 v[96:99], v[140:143], v[68:71], v[96:99]
    v_mfma_f32_16x16x32_bf16 v[100:103], v[140:143], v[84:87], v[100:103]
    s_nop 4
    v_cvt_pk_bf16_f32 v104, v88, v89
    v_cvt_pk_bf16_f32 v105, v90, v91
    v_cvt_pk_bf16_f32 v106, v92, v93
    v_cvt_pk_bf16_f32 v107, v94, v95
    v_cvt_pk_bf16_f32 v108, v96, v97
    v_cvt_pk_bf16_f32 v109, v98, v99
    v_cvt_pk_bf16_f32 v110, v100, v101
    v_cvt_pk_bf16_f32 v111, v102, v103
    v_add_u32 v124, 0, v11
    global_store_dwordx4 v124, v[104:107], s[4:5]
    global_store_dwordx4 v124, v[108:111], s[4:5] offset:1024
    v_mfma_f32_16x16x32_bf16 v[88:91], v[144:147], v[24:27], 0
    v_mfma_f32_16x16x32_bf16 v[92:95], v[144:147], v[40:43], 0
    v_mfma_f32_16x16x32_bf16 v[96:99], v[144:147], v[56:59], 0
    v_mfma_f32_16x16x32_bf16 v[100:103], v[144:147], v[72:75], 0
    v_mfma_f32_16x16x32_bf16 v[88:91], v[148:151], v[28:31], v[88:91]
    v_mfma_f32_16x16x32_bf16 v[92:95], v[148:151], v[44:47], v[92:95]
    v_mfma_f32_16x16x32_bf16 v[96:99], v[148:151], v[60:63], v[96:99]
    v_mfma_f32_16x16x32_bf16 v[100:103], v[148:151], v[76:79], v[100:103]
    v_mfma_f32_16x16x32_bf16 v[88:91], v[152:155], v[32:35], v[88:91]
    v_mfma_f32_16x16x32_bf16 v[92:95], v[152:155], v[48:51], v[92:95]
    v_mfma_f32_16x16x32_bf16 v[96:99], v[152:155], v[64:67], v[96:99]
    v_mfma_f32_16x16x32_bf16 v[100:103], v[152:155], v[80:83], v[100:103]
    v_mfma_f32_16x16x32_bf16 v[88:91], v[156:159], v[36:39], v[88:91]
    v_mfma_f32_16x16x32_bf16 v[92:95], v[156:159], v[52:55], v[92:95]
    v_mfma_f32_16x16x32_bf16 v[96:99], v[156:159], v[68:71], v[96:99]
    v_mfma_f32_16x16x32_bf16 v[100:103], v[156:159], v[84:87], v[100:103]
    s_nop 4
    v_cvt_pk_bf16_f32 v104, v88, v89
    v_cvt_pk_bf16_f32 v105, v90, v91
    v_cvt_pk_bf16_f32 v106, v92, v93
    v_cvt_pk_bf16_f32 v107, v94, v95
    v_cvt_pk_bf16_f32 v108, v96, v97
    v_cvt_pk_bf16_f32 v109, v98, v99
    v_cvt_pk_bf16_f32 v110, v100, v101
    v_cvt_pk_bf16_f32 v111, v102, v103
    v_add_u32 v124, 65536, v11
    global_store_dwordx4 v124, v[104:107], s[4:5]
    global_store_dwordx4 v124, v[108:111], s[4:5] offset:1024
    v_mfma_f32_16x16x32_bf16 v[88:91], v[160:163], v[24:27], 0
    v_mfma_f32_16x16x32_bf16 v[92:95], v[160:163], v[40:43], 0
    v_mfma_f32_16x16x32_bf16 v[96:99], v[160:163], v[56:59], 0
    v_mfma_f32_16x16x32_bf16 v[100:103], v[160:163], v[72:75], 0
    v_mfma_f32_16x16x32_bf16 v[88:91], v[164:167], v[28:31], v[88:91]
    v_mfma_f32_16x16x32_bf16 v[92:95], v[164:167], v[44:47], v[92:95]
    v_mfma_f32_16x16x32_bf16 v[96:99], v[164:167], v[60:63], v[96:99]
    v_mfma_f32_16x16x32_bf16 v[100:103], v[164:167], v[76:79], v[100:103]
    v_mfma_f32_16x16x32_bf16 v[88:91], v[168:171], v[32:35], v[88:91]
    v_mfma_f32_16x16x32_bf16 v[92:95], v[168:171], v[48:51], v[92:95]
    v_mfma_f32_16x16x32_bf16 v[96:99], v[168:171], v[64:67], v[96:99]
    v_mfma_f32_16x16x32_bf16 v[100:103], v[168:171], v[80:83], v[100:103]
    v_mfma_f32_16x16x32_bf16 v[88:91], v[172:175], v[36:39], v[88:91]
    v_mfma_f32_16x16x32_bf16 v[92:95], v[172:175], v[52:55], v[92:95]
    v_mfma_f32_16x16x32_bf16 v[96:99], v[172:175], v[68:71], v[96:99]
    v_mfma_f32_16x16x32_bf16 v[100:103], v[172:175], v[84:87], v[100:103]
    s_nop 4
    v_cvt_pk_bf16_f32 v104, v88, v89
    v_cvt_pk_bf16_f32 v105, v90, v91
    v_cvt_pk_bf16_f32 v106, v92, v93
    v_cvt_pk_bf16_f32 v107, v94, v95
    v_cvt_pk_bf16_f32 v108, v96, v97
    v_cvt_pk_bf16_f32 v109, v98, v99
    v_cvt_pk_bf16_f32 v110, v100, v101
    v_cvt_pk_bf16_f32 v111, v102, v103
    v_add_u32 v124, 131072, v11
    global_store_dwordx4 v124, v[104:107], s[4:5]
    global_store_dwordx4 v124, v[108:111], s[4:5] offset:1024
    v_mfma_f32_16x16x32_bf16 v[88:91], v[176:179], v[24:27], 0
    v_mfma_f32_16x16x32_bf16 v[92:95], v[176:179], v[40:43], 0
    v_mfma_f32_16x16x32_bf16 v[96:99], v[176:179], v[56:59], 0
    v_mfma_f32_16x16x32_bf16 v[100:103], v[176:179], v[72:75], 0
    v_mfma_f32_16x16x32_bf16 v[88:91], v[180:183], v[28:31], v[88:91]
    v_mfma_f32_16x16x32_bf16 v[92:95], v[180:183], v[44:47], v[92:95]
    v_mfma_f32_16x16x32_bf16 v[96:99], v[180:183], v[60:63], v[96:99]
    v_mfma_f32_16x16x32_bf16 v[100:103], v[180:183], v[76:79], v[100:103]
    v_mfma_f32_16x16x32_bf16 v[88:91], v[184:187], v[32:35], v[88:91]
    v_mfma_f32_16x16x32_bf16 v[92:95], v[184:187], v[48:51], v[92:95]
    v_mfma_f32_16x16x32_bf16 v[96:99], v[184:187], v[64:67], v[96:99]
    v_mfma_f32_16x16x32_bf16 v[100:103], v[184:187], v[80:83], v[100:103]
    v_mfma_f32_16x16x32_bf16 v[88:91], v[188:191], v[36:39], v[88:91]
    v_mfma_f32_16x16x32_bf16 v[92:95], v[188:191], v[52:55], v[92:95]
    v_mfma_f32_16x16x32_bf16 v[96:99], v[188:191], v[68:71], v[96:99]
    v_mfma_f32_16x16x32_bf16 v[100:103], v[188:191], v[84:87], v[100:103]
    s_nop 4
    v_cvt_pk_bf16_f32 v104, v88, v89
    v_cvt_pk_bf16_f32 v105, v90, v91
    v_cvt_pk_bf16_f32 v106, v92, v93
    v_cvt_pk_bf16_f32 v107, v94, v95
    v_cvt_pk_bf16_f32 v108, v96, v97
    v_cvt_pk_bf16_f32 v109, v98, v99
    v_cvt_pk_bf16_f32 v110, v100, v101
    v_cvt_pk_bf16_f32 v111, v102, v103
    v_add_u32 v124, 196608, v11
    global_store_dwordx4 v124, v[104:107], s[4:5]
    global_store_dwordx4 v124, v[108:111], s[4:5] offset:1024
    v_mfma_f32_16x16x32_bf16 v[88:91], v[192:195], v[24:27], 0
    v_mfma_f32_16x16x32_bf16 v[92:95], v[192:195], v[40:43], 0
    v_mfma_f32_16x16x32_bf16 v[96:99], v[192:195], v[56:59], 0
    v_mfma_f32_16x16x32_bf16 v[100:103], v[192:195], v[72:75], 0
    v_mfma_f32_16x16x32_bf16 v[88:91], v[196:199], v[28:31], v[88:91]
    v_mfma_f32_16x16x32_bf16 v[92:95], v[196:199], v[44:47], v[92:95]
    v_mfma_f32_16x16x32_bf16 v[96:99], v[196:199], v[60:63], v[96:99]
    v_mfma_f32_16x16x32_bf16 v[100:103], v[196:199], v[76:79], v[100:103]
    v_mfma_f32_16x16x32_bf16 v[88:91], v[200:203], v[32:35], v[88:91]
    v_mfma_f32_16x16x32_bf16 v[92:95], v[200:203], v[48:51], v[92:95]
    v_mfma_f32_16x16x32_bf16 v[96:99], v[200:203], v[64:67], v[96:99]
    v_mfma_f32_16x16x32_bf16 v[100:103], v[200:203], v[80:83], v[100:103]
    v_mfma_f32_16x16x32_bf16 v[88:91], v[204:207], v[36:39], v[88:91]
    v_mfma_f32_16x16x32_bf16 v[92:95], v[204:207], v[52:55], v[92:95]
    v_mfma_f32_16x16x32_bf16 v[96:99], v[204:207], v[68:71], v[96:99]
    v_mfma_f32_16x16x32_bf16 v[100:103], v[204:207], v[84:87], v[100:103]
    s_nop 4
    v_cvt_pk_bf16_f32 v104, v88, v89
    v_cvt_pk_bf16_f32 v105, v90, v91
    v_cvt_pk_bf16_f32 v106, v92, v93
    v_cvt_pk_bf16_f32 v107, v94, v95
    v_cvt_pk_bf16_f32 v108, v96, v97
    v_cvt_pk_bf16_f32 v109, v98, v99
    v_cvt_pk_bf16_f32 v110, v100, v101
    v_cvt_pk_bf16_f32 v111, v102, v103
    v_add_u32 v124, 262144, v11
    global_store_dwordx4 v124, v[104:107], s[4:5]
    global_store_dwordx4 v124, v[108:111], s[4:5] offset:1024
    v_mfma_f32_16x16x32_bf16 v[88:91], v[208:211], v[24:27], 0
    v_mfma_f32_16x16x32_bf16 v[92:95], v[208:211], v[40:43], 0
    v_mfma_f32_16x16x32_bf16 v[96:99], v[208:211], v[56:59], 0
    v_mfma_f32_16x16x32_bf16 v[100:103], v[208:211], v[72:75], 0
    v_mfma_f32_16x16x32_bf16 v[88:91], v[212:215], v[28:31], v[88:91]
    v_mfma_f32_16x16x32_bf16 v[92:95], v[212:215], v[44:47], v[92:95]
    v_mfma_f32_16x16x32_bf16 v[96:99], v[212:215], v[60:63], v[96:99]
    v_mfma_f32_16x16x32_bf16 v[100:103], v[212:215], v[76:79], v[100:103]
    v_mfma_f32_16x16x32_bf16 v[88:91], v[216:219], v[32:35], v[88:91]
    v_mfma_f32_16x16x32_bf16 v[92:95], v[216:219], v[48:51], v[92:95]
    v_mfma_f32_16x16x32_bf16 v[96:99], v[216:219], v[64:67], v[96:99]
    v_mfma_f32_16x16x32_bf16 v[100:103], v[216:219], v[80:83], v[100:103]
    v_mfma_f32_16x16x32_bf16 v[88:91], v[220:223], v[36:39], v[88:91]
    v_mfma_f32_16x16x32_bf16 v[92:95], v[220:223], v[52:55], v[92:95]
    v_mfma_f32_16x16x32_bf16 v[96:99], v[220:223], v[68:71], v[96:99]
    v_mfma_f32_16x16x32_bf16 v[100:103], v[220:223], v[84:87], v[100:103]
    s_nop 4
    v_cvt_pk_bf16_f32 v104, v88, v89
    v_cvt_pk_bf16_f32 v105, v90, v91
    v_cvt_pk_bf16_f32 v106, v92, v93
    v_cvt_pk_bf16_f32 v107, v94, v95
    v_cvt_pk_bf16_f32 v108, v96, v97
    v_cvt_pk_bf16_f32 v109, v98, v99
    v_cvt_pk_bf16_f32 v110, v100, v101
    v_cvt_pk_bf16_f32 v111, v102, v103
    v_add_u32 v124, 327680, v11
    global_store_dwordx4 v124, v[104:107], s[4:5]
    global_store_dwordx4 v124, v[108:111], s[4:5] offset:1024
    v_mfma_f32_16x16x32_bf16 v[88:91], v[224:227], v[24:27], 0
    v_mfma_f32_16x16x32_bf16 v[92:95], v[224:227], v[40:43], 0
    v_mfma_f32_16x16x32_bf16 v[96:99], v[224:227], v[56:59], 0
    v_mfma_f32_16x16x32_bf16 v[100:103], v[224:227], v[72:75], 0
    v_mfma_f32_16x16x32_bf16 v[88:91], v[228:231], v[28:31], v[88:91]
    v_mfma_f32_16x16x32_bf16 v[92:95], v[228:231], v[44:47], v[92:95]
    v_mfma_f32_16x16x32_bf16 v[96:99], v[228:231], v[60:63], v[96:99]
    v_mfma_f32_16x16x32_bf16 v[100:103], v[228:231], v[76:79], v[100:103]
    v_mfma_f32_16x16x32_bf16 v[88:91], v[232:235], v[32:35], v[88:91]
    v_mfma_f32_16x16x32_bf16 v[92:95], v[232:235], v[48:51], v[92:95]
    v_mfma_f32_16x16x32_bf16 v[96:99], v[232:235], v[64:67], v[96:99]
    v_mfma_f32_16x16x32_bf16 v[100:103], v[232:235], v[80:83], v[100:103]
    v_mfma_f32_16x16x32_bf16 v[88:91], v[236:239], v[36:39], v[88:91]
    v_mfma_f32_16x16x32_bf16 v[92:95], v[236:239], v[52:55], v[92:95]
    v_mfma_f32_16x16x32_bf16 v[96:99], v[236:239], v[68:71], v[96:99]
    v_mfma_f32_16x16x32_bf16 v[100:103], v[236:239], v[84:87], v[100:103]
    s_nop 4
    v_cvt_pk_bf16_f32 v104, v88, v89
    v_cvt_pk_bf16_f32 v105, v90, v91
    v_cvt_pk_bf16_f32 v106, v92, v93
    v_cvt_pk_bf16_f32 v107, v94, v95
    v_cvt_pk_bf16_f32 v108, v96, v97
    v_cvt_pk_bf16_f32 v109, v98, v99
    v_cvt_pk_bf16_f32 v110, v100, v101
    v_cvt_pk_bf16_f32 v111, v102, v103
    v_add_u32 v124, 393216, v11
    global_store_dwordx4 v124, v[104:107], s[4:5]
    global_store_dwordx4 v124, v[108:111], s[4:5] offset:1024
    v_mfma_f32_16x16x32_bf16 v[88:91], v[240:243], v[24:27], 0
    v_mfma_f32_16x16x32_bf16 v[92:95], v[240:243], v[40:43], 0
    v_mfma_f32_16x16x32_bf16 v[96:99], v[240:243], v[56:59], 0
    v_mfma_f32_16x16x32_bf16 v[100:103], v[240:243], v[72:75], 0
    v_mfma_f32_16x16x32_bf16 v[88:91], v[244:247], v[28:31], v[88:91]
    v_mfma_f32_16x16x32_bf16 v[92:95], v[244:247], v[44:47], v[92:95]
    v_mfma_f32_16x16x32_bf16 v[96:99], v[244:247], v[60:63], v[96:99]
    v_mfma_f32_16x16x32_bf16 v[100:103], v[244:247], v[76:79], v[100:103]
    v_mfma_f32_16x16x32_bf16 v[88:91], v[248:251], v[32:35], v[88:91]
    v_mfma_f32_16x16x32_bf16 v[92:95], v[248:251], v[48:51], v[92:95]
    v_mfma_f32_16x16x32_bf16 v[96:99], v[248:251], v[64:67], v[96:99]
    v_mfma_f32_16x16x32_bf16 v[100:103], v[248:251], v[80:83], v[100:103]
    v_mfma_f32_16x16x32_bf16 v[88:91], v[252:255], v[36:39], v[88:91]
    v_mfma_f32_16x16x32_bf16 v[92:95], v[252:255], v[52:55], v[92:95]
    v_mfma_f32_16x16x32_bf16 v[96:99], v[252:255], v[68:71], v[96:99]
    v_mfma_f32_16x16x32_bf16 v[100:103], v[252:255], v[84:87], v[100:103]
    s_nop 4
    v_cvt_pk_bf16_f32 v104, v88, v89
    v_cvt_pk_bf16_f32 v105, v90, v91
    v_cvt_pk_bf16_f32 v106, v92, v93
    v_cvt_pk_bf16_f32 v107, v94, v95
    v_cvt_pk_bf16_f32 v108, v96, v97
    v_cvt_pk_bf16_f32 v109, v98, v99
    v_cvt_pk_bf16_f32 v110, v100, v101
    v_cvt_pk_bf16_f32 v111, v102, v103
    v_add_u32 v124, 458752, v11
    global_store_dwordx4 v124, v[104:107], s[4:5]
    global_store_dwordx4 v124, v[108:111], s[4:5] offset:1024
    s_waitcnt vmcnt(0)
    s_barrier
    s_lshl_b32 s23, s21, 2
    s_add_u32 s23, s23, s57
    v_mov_b32 v124, s23
    v_mov_b32 v125, s34
    global_store_dword v124, v125, s[4:5]
    v_and_b32 v124, 31, v0
    v_min_u32 v124, 31, v124
    v_lshlrev_b32 v124, 2, v124
    v_add_u32 v124, s57, v124
    s_mov_b32 s90, 0
    s_nop 0
Lpoll_29:
    global_load_dword v125, v124, s[4:5] sc1
    s_waitcnt vmcnt(0)
    v_cmp_gt_u32 s[40:41], s34, v125
    s_cmp_eq_u64 s[40:41], 0
    s_cbranch_scc1 Lpd_30
    s_add_u32 s90, s90, 1
    s_cmp_lt_u32 s90, 400000
    s_nop 0
    s_cbranch_scc1 Lpoll_29
    v_mov_b32 v126, 92
    v_mov_b32 v127, 263
    global_store_dword v126, v127, s[10:11]
    s_waitcnt vmcnt(0)
    s_endpgm
Lpd_30:
    v_add_u32 v124, 0, v12
    global_load_dwordx4 v[40:43], v124, s[4:5] sc1
    v_add_u32 v124, 4096, v12
    global_load_dwordx4 v[44:47], v124, s[4:5] sc1
    v_add_u32 v124, 8192, v12
    global_load_dwordx4 v[48:51], v124, s[4:5] sc1
    v_add_u32 v124, 12288, v12
    global_load_dwordx4 v[52:55], v124, s[4:5] sc1
    v_add_u32 v124, 16384, v12
    global_load_dwordx4 v[56:59], v124, s[4:5] sc1
    v_add_u32 v124, 20480, v12
    global_load_dwordx4 v[60:63], v124, s[4:5] sc1
    v_add_u32 v124, 24576, v12
    global_load_dwordx4 v[64:67], v124, s[4:5] sc1
    v_add_u32 v124, 28672, v12
    global_load_dwordx4 v[68:71], v124, s[4:5] sc1
    v_add_u32 v124, 32768, v12
    global_load_dwordx4 v[72:75], v124, s[4:5] sc1
    v_add_u32 v124, 36864, v12
    global_load_dwordx4 v[76:79], v124, s[4:5] sc1
    v_add_u32 v124, 40960, v12
    global_load_dwordx4 v[80:83], v124, s[4:5] sc1
    v_add_u32 v124, 45056, v12
    global_load_dwordx4 v[84:87], v124, s[4:5] sc1
    v_add_u32 v124, 49152, v12
    global_load_dwordx4 v[88:91], v124, s[4:5] sc1
    v_add_u32 v124, 53248, v12
    global_load_dwordx4 v[92:95], v124, s[4:5] sc1
    v_add_u32 v124, 57344, v12
    global_load_dwordx4 v[96:99], v124, s[4:5] sc1
    v_add_u32 v124, 61440, v12
    global_load_dwordx4 v[100:103], v124, s[4:5] sc1
    s_waitcnt vmcnt(15)
    v_lshlrev_b32 v24, 16, v40
    v_and_b32 v25, 0xffff0000, v40
    v_lshlrev_b32 v26, 16, v41
    v_and_b32 v27, 0xffff0000, v41
    v_lshlrev_b32 v28, 16, v42
    v_and_b32 v29, 0xffff0000, v42
    v_lshlrev_b32 v30, 16, v43
    v_and_b32 v31, 0xffff0000, v43
    s_waitcnt vmcnt(14)
    v_lshlrev_b32 v124, 16, v44
    v_and_b32 v125, 0xffff0000, v44
    v_pk_add_f32 v[24:25], v[24:25], v[124:125]
    v_lshlrev_b32 v124, 16, v45
    v_and_b32 v125, 0xffff0000, v45
    v_pk_add_f32 v[26:27], v[26:27], v[124:125]
    v_lshlrev_b32 v124, 16, v46
    v_and_b32 v125, 0xffff0000, v46
    v_pk_add_f32 v[28:29], v[28:29], v[124:125]
    v_lshlrev_b32 v124, 16, v47
    v_and_b32 v125, 0xffff0000, v47
    v_pk_add_f32 v[30:31], v[30:31], v[124:125]
    s_waitcnt vmcnt(13)
    v_lshlrev_b32 v124, 16, v48
    v_and_b32 v125, 0xffff0000, v48
    v_pk_add_f32 v[24:25], v[24:25], v[124:125]
    v_lshlrev_b32 v124, 16, v49
    v_and_b32 v125, 0xffff0000, v49
    v_pk_add_f32 v[26:27], v[26:27], v[124:125]
    v_lshlrev_b32 v124, 16, v50
    v_and_b32 v125, 0xffff0000, v50
    v_pk_add_f32 v[28:29], v[28:29], v[124:125]
    v_lshlrev_b32 v124, 16, v51
    v_and_b32 v125, 0xffff0000, v51
    v_pk_add_f32 v[30:31], v[30:31], v[124:125]
    s_waitcnt vmcnt(12)
    v_lshlrev_b32 v124, 16, v52
    v_and_b32 v125, 0xffff0000, v52
    v_pk_add_f32 v[24:25], v[24:25], v[124:125]
    v_lshlrev_b32 v124, 16, v53
    v_and_b32 v125, 0xffff0000, v53
    v_pk_add_f32 v[26:27], v[26:27], v[124:125]
    v_lshlrev_b32 v124, 16, v54
    v_and_b32 v125, 0xffff0000, v54
    v_pk_add_f32 v[28:29], v[28:29], v[124:125]
    v_lshlrev_b32 v124, 16, v55
    v_and_b32 v125, 0xffff0000, v55
    v_pk_add_f32 v[30:31], v[30:31], v[124:125]
    s_waitcnt vmcnt(11)
    v_lshlrev_b32 v124, 16, v56
    v_and_b32 v125, 0xffff0000, v56
    v_pk_add_f32 v[24:25], v[24:25], v[124:125]
    v_lshlrev_b32 v124, 16, v57
    v_and_b32 v125, 0xffff0000, v57
    v_pk_add_f32 v[26:27], v[26:27], v[124:125]
    v_lshlrev_b32 v124, 16, v58
    v_and_b32 v125, 0xffff0000, v58
    v_pk_add_f32 v[28:29], v[28:29], v[124:125]
    v_lshlrev_b32 v124, 16, v59
    v_and_b32 v125, 0xffff0000, v59
    v_pk_add_f32 v[30:31], v[30:31], v[124:125]
    s_waitcnt vmcnt(10)
    v_lshlrev_b32 v124, 16, v60
    v_and_b32 v125, 0xffff0000, v60
    v_pk_add_f32 v[24:25], v[24:25], v[124:125]
    v_lshlrev_b32 v124, 16, v61
    v_and_b32 v125, 0xffff0000, v61
    v_pk_add_f32 v[26:27], v[26:27], v[124:125]
    v_lshlrev_b32 v124, 16, v62
    v_and_b32 v125, 0xffff0000, v62
    v_pk_add_f32 v[28:29], v[28:29], v[124:125]
    v_lshlrev_b32 v124, 16, v63
    v_and_b32 v125, 0xffff0000, v63
    v_pk_add_f32 v[30:31], v[30:31], v[124:125]
    s_waitcnt vmcnt(9)
    v_lshlrev_b32 v124, 16, v64
    v_and_b32 v125, 0xffff0000, v64
    v_pk_add_f32 v[24:25], v[24:25], v[124:125]
    v_lshlrev_b32 v124, 16, v65
    v_and_b32 v125, 0xffff0000, v65
    v_pk_add_f32 v[26:27], v[26:27], v[124:125]
    v_lshlrev_b32 v124, 16, v66
    v_and_b32 v125, 0xffff0000, v66
    v_pk_add_f32 v[28:29], v[28:29], v[124:125]
    v_lshlrev_b32 v124, 16, v67
    v_and_b32 v125, 0xffff0000, v67
    v_pk_add_f32 v[30:31], v[30:31], v[124:125]
    s_waitcnt vmcnt(8)
    v_lshlrev_b32 v124, 16, v68
    v_and_b32 v125, 0xffff0000, v68
    v_pk_add_f32 v[24:25], v[24:25], v[124:125]
    v_lshlrev_b32 v124, 16, v69
    v_and_b32 v125, 0xffff0000, v69
    v_pk_add_f32 v[26:27], v[26:27], v[124:125]
    v_lshlrev_b32 v124, 16, v70
    v_and_b32 v125, 0xffff0000, v70
    v_pk_add_f32 v[28:29], v[28:29], v[124:125]
    v_lshlrev_b32 v124, 16, v71
    v_and_b32 v125, 0xffff0000, v71
    v_pk_add_f32 v[30:31], v[30:31], v[124:125]
    s_waitcnt vmcnt(7)
    v_lshlrev_b32 v124, 16, v72
    v_and_b32 v125, 0xffff0000, v72
    v_pk_add_f32 v[24:25], v[24:25], v[124:125]
    v_lshlrev_b32 v124, 16, v73
    v_and_b32 v125, 0xffff0000, v73
    v_pk_add_f32 v[26:27], v[26:27], v[124:125]
    v_lshlrev_b32 v124, 16, v74
    v_and_b32 v125, 0xffff0000, v74
    v_pk_add_f32 v[28:29], v[28:29], v[124:125]
    v_lshlrev_b32 v124, 16, v75
    v_and_b32 v125, 0xffff0000, v75
    v_pk_add_f32 v[30:31], v[30:31], v[124:125]
    s_waitcnt vmcnt(6)
    v_lshlrev_b32 v124, 16, v76
    v_and_b32 v125, 0xffff0000, v76
    v_pk_add_f32 v[24:25], v[24:25], v[124:125]
    v_lshlrev_b32 v124, 16, v77
    v_and_b32 v125, 0xffff0000, v77
    v_pk_add_f32 v[26:27], v[26:27], v[124:125]
    v_lshlrev_b32 v124, 16, v78
    v_and_b32 v125, 0xffff0000, v78
    v_pk_add_f32 v[28:29], v[28:29], v[124:125]
    v_lshlrev_b32 v124, 16, v79
    v_and_b32 v125, 0xffff0000, v79
    v_pk_add_f32 v[30:31], v[30:31], v[124:125]
    s_waitcnt vmcnt(5)
    v_lshlrev_b32 v124, 16, v80
    v_and_b32 v125, 0xffff0000, v80
    v_pk_add_f32 v[24:25], v[24:25], v[124:125]
    v_lshlrev_b32 v124, 16, v81
    v_and_b32 v125, 0xffff0000, v81
    v_pk_add_f32 v[26:27], v[26:27], v[124:125]
    v_lshlrev_b32 v124, 16, v82
    v_and_b32 v125, 0xffff0000, v82
    v_pk_add_f32 v[28:29], v[28:29], v[124:125]
    v_lshlrev_b32 v124, 16, v83
    v_and_b32 v125, 0xffff0000, v83
    v_pk_add_f32 v[30:31], v[30:31], v[124:125]
    s_waitcnt vmcnt(4)
    v_lshlrev_b32 v124, 16, v84
    v_and_b32 v125, 0xffff0000, v84
    v_pk_add_f32 v[24:25], v[24:25], v[124:125]
    v_lshlrev_b32 v124, 16, v85
    v_and_b32 v125, 0xffff0000, v85
    v_pk_add_f32 v[26:27], v[26:27], v[124:125]
    v_lshlrev_b32 v124, 16, v86
    v_and_b32 v125, 0xffff0000, v86
    v_pk_add_f32 v[28:29], v[28:29], v[124:125]
    v_lshlrev_b32 v124, 16, v87
    v_and_b32 v125, 0xffff0000, v87
    v_pk_add_f32 v[30:31], v[30:31], v[124:125]
    s_waitcnt vmcnt(3)
    v_lshlrev_b32 v124, 16, v88
    v_and_b32 v125, 0xffff0000, v88
    v_pk_add_f32 v[24:25], v[24:25], v[124:125]
    v_lshlrev_b32 v124, 16, v89
    v_and_b32 v125, 0xffff0000, v89
    v_pk_add_f32 v[26:27], v[26:27], v[124:125]
    v_lshlrev_b32 v124, 16, v90
    v_and_b32 v125, 0xffff0000, v90
    v_pk_add_f32 v[28:29], v[28:29], v[124:125]
    v_lshlrev_b32 v124, 16, v91
    v_and_b32 v125, 0xffff0000, v91
    v_pk_add_f32 v[30:31], v[30:31], v[124:125]
    s_waitcnt vmcnt(2)
    v_lshlrev_b32 v124, 16, v92
    v_and_b32 v125, 0xffff0000, v92
    v_pk_add_f32 v[24:25], v[24:25], v[124:125]
    v_lshlrev_b32 v124, 16, v93
    v_and_b32 v125, 0xffff0000, v93
    v_pk_add_f32 v[26:27], v[26:27], v[124:125]
    v_lshlrev_b32 v124, 16, v94
    v_and_b32 v125, 0xffff0000, v94
    v_pk_add_f32 v[28:29], v[28:29], v[124:125]
    v_lshlrev_b32 v124, 16, v95
    v_and_b32 v125, 0xffff0000, v95
    v_pk_add_f32 v[30:31], v[30:31], v[124:125]
    s_waitcnt vmcnt(1)
    v_lshlrev_b32 v124, 16, v96
    v_and_b32 v125, 0xffff0000, v96
    v_pk_add_f32 v[24:25], v[24:25], v[124:125]
    v_lshlrev_b32 v124, 16, v97
    v_and_b32 v125, 0xffff0000, v97
    v_pk_add_f32 v[26:27], v[26:27], v[124:125]
    v_lshlrev_b32 v124, 16, v98
    v_and_b32 v125, 0xffff0000, v98
    v_pk_add_f32 v[28:29], v[28:29], v[124:125]
    v_lshlrev_b32 v124, 16, v99
    v_and_b32 v125, 0xffff0000, v99
    v_pk_add_f32 v[30:31], v[30:31], v[124:125]
    s_waitcnt vmcnt(0)
    v_lshlrev_b32 v124, 16, v100
    v_and_b32 v125, 0xffff0000, v100
    v_pk_add_f32 v[24:25], v[24:25], v[124:125]
    v_lshlrev_b32 v124, 16, v101
    v_and_b32 v125, 0xffff0000, v101
    v_pk_add_f32 v[26:27], v[26:27], v[124:125]
    v_lshlrev_b32 v124, 16, v102
    v_and_b32 v125, 0xffff0000, v102
    v_pk_add_f32 v[28:29], v[28:29], v[124:125]
    v_lshlrev_b32 v124, 16, v103
    v_and_b32 v125, 0xffff0000, v103
    v_pk_add_f32 v[30:31], v[30:31], v[124:125]
    s_lshl_b32 s23, s52, 2
    s_add_u32 s23, s23, s60
    v_mov_b32 v124, s23
    v_mov_b32 v125, s34
    global_store_dword v124, v125, s[4:5]
    v_mov_b32 v32, v24
    s_nop 1
    v_permlane32_swap_b32 v24, v32
    v_add_f32 v24, v24, v32
    v_mov_b32 v33, v25
    s_nop 1
    v_permlane32_swap_b32 v25, v33
    v_add_f32 v25, v25, v33
    v_mov_b32 v34, v26
    s_nop 1
    v_permlane32_swap_b32 v26, v34
    v_add_f32 v26, v26, v34
    v_mov_b32 v35, v27
    s_nop 1
    v_permlane32_swap_b32 v27, v35
    v_add_f32 v27, v27, v35
    v_mov_b32 v36, v28
    s_nop 1
    v_permlane32_swap_b32 v28, v36
    v_add_f32 v28, v28, v36
    v_mov_b32 v37, v29
    s_nop 1
    v_permlane32_swap_b32 v29, v37
    v_add_f32 v29, v29, v37
    v_mov_b32 v38, v30
    s_nop 1
    v_permlane32_swap_b32 v30, v38
    v_add_f32 v30, v30, v38
    v_mov_b32 v39, v31
    s_nop 1
    v_permlane32_swap_b32 v31, v39
    v_add_f32 v31, v31, v39
    v_cndmask_b32 v24, v24, v28, s[58:59]
    v_cndmask_b32 v25, v25, v29, s[58:59]
    v_cndmask_b32 v26, v26, v30, s[58:59]
    v_cndmask_b32 v27, v27, v31, s[58:59]
    s_lshl_b32 s23, s35, 16
    v_add_u32 v124, s23, v13
    v_cvt_pk_bf16_f32 v34, v24, v25
    v_cvt_pk_bf16_f32 v35, v26, v27
    v_lshlrev_b32 v24, 16, v34
    v_and_b32 v25, 0xffff0000, v34
    v_lshlrev_b32 v28, 16, v22
    v_and_b32 v29, 0xffff0000, v22
    v_lshlrev_b32 v26, 16, v35
    v_and_b32 v27, 0xffff0000, v35
    v_lshlrev_b32 v30, 16, v23
    v_and_b32 v31, 0xffff0000, v23
    v_add_f32 v24, v24, v28
    v_add_f32 v25, v25, v29
    v_add_f32 v26, v26, v30
    v_add_f32 v27, v27, v31
    v_cvt_pk_bf16_f32 v32, v24, v25
    v_cvt_pk_bf16_f32 v33, v26, v27
    s_lshl_b32 s23, s61, 21
    s_add_u32 s23, s23, 27262976
    v_add_u32 v125, s23, v124
    global_store_dwordx2 v125, v[32:33], s[4:5] sc1
    s_waitcnt vmcnt(0)
    s_lshl_b32 s23, s61, 5
    s_add_u32 s23, s23, s35
    s_lshl_b32 s23, s23, 7
    s_add_u32 s23, s23, s52
    s_lshl_b32 s23, s23, 2
    s_add_u32 s23, s23, 131072
    v_mov_b32 v124, s23
    v_mov_b32 v125, 1
    global_store_dword v124, v125, s[4:5] sc1
    s_add_u32 s34, s34, 1
    s_cmp_le_u32 s34, 32
    s_cbranch_scc1 LB_item
    s_waitcnt vmcnt(0)
    s_endpgm
LroleF:
    s_load_dwordx2 s[12:13], s[0:1], 64
    s_load_dwordx2 s[14:15], s[0:1], 72
    s_load_dwordx2 s[16:17], s[0:1], 80
    s_waitcnt lgkmcnt(0)
    v_and_b32 v1, 15, v0
    v_lshrrev_b32 v2, 4, v0
    v_lshlrev_b32 v7, 4, v0
    s_sub_u32 s56, s22, 3
    s_lshl_b32 s52, s21, 2
    s_add_u32 s52, s52, s20
    s_cmp_ge_u32 s21, 28
    s_cbranch_scc1 LF_wdone
    v_lshrrev_b32 v24, 3, v0
    s_lshl_b32 s23, s20, 7
    v_add_u32 v24, s23, v24
    v_and_b32 v25, 7, v0
    s_movk_i32 s23, 3584
    v_mul_lo_u32 v26, v24, s23
    v_lshl_add_u32 v26, v25, 4, v26
    s_lshl_b32 s23, s21, 7
    v_add_u32 v26, s23, v26
    v_mul_u32_u24 v27, 144, v24
    v_lshl_add_u32 v27, v25, 4, v27
    v_add_u32 v28, 0, v26
    global_load_dwordx4 v[32:35], v28, s[12:13]
    v_add_u32 v28, 28672, v26
    global_load_dwordx4 v[36:39], v28, s[12:13]
    v_add_u32 v28, 57344, v26
    global_load_dwordx4 v[40:43], v28, s[12:13]
    v_add_u32 v28, 86016, v26
    global_load_dwordx4 v[44:47], v28, s[12:13]
    v_add_u32 v28, 114688, v26
    global_load_dwordx4 v[48:51], v28, s[12:13]
    v_add_u32 v28, 143360, v26
    global_load_dwordx4 v[52:55], v28, s[12:13]
    v_add_u32 v28, 172032, v26
    global_load_dwordx4 v[56:59], v28, s[12:13]
    v_add_u32 v28, 200704, v26
    global_load_dwordx4 v[60:63], v28, s[12:13]
    s_waitcnt vmcnt(7)
    ds_write_b128 v27, v[32:35] offset:0
    s_waitcnt vmcnt(6)
    ds_write_b128 v27, v[36:39] offset:1152
    s_waitcnt vmcnt(5)
    ds_write_b128 v27, v[40:43] offset:2304
    s_waitcnt vmcnt(4)
    ds_write_b128 v27, v[44:47] offset:3456
    s_waitcnt vmcnt(3)
    ds_write_b128 v27, v[48:51] offset:4608
    s_waitcnt vmcnt(2)
    ds_write_b128 v27, v[52:55] offset:5760
    s_waitcnt vmcnt(1)
    ds_write_b128 v27, v[56:59] offset:6912
    s_waitcnt vmcnt(0)
    ds_write_b128 v27, v[60:63] offset:8064
    v_add_u32 v28, 229376, v26
    global_load_dwordx4 v[32:35], v28, s[12:13]
    v_add_u32 v28, 258048, v26
    global_load_dwordx4 v[36:39], v28, s[12:13]
    v_add_u32 v28, 286720, v26
    global_load_dwordx4 v[40:43], v28, s[12:13]
    v_add_u32 v28, 315392, v26
    global_load_dwordx4 v[44:47], v28, s[12:13]
    v_add_u32 v28, 344064, v26
    global_load_dwordx4 v[48:51], v28, s[12:13]
    v_add_u32 v28, 372736, v26
    global_load_dwordx4 v[52:55], v28, s[12:13]
    v_add_u32 v28, 401408, v26
    global_load_dwordx4 v[56:59], v28, s[12:13]
    v_add_u32 v28, 430080, v26
    global_load_dwordx4 v[60:63], v28, s[12:13]
    s_waitcnt vmcnt(7)
    ds_write_b128 v27, v[32:35] offset:9216
    s_waitcnt vmcnt(6)
    ds_write_b128 v27, v[36:39] offset:10368
    s_waitcnt vmcnt(5)
    ds_write_b128 v27, v[40:43] offset:11520
    s_waitcnt vmcnt(4)
    ds_write_b128 v27, v[44:47] offset:12672
    s_waitcnt vmcnt(3)
    ds_write_b128 v27, v[48:51] offset:13824
    s_waitcnt vmcnt(2)
    ds_write_b128 v27, v[52:55] offset:14976
    s_waitcnt vmcnt(1)
    ds_write_b128 v27, v[56:59] offset:16128
    s_waitcnt vmcnt(0)
    ds_write_b128 v27, v[60:63] offset:17280
    v_add_u32 v28, 0, v26
    global_load_dwordx4 v[32:35], v28, s[14:15]
    v_add_u32 v28, 28672, v26
    global_load_dwordx4 v[36:39], v28, s[14:15]
    v_add_u32 v28, 57344, v26
    global_load_dwordx4 v[40:43], v28, s[14:15]
    v_add_u32 v28, 86016, v26
    global_load_dwordx4 v[44:47], v28, s[14:15]
    v_add_u32 v28, 114688, v26
    global_load_dwordx4 v[48:51], v28, s[14:15]
    v_add_u32 v28, 143360, v26
    global_load_dwordx4 v[52:55], v28, s[14:15]
    v_add_u32 v28, 172032, v26
    global_load_dwordx4 v[56:59], v28, s[14:15]
    v_add_u32 v28, 200704, v26
    global_load_dwordx4 v[60:63], v28, s[14:15]
    s_waitcnt vmcnt(7)
    v_add_u32 v28, 73728, v27
    ds_write_b128 v28, v[32:35] offset:0
    s_waitcnt vmcnt(6)
    s_nop 0
    v_add_u32 v28, 73728, v27
    ds_write_b128 v28, v[36:39] offset:1152
    s_waitcnt vmcnt(5)
    s_nop 0
    v_add_u32 v28, 73728, v27
    ds_write_b128 v28, v[40:43] offset:2304
    s_waitcnt vmcnt(4)
    s_nop 0
    v_add_u32 v28, 73728, v27
    ds_write_b128 v28, v[44:47] offset:3456
    s_waitcnt vmcnt(3)
    s_nop 0
    v_add_u32 v28, 73728, v27
    ds_write_b128 v28, v[48:51] offset:4608
    s_waitcnt vmcnt(2)
    s_nop 0
    v_add_u32 v28, 73728, v27
    ds_write_b128 v28, v[52:55] offset:5760
    s_waitcnt vmcnt(1)
    s_nop 0
    v_add_u32 v28, 73728, v27
    ds_write_b128 v28, v[56:59] offset:6912
    s_waitcnt vmcnt(0)
    s_nop 0
    v_add_u32 v28, 73728, v27
    ds_write_b128 v28, v[60:63] offset:8064
    s_nop 1
    v_add_u32 v28, 229376, v26
    global_load_dwordx4 v[32:35], v28, s[14:15]
    v_add_u32 v28, 258048, v26
    global_load_dwordx4 v[36:39], v28, s[14:15]
    v_add_u32 v28, 286720, v26
    global_load_dwordx4 v[40:43], v28, s[14:15]
    v_add_u32 v28, 315392, v26
    global_load_dwordx4 v[44:47], v28, s[14:15]
    v_add_u32 v28, 344064, v26
    global_load_dwordx4 v[48:51], v28, s[14:15]
    v_add_u32 v28, 372736, v26
    global_load_dwordx4 v[52:55], v28, s[14:15]
    v_add_u32 v28, 401408, v26
    global_load_dwordx4 v[56:59], v28, s[14:15]
    v_add_u32 v28, 430080, v26
    global_load_dwordx4 v[60:63], v28, s[14:15]
    s_waitcnt vmcnt(7)
    v_add_u32 v28, 73728, v27
    ds_write_b128 v28, v[32:35] offset:9216
    s_waitcnt vmcnt(6)
    s_nop 0
    v_add_u32 v28, 73728, v27
    ds_write_b128 v28, v[36:39] offset:10368
    s_waitcnt vmcnt(5)
    s_nop 0
    v_add_u32 v28, 73728, v27
    ds_write_b128 v28, v[40:43] offset:11520
    s_waitcnt vmcnt(4)
    s_nop 0
    v_add_u32 v28, 73728, v27
    ds_write_b128 v28, v[44:47] offset:12672
    s_waitcnt vmcnt(3)
    s_nop 0
    v_add_u32 v28, 73728, v27
    ds_write_b128 v28, v[48:51] offset:13824
    s_waitcnt vmcnt(2)
    s_nop 0
    v_add_u32 v28, 73728, v27
    ds_write_b128 v28, v[52:55] offset:14976
    s_waitcnt vmcnt(1)
    s_nop 0
    v_add_u32 v28, 73728, v27
    ds_write_b128 v28, v[56:59] offset:16128
    s_waitcnt vmcnt(0)
    s_nop 0
    v_add_u32 v28, 73728, v27
    ds_write_b128 v28, v[60:63] offset:17280
    s_waitcnt lgkmcnt(0)
    s_barrier
    v_lshrrev_b32 v26, 2, v1
    v_lshl_add_u32 v26, v2, 3, v26
    v_mul_u32_u24 v26, 144, v26
    v_and_b32 v27, 3, v1
    v_lshl_add_u32 v26, v27, 3, v26
    s_lshl_b32 s24, s20, 5
    v_add_u32 v26, s24, v26
    v_add_u32 v27, 36864, v26
    v_add_u32 v28, 73728, v26
    v_add_u32 v29, 110592, v26
    ds_read_b64_tr_b16 a[0:1], v26 offset:0
    ds_read_b64_tr_b16 a[2:3], v26 offset:576
    ds_read_b64_tr_b16 a[4:5], v26 offset:4608
    ds_read_b64_tr_b16 a[6:7], v26 offset:5184
    ds_read_b64_tr_b16 a[8:9], v26 offset:9216
    ds_read_b64_tr_b16 a[10:11], v26 offset:9792
    ds_read_b64_tr_b16 a[12:13], v26 offset:13824
    ds_read_b64_tr_b16 a[14:15], v26 offset:14400
    ds_read_b64_tr_b16 a[16:17], v26 offset:18432
    ds_read_b64_tr_b16 a[18:19], v26 offset:19008
    ds_read_b64_tr_b16 a[20:21], v26 offset:23040
    ds_read_b64_tr_b16 a[22:23], v26 offset:23616
    ds_read_b64_tr_b16 a[24:25], v26 offset:27648
    ds_read_b64_tr_b16 a[26:27], v26 offset:28224
    ds_read_b64_tr_b16 a[28:29], v26 offset:32256
    ds_read_b64_tr_b16 a[30:31], v26 offset:32832
    ds_read_b64_tr_b16 a[32:33], v27 offset:0
    ds_read_b64_tr_b16 a[34:35], v27 offset:576
    ds_read_b64_tr_b16 a[36:37], v27 offset:4608
    ds_read_b64_tr_b16 a[38:39], v27 offset:5184
    ds_read_b64_tr_b16 a[40:41], v27 offset:9216
    ds_read_b64_tr_b16 a[42:43], v27 offset:9792
    ds_read_b64_tr_b16 a[44:45], v27 offset:13824
    ds_read_b64_tr_b16 a[46:47], v27 offset:14400
    ds_read_b64_tr_b16 a[48:49], v27 offset:18432
    ds_read_b64_tr_b16 a[50:51], v27 offset:19008
    ds_read_b64_tr_b16 a[52:53], v27 offset:23040
    ds_read_b64_tr_b16 a[54:55], v27 offset:23616
    ds_read_b64_tr_b16 a[56:57], v27 offset:27648
    ds_read_b64_tr_b16 a[58:59], v27 offset:28224
    ds_read_b64_tr_b16 a[60:61], v27 offset:32256
    ds_read_b64_tr_b16 a[62:63], v27 offset:32832
    ds_read_b64_tr_b16 a[64:65], v28 offset:0
    ds_read_b64_tr_b16 a[66:67], v28 offset:576
    ds_read_b64_tr_b16 a[68:69], v28 offset:4608
    ds_read_b64_tr_b16 a[70:71], v28 offset:5184
    ds_read_b64_tr_b16 a[72:73], v28 offset:9216
    ds_read_b64_tr_b16 a[74:75], v28 offset:9792
    ds_read_b64_tr_b16 a[76:77], v28 offset:13824
    ds_read_b64_tr_b16 a[78:79], v28 offset:14400
    ds_read_b64_tr_b16 a[80:81], v28 offset:18432
    ds_read_b64_tr_b16 a[82:83], v28 offset:19008
    ds_read_b64_tr_b16 a[84:85], v28 offset:23040
    ds_read_b64_tr_b16 a[86:87], v28 offset:23616
    ds_read_b64_tr_b16 a[88:89], v28 offset:27648
    ds_read_b64_tr_b16 a[90:91], v28 offset:28224
    ds_read_b64_tr_b16 a[92:93], v28 offset:32256
    ds_read_b64_tr_b16 a[94:95], v28 offset:32832
    ds_read_b64_tr_b16 a[96:97], v29 offset:0
    ds_read_b64_tr_b16 a[98:99], v29 offset:576
    ds_read_b64_tr_b16 a[100:101], v29 offset:4608
    ds_read_b64_tr_b16 a[102:103], v29 offset:5184
    ds_read_b64_tr_b16 a[104:105], v29 offset:9216
    ds_read_b64_tr_b16 a[106:107], v29 offset:9792
    ds_read_b64_tr_b16 a[108:109], v29 offset:13824
    ds_read_b64_tr_b16 a[110:111], v29 offset:14400
    ds_read_b64_tr_b16 a[112:113], v29 offset:18432
    ds_read_b64_tr_b16 a[114:115], v29 offset:19008
    ds_read_b64_tr_b16 a[116:117], v29 offset:23040
    ds_read_b64_tr_b16 a[118:119], v29 offset:23616
    ds_read_b64_tr_b16 a[120:121], v29 offset:27648
    ds_read_b64_tr_b16 a[122:123], v29 offset:28224
    ds_read_b64_tr_b16 a[124:125], v29 offset:32256
    ds_read_b64_tr_b16 a[126:127], v29 offset:32832
    s_waitcnt lgkmcnt(0)
    s_barrier
    s_lshl_b32 s23, s21, 16
    s_lshl_b32 s24, s20, 14
    s_add_u32 s23, s23, s24
    v_add_u32 v24, s23, v7
    s_mul_i32 s24, s20, 16640
    v_add_u32 v25, s24, v7
    v_add_u32 v26, 0, v24
    v_add_u32 v27, 4096, v24
    global_load_dwordx4 v[32:35], v26, s[16:17] offset:0
    global_load_dwordx4 v[36:39], v26, s[16:17] offset:1024
    global_load_dwordx4 v[40:43], v26, s[16:17] offset:2048
    global_load_dwordx4 v[44:47], v26, s[16:17] offset:3072
    global_load_dwordx4 v[48:51], v27, s[16:17] offset:0
    global_load_dwordx4 v[52:55], v27, s[16:17] offset:1024
    global_load_dwordx4 v[56:59], v27, s[16:17] offset:2048
    global_load_dwordx4 v[60:63], v27, s[16:17] offset:3072
    s_waitcnt vmcnt(7)
    ds_write_b128 v25, v[32:35] offset:0
    s_waitcnt vmcnt(6)
    ds_write_b128 v25, v[36:39] offset:1040
    s_waitcnt vmcnt(5)
    ds_write_b128 v25, v[40:43] offset:2080
    s_waitcnt vmcnt(4)
    ds_write_b128 v25, v[44:47] offset:3120
    s_waitcnt vmcnt(3)
    ds_write_b128 v25, v[48:51] offset:4160
    s_waitcnt vmcnt(2)
    ds_write_b128 v25, v[52:55] offset:5200
    s_waitcnt vmcnt(1)
    ds_write_b128 v25, v[56:59] offset:6240
    s_waitcnt vmcnt(0)
    ds_write_b128 v25, v[60:63] offset:7280
    v_add_u32 v26, 8192, v24
    v_add_u32 v27, 12288, v24
    global_load_dwordx4 v[32:35], v26, s[16:17] offset:0
    global_load_dwordx4 v[36:39], v26, s[16:17] offset:1024
    global_load_dwordx4 v[40:43], v26, s[16:17] offset:2048
    global_load_dwordx4 v[44:47], v26, s[16:17] offset:3072
    global_load_dwordx4 v[48:51], v27, s[16:17] offset:0
    global_load_dwordx4 v[52:55], v27, s[16:17] offset:1024
    global_load_dwordx4 v[56:59], v27, s[16:17] offset:2048
    global_load_dwordx4 v[60:63], v27, s[16:17] offset:3072
    s_waitcnt vmcnt(7)
    ds_write_b128 v25, v[32:35] offset:8320
    s_waitcnt vmcnt(6)
    ds_write_b128 v25, v[36:39] offset:9360
    s_waitcnt vmcnt(5)
    ds_write_b128 v25, v[40:43] offset:10400
    s_waitcnt vmcnt(4)
    ds_write_b128 v25, v[44:47] offset:11440
    s_waitcnt vmcnt(3)
    ds_write_b128 v25, v[48:51] offset:12480
    s_waitcnt vmcnt(2)
    ds_write_b128 v25, v[52:55] offset:13520
    s_waitcnt vmcnt(1)
    ds_write_b128 v25, v[56:59] offset:14560
    s_waitcnt vmcnt(0)
    ds_write_b128 v25, v[60:63] offset:15600
    s_waitcnt lgkmcnt(0)
    s_barrier
    v_lshrrev_b32 v26, 2, v1
    v_lshl_add_u32 v26, v2, 2, v26
    v_mul_u32_u24 v26, 1040, v26
    v_and_b32 v27, 3, v1
    v_lshl_add_u32 v26, v27, 3, v26
    s_lshl_b32 s24, s20, 8
    v_add_u32 v26, s24, v26
    ds_read_b64_tr_b16 v[128:129], v26 offset:0
    ds_read_b64_tr_b16 v[130:131], v26 offset:16640
    ds_read_b64_tr_b16 v[132:133], v26 offset:33280
    ds_read_b64_tr_b16 v[134:135], v26 offset:49920
    ds_read_b64_tr_b16 v[136:137], v26 offset:32
    ds_read_b64_tr_b16 v[138:139], v26 offset:16672
    ds_read_b64_tr_b16 v[140:141], v26 offset:33312
    ds_read_b64_tr_b16 v[142:143], v26 offset:49952
    ds_read_b64_tr_b16 v[144:145], v26 offset:64
    ds_read_b64_tr_b16 v[146:147], v26 offset:16704
    ds_read_b64_tr_b16 v[148:149], v26 offset:33344
    ds_read_b64_tr_b16 v[150:151], v26 offset:49984
    ds_read_b64_tr_b16 v[152:153], v26 offset:96
    ds_read_b64_tr_b16 v[154:155], v26 offset:16736
    ds_read_b64_tr_b16 v[156:157], v26 offset:33376
    ds_read_b64_tr_b16 v[158:159], v26 offset:50016
    ds_read_b64_tr_b16 v[160:161], v26 offset:128
    ds_read_b64_tr_b16 v[162:163], v26 offset:16768
    ds_read_b64_tr_b16 v[164:165], v26 offset:33408
    ds_read_b64_tr_b16 v[166:167], v26 offset:50048
    ds_read_b64_tr_b16 v[168:169], v26 offset:160
    ds_read_b64_tr_b16 v[170:171], v26 offset:16800
    ds_read_b64_tr_b16 v[172:173], v26 offset:33440
    ds_read_b64_tr_b16 v[174:175], v26 offset:50080
    ds_read_b64_tr_b16 v[176:177], v26 offset:192
    ds_read_b64_tr_b16 v[178:179], v26 offset:16832
    ds_read_b64_tr_b16 v[180:181], v26 offset:33472
    ds_read_b64_tr_b16 v[182:183], v26 offset:50112
    ds_read_b64_tr_b16 v[184:185], v26 offset:224
    ds_read_b64_tr_b16 v[186:187], v26 offset:16864
    ds_read_b64_tr_b16 v[188:189], v26 offset:33504
    ds_read_b64_tr_b16 v[190:191], v26 offset:50144
    s_waitcnt lgkmcnt(0)
LF_wdone:
    s_barrier
    s_lshl_b32 s23, s56, 21
    s_add_u32 s23, s23, 33554432
    s_lshl_b32 s24, s20, 19
    s_add_u32 s24, s24, s23
    s_lshl_b32 s25, s21, 11
    s_add_u32 s24, s24, s25
    v_add_u32 v11, s24, v7
    s_lshl_b32 s24, s21, 16
    s_add_u32 s24, s24, s23
    s_lshr_b32 s25, s20, 1
    s_lshl_b32 s25, s25, 10
    s_add_u32 s24, s24, s25
    s_and_b32 s25, s20, 1
    s_lshl_b32 s25, s25, 9
    s_add_u32 s24, s24, s25
    v_lshrrev_b32 v24, 5, v0
    v_and_b32 v25, 31, v0
    v_lshlrev_b32 v25, 4, v25
    v_lshl_add_u32 v25, v24, 11, v25
    v_add_u32 v12, s24, v25
    s_lshr_b32 s25, s20, 1
    s_lshl_b32 s25, s25, 5
    v_lshl_add_u32 v26, v24, 4, v1
    v_add_u32 v26, s25, v26
    v_lshlrev_b32 v26, 10, v26
    v_and_b32 v27, 1, v2
    s_and_b32 s25, s20, 1
    s_lshl_b32 s25, s25, 4
    s_lshl_b32 s24, s21, 5
    s_add_u32 s25, s25, s24
    v_lshl_add_u32 v26, v27, 3, v26
    v_add_u32 v13, s25, v26
    v_cmp_eq_u32 s[58:59], 1, v24
    s_lshl_b32 s23, s56, 7
    s_add_u32 s57, s23, 180224
    s_lshl_b32 s23, s56, 9
    s_add_u32 s60, s23, 184320
    v_add_u32 v124, 0, v2
    v_xor_b32 v124, v124, v1
    v_lshlrev_b32 v124, 4, v124
    v_lshl_add_u32 v124, v1, 10, v124
    v_add_u32 v3, 0, v124
    v_add_u32 v124, 4, v2
    v_xor_b32 v124, v124, v1
    v_lshlrev_b32 v124, 4, v124
    v_lshl_add_u32 v124, v1, 10, v124
    v_add_u32 v4, 0, v124
    v_add_u32 v124, 8, v2
    v_xor_b32 v124, v124, v1
    v_lshlrev_b32 v124, 4, v124
    v_lshl_add_u32 v124, v1, 10, v124
    v_add_u32 v5, 0, v124
    v_add_u32 v124, 12, v2
    v_xor_b32 v124, v124, v1
    v_lshlrev_b32 v124, 4, v124
    v_lshl_add_u32 v124, v1, 10, v124
    v_add_u32 v6, 0, v124
    v_lshlrev_b32 v21, 3, v0
    v_add_u32 v21, 65536, v21
    s_lshl_b32 s23, s20, 11
    v_add_u32 v20, s23, v21
    s_mov_b32 s34, 1
    v_mov_b32 v124, 32
    s_mov_b32 s90, 0
    s_nop 0
Lpoll_31:
    global_load_dword v125, v124, s[10:11] sc1
    s_waitcnt vmcnt(0)
    s_movk_i32 s23, 0x100
    v_cmp_gt_u32 s[40:41], s23, v125
    s_cmp_eq_u64 s[40:41], 0
    s_cbranch_scc1 Lpd_32
    s_add_u32 s90, s90, 1
    s_cmp_lt_u32 s90, 400000
    s_nop 0
    s_cbranch_scc1 Lpoll_31
    v_mov_b32 v126, 108
    v_mov_b32 v127, 267
    global_store_dword v126, v127, s[10:11]
    s_waitcnt vmcnt(0)
    s_endpgm
Lpd_32:
    s_getpc_b64 s[54:55]
LpcLtab_F:
    s_add_u32 s54, s54, Ltab_F - LpcLtab_F
    s_addc_u32 s55, s55, 0
    s_sub_u32 s23, s22, 5
    s_mul_i32 s23, s23, 256
    s_add_u32 s54, s54, s23
    s_addc_u32 s55, s55, 0
LF_item:
    s_lshl_b32 s23, s34, 2
    s_sub_u32 s23, s23, 4
    s_load_dword s31, s[54:55], s23
    s_waitcnt lgkmcnt(0)
    s_cmp_ge_u32 s31, 64
    s_cbranch_scc1 LF_done
    s_and_b32 s35, s31, 31
    s_lshr_b32 s61, s31, 5
    s_lshl_b32 s23, s61, 5
    s_add_u32 s23, s23, s35
    s_lshl_b32 s23, s23, 9
    s_add_u32 s23, s23, 131072
    v_lshlrev_b32 v124, 3, v0
    v_add_u32 v124, s23, v124
    s_mov_b32 s90, 0
    s_nop 0
Lpoll_33:
    global_load_dwordx2 v[24:25], v124, s[4:5] sc1
    s_waitcnt vmcnt(0)
    v_and_b32 v24, v24, v25
    v_cmp_ne_u32 s[40:41], 1, v24
    s_cmp_eq_u64 s[40:41], 0
    s_cbranch_scc1 Lpd_34
    s_add_u32 s90, s90, 1
    s_cmp_lt_u32 s90, 400000
    s_nop 0
    s_cbranch_scc1 Lpoll_33
    v_mov_b32 v126, 96
    v_mov_b32 v127, 264
    global_store_dword v126, v127, s[10:11]
    s_waitcnt vmcnt(0)
    s_endpgm
Lpd_34:
    s_lshl_b32 s33, s61, 21
    s_lshl_b32 s23, s35, 16
    s_add_u32 s33, s33, s23
    s_add_u32 s33, s33, 27262976
    v_add_u32 v125, s33, v13
    global_load_dwordx2 v[22:23], v125, s[4:5] sc1
    s_cmp_ge_u32 s21, 28
    s_cbranch_scc1 LF_cons
    v_lshlrev_b32 v124, 3, v0
    v_add_u32 v124, s60, v124
    global_load_dwordx2 v[16:17], v124, s[4:5] sc1
    v_lshrrev_b32 v24, 3, v0
    s_lshl_b32 s23, s20, 3
    v_add_u32 v24, s23, v24
    v_and_b32 v25, 7, v0
    v_lshlrev_b32 v26, 10, v24
    v_lshl_add_u32 v26, v25, 4, v26
    v_add_u32 v26, s33, v26
    v_add_u32 v27, 32768, v26
    global_load_dwordx4 v[92:95], v26, s[4:5] offset:0 sc1
    global_load_dwordx4 v[96:99], v26, s[4:5] offset:128 sc1
    global_load_dwordx4 v[100:103], v26, s[4:5] offset:256 sc1
    global_load_dwordx4 v[104:107], v26, s[4:5] offset:384 sc1
    global_load_dwordx4 v[108:111], v26, s[4:5] offset:512 sc1
    global_load_dwordx4 v[112:115], v26, s[4:5] offset:640 sc1
    global_load_dwordx4 v[116:119], v26, s[4:5] offset:768 sc1
    global_load_dwordx4 v[120:123], v26, s[4:5] offset:896 sc1
    global_load_dwordx4 v[28:31], v27, s[4:5] offset:0 sc1
    global_load_dwordx4 v[32:35], v27, s[4:5] offset:128 sc1
    global_load_dwordx4 v[36:39], v27, s[4:5] offset:256 sc1
    global_load_dwordx4 v[40:43], v27, s[4:5] offset:384 sc1
    global_load_dwordx4 v[44:47], v27, s[4:5] offset:512 sc1
    global_load_dwordx4 v[48:51], v27, s[4:5] offset:640 sc1
    global_load_dwordx4 v[52:55], v27, s[4:5] offset:768 sc1
    global_load_dwordx4 v[56:59], v27, s[4:5] offset:896 sc1
    v_and_b32 v27, 7, v24
    v_xor_b32 v27, v27, v25
    v_lshlrev_b32 v27, 4, v27
    v_lshl_add_u32 v27, v24, 10, v27
    v_bfe_u32 v25, v24, 3, 1
    v_lshl_add_u32 v27, v25, 7, v27
    v_add_u32 v27, 0, v27
    v_xor_b32 v25, 128, v27
    s_waitcnt vmcnt(15)
    v_lshlrev_b32 v60, 16, v92
    v_and_b32 v61, 0xffff0000, v92
    v_lshlrev_b32 v62, 16, v93
    v_and_b32 v63, 0xffff0000, v93
    v_lshlrev_b32 v64, 16, v94
    v_and_b32 v65, 0xffff0000, v94
    v_lshlrev_b32 v66, 16, v95
    v_and_b32 v67, 0xffff0000, v95
    s_waitcnt vmcnt(14)
    v_lshlrev_b32 v68, 16, v96
    v_and_b32 v69, 0xffff0000, v96
    v_lshlrev_b32 v70, 16, v97
    v_and_b32 v71, 0xffff0000, v97
    v_lshlrev_b32 v72, 16, v98
    v_and_b32 v73, 0xffff0000, v98
    v_lshlrev_b32 v74, 16, v99
    v_and_b32 v75, 0xffff0000, v99
    s_waitcnt vmcnt(13)
    v_lshlrev_b32 v76, 16, v100
    v_and_b32 v77, 0xffff0000, v100
    v_lshlrev_b32 v78, 16, v101
    v_and_b32 v79, 0xffff0000, v101
    v_lshlrev_b32 v80, 16, v102
    v_and_b32 v81, 0xffff0000, v102
    v_lshlrev_b32 v82, 16, v103
    v_and_b32 v83, 0xffff0000, v103
    s_waitcnt vmcnt(12)
    v_lshlrev_b32 v84, 16, v104
    v_and_b32 v85, 0xffff0000, v104
    v_lshlrev_b32 v86, 16, v105
    v_and_b32 v87, 0xffff0000, v105
    v_lshlrev_b32 v88, 16, v106
    v_and_b32 v89, 0xffff0000, v106
    v_lshlrev_b32 v90, 16, v107
    v_and_b32 v91, 0xffff0000, v107
    s_waitcnt vmcnt(11)
    v_lshlrev_b32 v92, 16, v108
    v_and_b32 v93, 0xffff0000, v108
    v_lshlrev_b32 v94, 16, v109
    v_and_b32 v95, 0xffff0000, v109
    v_lshlrev_b32 v96, 16, v110
    v_and_b32 v97, 0xffff0000, v110
    v_lshlrev_b32 v98, 16, v111
    v_and_b32 v99, 0xffff0000, v111
    s_waitcnt vmcnt(10)
    v_lshlrev_b32 v100, 16, v112
    v_and_b32 v101, 0xffff0000, v112
    v_lshlrev_b32 v102, 16, v113
    v_and_b32 v103, 0xffff0000, v113
    v_lshlrev_b32 v104, 16, v114
    v_and_b32 v105, 0xffff0000, v114
    v_lshlrev_b32 v106, 16, v115
    v_and_b32 v107, 0xffff0000, v115
    s_waitcnt vmcnt(9)
    v_lshlrev_b32 v108, 16, v116
    v_and_b32 v109, 0xffff0000, v116
    v_lshlrev_b32 v110, 16, v117
    v_and_b32 v111, 0xffff0000, v117
    v_lshlrev_b32 v112, 16, v118
    v_and_b32 v113, 0xffff0000, v118
    v_lshlrev_b32 v114, 16, v119
    v_and_b32 v115, 0xffff0000, v119
    s_waitcnt vmcnt(8)
    v_lshlrev_b32 v116, 16, v120
    v_and_b32 v117, 0xffff0000, v120
    v_lshlrev_b32 v118, 16, v121
    v_and_b32 v119, 0xffff0000, v121
    v_lshlrev_b32 v120, 16, v122
    v_and_b32 v121, 0xffff0000, v122
    v_lshlrev_b32 v122, 16, v123
    v_and_b32 v123, 0xffff0000, v123
    v_pk_add_f32 v[124:125], v[60:61], v[62:63]
    v_pk_add_f32 v[124:125], v[124:125], v[64:65]
    v_pk_add_f32 v[124:125], v[124:125], v[66:67]
    v_pk_add_f32 v[124:125], v[124:125], v[68:69]
    v_pk_add_f32 v[124:125], v[124:125], v[70:71]
    v_pk_add_f32 v[124:125], v[124:125], v[72:73]
    v_pk_add_f32 v[124:125], v[124:125], v[74:75]
    v_pk_add_f32 v[124:125], v[124:125], v[76:77]
    v_pk_add_f32 v[124:125], v[124:125], v[78:79]
    v_pk_add_f32 v[124:125], v[124:125], v[80:81]
    v_pk_add_f32 v[124:125], v[124:125], v[82:83]
    v_pk_add_f32 v[124:125], v[124:125], v[84:85]
    v_pk_add_f32 v[124:125], v[124:125], v[86:87]
    v_pk_add_f32 v[124:125], v[124:125], v[88:89]
    v_pk_add_f32 v[124:125], v[124:125], v[90:91]
    v_pk_add_f32 v[124:125], v[124:125], v[92:93]
    v_pk_add_f32 v[124:125], v[124:125], v[94:95]
    v_pk_add_f32 v[124:125], v[124:125], v[96:97]
    v_pk_add_f32 v[124:125], v[124:125], v[98:99]
    v_pk_add_f32 v[124:125], v[124:125], v[100:101]
    v_pk_add_f32 v[124:125], v[124:125], v[102:103]
    v_pk_add_f32 v[124:125], v[124:125], v[104:105]
    v_pk_add_f32 v[124:125], v[124:125], v[106:107]
    v_pk_add_f32 v[124:125], v[124:125], v[108:109]
    v_pk_add_f32 v[124:125], v[124:125], v[110:111]
    v_pk_add_f32 v[124:125], v[124:125], v[112:113]
    v_pk_add_f32 v[124:125], v[124:125], v[114:115]
    v_pk_add_f32 v[124:125], v[124:125], v[116:117]
    v_pk_add_f32 v[124:125], v[124:125], v[118:119]
    v_pk_add_f32 v[124:125], v[124:125], v[120:121]
    v_pk_add_f32 v[124:125], v[124:125], v[122:123]
    v_add_f32 v124, v124, v125
    s_nop 1
    v_add_f32_dpp v124, v124, v124 quad_perm:[1,0,3,2] row_mask:0xf bank_mask:0xf
    s_nop 1
    v_add_f32_dpp v124, v124, v124 quad_perm:[2,3,0,1] row_mask:0xf bank_mask:0xf
    s_nop 1
    v_add_f32_dpp v124, v124, v124 row_half_mirror row_mask:0xf bank_mask:0xf
    v_mul_f32 v124, 0xbb000000, v124
    v_mov_b32 v125, v124
    v_pk_add_f32 v[60:61], v[60:61], v[124:125]
    v_pk_add_f32 v[62:63], v[62:63], v[124:125]
    v_pk_add_f32 v[64:65], v[64:65], v[124:125]
    v_pk_add_f32 v[66:67], v[66:67], v[124:125]
    v_pk_add_f32 v[68:69], v[68:69], v[124:125]
    v_pk_add_f32 v[70:71], v[70:71], v[124:125]
    v_pk_add_f32 v[72:73], v[72:73], v[124:125]
    v_pk_add_f32 v[74:75], v[74:75], v[124:125]
    v_pk_add_f32 v[76:77], v[76:77], v[124:125]
    v_pk_add_f32 v[78:79], v[78:79], v[124:125]
    v_pk_add_f32 v[80:81], v[80:81], v[124:125]
    v_pk_add_f32 v[82:83], v[82:83], v[124:125]
    v_pk_add_f32 v[84:85], v[84:85], v[124:125]
    v_pk_add_f32 v[86:87], v[86:87], v[124:125]
    v_pk_add_f32 v[88:89], v[88:89], v[124:125]
    v_pk_add_f32 v[90:91], v[90:91], v[124:125]
    v_pk_add_f32 v[92:93], v[92:93], v[124:125]
    v_pk_add_f32 v[94:95], v[94:95], v[124:125]
    v_pk_add_f32 v[96:97], v[96:97], v[124:125]
    v_pk_add_f32 v[98:99], v[98:99], v[124:125]
    v_pk_add_f32 v[100:101], v[100:101], v[124:125]
    v_pk_add_f32 v[102:103], v[102:103], v[124:125]
    v_pk_add_f32 v[104:105], v[104:105], v[124:125]
    v_pk_add_f32 v[106:107], v[106:107], v[124:125]
    v_pk_add_f32 v[108:109], v[108:109], v[124:125]
    v_pk_add_f32 v[110:111], v[110:111], v[124:125]
    v_pk_add_f32 v[112:113], v[112:113], v[124:125]
    v_pk_add_f32 v[114:115], v[114:115], v[124:125]
    v_pk_add_f32 v[116:117], v[116:117], v[124:125]
    v_pk_add_f32 v[118:119], v[118:119], v[124:125]
    v_pk_add_f32 v[120:121], v[120:121], v[124:125]
    v_pk_add_f32 v[122:123], v[122:123], v[124:125]
    v_pk_mul_f32 v[124:125], v[60:61], v[60:61]
    v_pk_fma_f32 v[124:125], v[62:63], v[62:63], v[124:125]
    v_pk_fma_f32 v[124:125], v[64:65], v[64:65], v[124:125]
    v_pk_fma_f32 v[124:125], v[66:67], v[66:67], v[124:125]
    v_pk_fma_f32 v[124:125], v[68:69], v[68:69], v[124:125]
    v_pk_fma_f32 v[124:125], v[70:71], v[70:71], v[124:125]
    v_pk_fma_f32 v[124:125], v[72:73], v[72:73], v[124:125]
    v_pk_fma_f32 v[124:125], v[74:75], v[74:75], v[124:125]
    v_pk_fma_f32 v[124:125], v[76:77], v[76:77], v[124:125]
    v_pk_fma_f32 v[124:125], v[78:79], v[78:79], v[124:125]
    v_pk_fma_f32 v[124:125], v[80:81], v[80:81], v[124:125]
    v_pk_fma_f32 v[124:125], v[82:83], v[82:83], v[124:125]
    v_pk_fma_f32 v[124:125], v[84:85], v[84:85], v[124:125]
    v_pk_fma_f32 v[124:125], v[86:87], v[86:87], v[124:125]
    v_pk_fma_f32 v[124:125], v[88:89], v[88:89], v[124:125]
    v_pk_fma_f32 v[124:125], v[90:91], v[90:91], v[124:125]
    v_pk_fma_f32 v[124:125], v[92:93], v[92:93], v[124:125]
    v_pk_fma_f32 v[124:125], v[94:95], v[94:95], v[124:125]
    v_pk_fma_f32 v[124:125], v[96:97], v[96:97], v[124:125]
    v_pk_fma_f32 v[124:125], v[98:99], v[98:99], v[124:125]
    v_pk_fma_f32 v[124:125], v[100:101], v[100:101], v[124:125]
    v_pk_fma_f32 v[124:125], v[102:103], v[102:103], v[124:125]
    v_pk_fma_f32 v[124:125], v[104:105], v[104:105], v[124:125]
    v_pk_fma_f32 v[124:125], v[106:107], v[106:107], v[124:125]
    v_pk_fma_f32 v[124:125], v[108:109], v[108:109], v[124:125]
    v_pk_fma_f32 v[124:125], v[110:111], v[110:111], v[124:125]
    v_pk_fma_f32 v[124:125], v[112:113], v[112:113], v[124:125]
    v_pk_fma_f32 v[124:125], v[114:115], v[114:115], v[124:125]
    v_pk_fma_f32 v[124:125], v[116:117], v[116:117], v[124:125]
    v_pk_fma_f32 v[124:125], v[118:119], v[118:119], v[124:125]
    v_pk_fma_f32 v[124:125], v[120:121], v[120:121], v[124:125]
    v_pk_fma_f32 v[124:125], v[122:123], v[122:123], v[124:125]
    v_add_f32 v124, v124, v125
    s_nop 1
    v_add_f32_dpp v124, v124, v124 quad_perm:[1,0,3,2] row_mask:0xf bank_mask:0xf
    s_nop 1
    v_add_f32_dpp v124, v124, v124 quad_perm:[2,3,0,1] row_mask:0xf bank_mask:0xf
    s_nop 1
    v_add_f32_dpp v124, v124, v124 row_half_mirror row_mask:0xf bank_mask:0xf
    v_mov_b32 v125, 0x3727c5ac
    v_fmac_f32 v125, 0x3b000000, v124
    v_rsq_f32 v124, v125
    s_nop 0
    v_mov_b32 v125, v124
    v_pk_mul_f32 v[60:61], v[60:61], v[124:125]
    v_cvt_pk_bf16_f32 v60, v60, v61
    v_pk_mul_f32 v[62:63], v[62:63], v[124:125]
    v_cvt_pk_bf16_f32 v61, v62, v63
    v_pk_mul_f32 v[64:65], v[64:65], v[124:125]
    v_cvt_pk_bf16_f32 v62, v64, v65
    v_pk_mul_f32 v[66:67], v[66:67], v[124:125]
    v_cvt_pk_bf16_f32 v63, v66, v67
    ds_write_b128 v27, v[60:63] offset:0
    v_pk_mul_f32 v[68:69], v[68:69], v[124:125]
    v_cvt_pk_bf16_f32 v64, v68, v69
    v_pk_mul_f32 v[70:71], v[70:71], v[124:125]
    v_cvt_pk_bf16_f32 v65, v70, v71
    v_pk_mul_f32 v[72:73], v[72:73], v[124:125]
    v_cvt_pk_bf16_f32 v66, v72, v73
    v_pk_mul_f32 v[74:75], v[74:75], v[124:125]
    v_cvt_pk_bf16_f32 v67, v74, v75
    ds_write_b128 v25, v[64:67] offset:0
    v_pk_mul_f32 v[76:77], v[76:77], v[124:125]
    v_cvt_pk_bf16_f32 v68, v76, v77
    v_pk_mul_f32 v[78:79], v[78:79], v[124:125]
    v_cvt_pk_bf16_f32 v69, v78, v79
    v_pk_mul_f32 v[80:81], v[80:81], v[124:125]
    v_cvt_pk_bf16_f32 v70, v80, v81
    v_pk_mul_f32 v[82:83], v[82:83], v[124:125]
    v_cvt_pk_bf16_f32 v71, v82, v83
    ds_write_b128 v27, v[68:71] offset:256
    v_pk_mul_f32 v[84:85], v[84:85], v[124:125]
    v_cvt_pk_bf16_f32 v72, v84, v85
    v_pk_mul_f32 v[86:87], v[86:87], v[124:125]
    v_cvt_pk_bf16_f32 v73, v86, v87
    v_pk_mul_f32 v[88:89], v[88:89], v[124:125]
    v_cvt_pk_bf16_f32 v74, v88, v89
    v_pk_mul_f32 v[90:91], v[90:91], v[124:125]
    v_cvt_pk_bf16_f32 v75, v90, v91
    ds_write_b128 v25, v[72:75] offset:256
    v_pk_mul_f32 v[92:93], v[92:93], v[124:125]
    v_cvt_pk_bf16_f32 v76, v92, v93
    v_pk_mul_f32 v[94:95], v[94:95], v[124:125]
    v_cvt_pk_bf16_f32 v77, v94, v95
    v_pk_mul_f32 v[96:97], v[96:97], v[124:125]
    v_cvt_pk_bf16_f32 v78, v96, v97
    v_pk_mul_f32 v[98:99], v[98:99], v[124:125]
    v_cvt_pk_bf16_f32 v79, v98, v99
    ds_write_b128 v27, v[76:79] offset:512
    v_pk_mul_f32 v[100:101], v[100:101], v[124:125]
    v_cvt_pk_bf16_f32 v80, v100, v101
    v_pk_mul_f32 v[102:103], v[102:103], v[124:125]
    v_cvt_pk_bf16_f32 v81, v102, v103
    v_pk_mul_f32 v[104:105], v[104:105], v[124:125]
    v_cvt_pk_bf16_f32 v82, v104, v105
    v_pk_mul_f32 v[106:107], v[106:107], v[124:125]
    v_cvt_pk_bf16_f32 v83, v106, v107
    ds_write_b128 v25, v[80:83] offset:512
    v_pk_mul_f32 v[108:109], v[108:109], v[124:125]
    v_cvt_pk_bf16_f32 v84, v108, v109
    v_pk_mul_f32 v[110:111], v[110:111], v[124:125]
    v_cvt_pk_bf16_f32 v85, v110, v111
    v_pk_mul_f32 v[112:113], v[112:113], v[124:125]
    v_cvt_pk_bf16_f32 v86, v112, v113
    v_pk_mul_f32 v[114:115], v[114:115], v[124:125]
    v_cvt_pk_bf16_f32 v87, v114, v115
    ds_write_b128 v27, v[84:87] offset:768
    v_pk_mul_f32 v[116:117], v[116:117], v[124:125]
    v_cvt_pk_bf16_f32 v88, v116, v117
    v_pk_mul_f32 v[118:119], v[118:119], v[124:125]
    v_cvt_pk_bf16_f32 v89, v118, v119
    v_pk_mul_f32 v[120:121], v[120:121], v[124:125]
    v_cvt_pk_bf16_f32 v90, v120, v121
    v_pk_mul_f32 v[122:123], v[122:123], v[124:125]
    v_cvt_pk_bf16_f32 v91, v122, v123
    ds_write_b128 v25, v[88:91] offset:768
    s_waitcnt vmcnt(7)
    v_lshlrev_b32 v60, 16, v28
    v_and_b32 v61, 0xffff0000, v28
    v_lshlrev_b32 v62, 16, v29
    v_and_b32 v63, 0xffff0000, v29
    v_lshlrev_b32 v64, 16, v30
    v_and_b32 v65, 0xffff0000, v30
    v_lshlrev_b32 v66, 16, v31
    v_and_b32 v67, 0xffff0000, v31
    s_waitcnt vmcnt(6)
    v_lshlrev_b32 v68, 16, v32
    v_and_b32 v69, 0xffff0000, v32
    v_lshlrev_b32 v70, 16, v33
    v_and_b32 v71, 0xffff0000, v33
    v_lshlrev_b32 v72, 16, v34
    v_and_b32 v73, 0xffff0000, v34
    v_lshlrev_b32 v74, 16, v35
    v_and_b32 v75, 0xffff0000, v35
    s_waitcnt vmcnt(5)
    v_lshlrev_b32 v76, 16, v36
    v_and_b32 v77, 0xffff0000, v36
    v_lshlrev_b32 v78, 16, v37
    v_and_b32 v79, 0xffff0000, v37
    v_lshlrev_b32 v80, 16, v38
    v_and_b32 v81, 0xffff0000, v38
    v_lshlrev_b32 v82, 16, v39
    v_and_b32 v83, 0xffff0000, v39
    s_waitcnt vmcnt(4)
    v_lshlrev_b32 v84, 16, v40
    v_and_b32 v85, 0xffff0000, v40
    v_lshlrev_b32 v86, 16, v41
    v_and_b32 v87, 0xffff0000, v41
    v_lshlrev_b32 v88, 16, v42
    v_and_b32 v89, 0xffff0000, v42
    v_lshlrev_b32 v90, 16, v43
    v_and_b32 v91, 0xffff0000, v43
    s_waitcnt vmcnt(3)
    v_lshlrev_b32 v92, 16, v44
    v_and_b32 v93, 0xffff0000, v44
    v_lshlrev_b32 v94, 16, v45
    v_and_b32 v95, 0xffff0000, v45
    v_lshlrev_b32 v96, 16, v46
    v_and_b32 v97, 0xffff0000, v46
    v_lshlrev_b32 v98, 16, v47
    v_and_b32 v99, 0xffff0000, v47
    s_waitcnt vmcnt(2)
    v_lshlrev_b32 v100, 16, v48
    v_and_b32 v101, 0xffff0000, v48
    v_lshlrev_b32 v102, 16, v49
    v_and_b32 v103, 0xffff0000, v49
    v_lshlrev_b32 v104, 16, v50
    v_and_b32 v105, 0xffff0000, v50
    v_lshlrev_b32 v106, 16, v51
    v_and_b32 v107, 0xffff0000, v51
    s_waitcnt vmcnt(1)
    v_lshlrev_b32 v108, 16, v52
    v_and_b32 v109, 0xffff0000, v52
    v_lshlrev_b32 v110, 16, v53
    v_and_b32 v111, 0xffff0000, v53
    v_lshlrev_b32 v112, 16, v54
    v_and_b32 v113, 0xffff0000, v54
    v_lshlrev_b32 v114, 16, v55
    v_and_b32 v115, 0xffff0000, v55
    s_waitcnt vmcnt(0)
    v_lshlrev_b32 v116, 16, v56
    v_and_b32 v117, 0xffff0000, v56
    v_lshlrev_b32 v118, 16, v57
    v_and_b32 v119, 0xffff0000, v57
    v_lshlrev_b32 v120, 16, v58
    v_and_b32 v121, 0xffff0000, v58
    v_lshlrev_b32 v122, 16, v59
    v_and_b32 v123, 0xffff0000, v59
    v_pk_add_f32 v[124:125], v[60:61], v[62:63]
    v_pk_add_f32 v[124:125], v[124:125], v[64:65]
    v_pk_add_f32 v[124:125], v[124:125], v[66:67]
    v_pk_add_f32 v[124:125], v[124:125], v[68:69]
    v_pk_add_f32 v[124:125], v[124:125], v[70:71]
    v_pk_add_f32 v[124:125], v[124:125], v[72:73]
    v_pk_add_f32 v[124:125], v[124:125], v[74:75]
    v_pk_add_f32 v[124:125], v[124:125], v[76:77]
    v_pk_add_f32 v[124:125], v[124:125], v[78:79]
    v_pk_add_f32 v[124:125], v[124:125], v[80:81]
    v_pk_add_f32 v[124:125], v[124:125], v[82:83]
    v_pk_add_f32 v[124:125], v[124:125], v[84:85]
    v_pk_add_f32 v[124:125], v[124:125], v[86:87]
    v_pk_add_f32 v[124:125], v[124:125], v[88:89]
    v_pk_add_f32 v[124:125], v[124:125], v[90:91]
    v_pk_add_f32 v[124:125], v[124:125], v[92:93]
    v_pk_add_f32 v[124:125], v[124:125], v[94:95]
    v_pk_add_f32 v[124:125], v[124:125], v[96:97]
    v_pk_add_f32 v[124:125], v[124:125], v[98:99]
    v_pk_add_f32 v[124:125], v[124:125], v[100:101]
    v_pk_add_f32 v[124:125], v[124:125], v[102:103]
    v_pk_add_f32 v[124:125], v[124:125], v[104:105]
    v_pk_add_f32 v[124:125], v[124:125], v[106:107]
    v_pk_add_f32 v[124:125], v[124:125], v[108:109]
    v_pk_add_f32 v[124:125], v[124:125], v[110:111]
    v_pk_add_f32 v[124:125], v[124:125], v[112:113]
    v_pk_add_f32 v[124:125], v[124:125], v[114:115]
    v_pk_add_f32 v[124:125], v[124:125], v[116:117]
    v_pk_add_f32 v[124:125], v[124:125], v[118:119]
    v_pk_add_f32 v[124:125], v[124:125], v[120:121]
    v_pk_add_f32 v[124:125], v[124:125], v[122:123]
    v_add_f32 v124, v124, v125
    s_nop 1
    v_add_f32_dpp v124, v124, v124 quad_perm:[1,0,3,2] row_mask:0xf bank_mask:0xf
    s_nop 1
    v_add_f32_dpp v124, v124, v124 quad_perm:[2,3,0,1] row_mask:0xf bank_mask:0xf
    s_nop 1
    v_add_f32_dpp v124, v124, v124 row_half_mirror row_mask:0xf bank_mask:0xf
    v_mul_f32 v124, 0xbb000000, v124
    v_mov_b32 v125, v124
    v_pk_add_f32 v[60:61], v[60:61], v[124:125]
    v_pk_add_f32 v[62:63], v[62:63], v[124:125]
    v_pk_add_f32 v[64:65], v[64:65], v[124:125]
    v_pk_add_f32 v[66:67], v[66:67], v[124:125]
    v_pk_add_f32 v[68:69], v[68:69], v[124:125]
    v_pk_add_f32 v[70:71], v[70:71], v[124:125]
    v_pk_add_f32 v[72:73], v[72:73], v[124:125]
    v_pk_add_f32 v[74:75], v[74:75], v[124:125]
    v_pk_add_f32 v[76:77], v[76:77], v[124:125]
    v_pk_add_f32 v[78:79], v[78:79], v[124:125]
    v_pk_add_f32 v[80:81], v[80:81], v[124:125]
    v_pk_add_f32 v[82:83], v[82:83], v[124:125]
    v_pk_add_f32 v[84:85], v[84:85], v[124:125]
    v_pk_add_f32 v[86:87], v[86:87], v[124:125]
    v_pk_add_f32 v[88:89], v[88:89], v[124:125]
    v_pk_add_f32 v[90:91], v[90:91], v[124:125]
    v_pk_add_f32 v[92:93], v[92:93], v[124:125]
    v_pk_add_f32 v[94:95], v[94:95], v[124:125]
    v_pk_add_f32 v[96:97], v[96:97], v[124:125]
    v_pk_add_f32 v[98:99], v[98:99], v[124:125]
    v_pk_add_f32 v[100:101], v[100:101], v[124:125]
    v_pk_add_f32 v[102:103], v[102:103], v[124:125]
    v_pk_add_f32 v[104:105], v[104:105], v[124:125]
    v_pk_add_f32 v[106:107], v[106:107], v[124:125]
    v_pk_add_f32 v[108:109], v[108:109], v[124:125]
    v_pk_add_f32 v[110:111], v[110:111], v[124:125]
    v_pk_add_f32 v[112:113], v[112:113], v[124:125]
    v_pk_add_f32 v[114:115], v[114:115], v[124:125]
    v_pk_add_f32 v[116:117], v[116:117], v[124:125]
    v_pk_add_f32 v[118:119], v[118:119], v[124:125]
    v_pk_add_f32 v[120:121], v[120:121], v[124:125]
    v_pk_add_f32 v[122:123], v[122:123], v[124:125]
    v_pk_mul_f32 v[124:125], v[60:61], v[60:61]
    v_pk_fma_f32 v[124:125], v[62:63], v[62:63], v[124:125]
    v_pk_fma_f32 v[124:125], v[64:65], v[64:65], v[124:125]
    v_pk_fma_f32 v[124:125], v[66:67], v[66:67], v[124:125]
    v_pk_fma_f32 v[124:125], v[68:69], v[68:69], v[124:125]
    v_pk_fma_f32 v[124:125], v[70:71], v[70:71], v[124:125]
    v_pk_fma_f32 v[124:125], v[72:73], v[72:73], v[124:125]
    v_pk_fma_f32 v[124:125], v[74:75], v[74:75], v[124:125]
    v_pk_fma_f32 v[124:125], v[76:77], v[76:77], v[124:125]
    v_pk_fma_f32 v[124:125], v[78:79], v[78:79], v[124:125]
    v_pk_fma_f32 v[124:125], v[80:81], v[80:81], v[124:125]
    v_pk_fma_f32 v[124:125], v[82:83], v[82:83], v[124:125]
    v_pk_fma_f32 v[124:125], v[84:85], v[84:85], v[124:125]
    v_pk_fma_f32 v[124:125], v[86:87], v[86:87], v[124:125]
    v_pk_fma_f32 v[124:125], v[88:89], v[88:89], v[124:125]
    v_pk_fma_f32 v[124:125], v[90:91], v[90:91], v[124:125]
    v_pk_fma_f32 v[124:125], v[92:93], v[92:93], v[124:125]
    v_pk_fma_f32 v[124:125], v[94:95], v[94:95], v[124:125]
    v_pk_fma_f32 v[124:125], v[96:97], v[96:97], v[124:125]
    v_pk_fma_f32 v[124:125], v[98:99], v[98:99], v[124:125]
    v_pk_fma_f32 v[124:125], v[100:101], v[100:101], v[124:125]
    v_pk_fma_f32 v[124:125], v[102:103], v[102:103], v[124:125]
    v_pk_fma_f32 v[124:125], v[104:105], v[104:105], v[124:125]
    v_pk_fma_f32 v[124:125], v[106:107], v[106:107], v[124:125]
    v_pk_fma_f32 v[124:125], v[108:109], v[108:109], v[124:125]
    v_pk_fma_f32 v[124:125], v[110:111], v[110:111], v[124:125]
    v_pk_fma_f32 v[124:125], v[112:113], v[112:113], v[124:125]
    v_pk_fma_f32 v[124:125], v[114:115], v[114:115], v[124:125]
    v_pk_fma_f32 v[124:125], v[116:117], v[116:117], v[124:125]
    v_pk_fma_f32 v[124:125], v[118:119], v[118:119], v[124:125]
    v_pk_fma_f32 v[124:125], v[120:121], v[120:121], v[124:125]
    v_pk_fma_f32 v[124:125], v[122:123], v[122:123], v[124:125]
    v_add_f32 v124, v124, v125
    s_nop 1
    v_add_f32_dpp v124, v124, v124 quad_perm:[1,0,3,2] row_mask:0xf bank_mask:0xf
    s_nop 1
    v_add_f32_dpp v124, v124, v124 quad_perm:[2,3,0,1] row_mask:0xf bank_mask:0xf
    s_nop 1
    v_add_f32_dpp v124, v124, v124 row_half_mirror row_mask:0xf bank_mask:0xf
    v_mov_b32 v125, 0x3727c5ac
    v_fmac_f32 v125, 0x3b000000, v124
    v_rsq_f32 v124, v125
    s_nop 0
    v_mov_b32 v125, v124
    v_pk_mul_f32 v[60:61], v[60:61], v[124:125]
    v_cvt_pk_bf16_f32 v60, v60, v61
    v_pk_mul_f32 v[62:63], v[62:63], v[124:125]
    v_cvt_pk_bf16_f32 v61, v62, v63
    v_pk_mul_f32 v[64:65], v[64:65], v[124:125]
    v_cvt_pk_bf16_f32 v62, v64, v65
    v_pk_mul_f32 v[66:67], v[66:67], v[124:125]
    v_cvt_pk_bf16_f32 v63, v66, v67
    ds_write_b128 v27, v[60:63] offset:32768
    v_pk_mul_f32 v[68:69], v[68:69], v[124:125]
    v_cvt_pk_bf16_f32 v64, v68, v69
    v_pk_mul_f32 v[70:71], v[70:71], v[124:125]
    v_cvt_pk_bf16_f32 v65, v70, v71
    v_pk_mul_f32 v[72:73], v[72:73], v[124:125]
    v_cvt_pk_bf16_f32 v66, v72, v73
    v_pk_mul_f32 v[74:75], v[74:75], v[124:125]
    v_cvt_pk_bf16_f32 v67, v74, v75
    ds_write_b128 v25, v[64:67] offset:32768
    v_pk_mul_f32 v[76:77], v[76:77], v[124:125]
    v_cvt_pk_bf16_f32 v68, v76, v77
    v_pk_mul_f32 v[78:79], v[78:79], v[124:125]
    v_cvt_pk_bf16_f32 v69, v78, v79
    v_pk_mul_f32 v[80:81], v[80:81], v[124:125]
    v_cvt_pk_bf16_f32 v70, v80, v81
    v_pk_mul_f32 v[82:83], v[82:83], v[124:125]
    v_cvt_pk_bf16_f32 v71, v82, v83
    ds_write_b128 v27, v[68:71] offset:33024
    v_pk_mul_f32 v[84:85], v[84:85], v[124:125]
    v_cvt_pk_bf16_f32 v72, v84, v85
    v_pk_mul_f32 v[86:87], v[86:87], v[124:125]
    v_cvt_pk_bf16_f32 v73, v86, v87
    v_pk_mul_f32 v[88:89], v[88:89], v[124:125]
    v_cvt_pk_bf16_f32 v74, v88, v89
    v_pk_mul_f32 v[90:91], v[90:91], v[124:125]
    v_cvt_pk_bf16_f32 v75, v90, v91
    ds_write_b128 v25, v[72:75] offset:33024
    v_pk_mul_f32 v[92:93], v[92:93], v[124:125]
    v_cvt_pk_bf16_f32 v76, v92, v93
    v_pk_mul_f32 v[94:95], v[94:95], v[124:125]
    v_cvt_pk_bf16_f32 v77, v94, v95
    v_pk_mul_f32 v[96:97], v[96:97], v[124:125]
    v_cvt_pk_bf16_f32 v78, v96, v97
    v_pk_mul_f32 v[98:99], v[98:99], v[124:125]
    v_cvt_pk_bf16_f32 v79, v98, v99
    ds_write_b128 v27, v[76:79] offset:33280
    v_pk_mul_f32 v[100:101], v[100:101], v[124:125]
    v_cvt_pk_bf16_f32 v80, v100, v101
    v_pk_mul_f32 v[102:103], v[102:103], v[124:125]
    v_cvt_pk_bf16_f32 v81, v102, v103
    v_pk_mul_f32 v[104:105], v[104:105], v[124:125]
    v_cvt_pk_bf16_f32 v82, v104, v105
    v_pk_mul_f32 v[106:107], v[106:107], v[124:125]
    v_cvt_pk_bf16_f32 v83, v106, v107
    ds_write_b128 v25, v[80:83] offset:33280
    v_pk_mul_f32 v[108:109], v[108:109], v[124:125]
    v_cvt_pk_bf16_f32 v84, v108, v109
    v_pk_mul_f32 v[110:111], v[110:111], v[124:125]
    v_cvt_pk_bf16_f32 v85, v110, v111
    v_pk_mul_f32 v[112:113], v[112:113], v[124:125]
    v_cvt_pk_bf16_f32 v86, v112, v113
    v_pk_mul_f32 v[114:115], v[114:115], v[124:125]
    v_cvt_pk_bf16_f32 v87, v114, v115
    ds_write_b128 v27, v[84:87] offset:33536
    v_pk_mul_f32 v[116:117], v[116:117], v[124:125]
    v_cvt_pk_bf16_f32 v88, v116, v117
    v_pk_mul_f32 v[118:119], v[118:119], v[124:125]
    v_cvt_pk_bf16_f32 v89, v118, v119
    v_pk_mul_f32 v[120:121], v[120:121], v[124:125]
    v_cvt_pk_bf16_f32 v90, v120, v121
    v_pk_mul_f32 v[122:123], v[122:123], v[124:125]
    v_cvt_pk_bf16_f32 v91, v122, v123
    ds_write_b128 v25, v[88:91] offset:33536
    s_waitcnt lgkmcnt(0)
    s_barrier
    ds_read_b128 v[56:59], v3 offset:0
    ds_read_b128 v[60:63], v3 offset:16384
    ds_read_b128 v[64:67], v3 offset:32768
    ds_read_b128 v[68:71], v3 offset:49152
    ds_read_b128 v[72:75], v4 offset:0
    ds_read_b128 v[76:79], v4 offset:16384
    ds_read_b128 v[80:83], v4 offset:32768
    ds_read_b128 v[84:87], v4 offset:49152
    s_waitcnt lgkmcnt(4)
    v_mfma_f32_16x16x32_bf16 v[24:27], a[0:3], v[56:59], 0
    v_mfma_f32_16x16x32_bf16 v[40:43], a[64:67], v[56:59], 0
    v_mfma_f32_16x16x32_bf16 v[28:31], a[0:3], v[60:63], 0
    v_mfma_f32_16x16x32_bf16 v[44:47], a[64:67], v[60:63], 0
    v_mfma_f32_16x16x32_bf16 v[32:35], a[0:3], v[64:67], 0
    v_mfma_f32_16x16x32_bf16 v[48:51], a[64:67], v[64:67], 0
    v_mfma_f32_16x16x32_bf16 v[36:39], a[0:3], v[68:71], 0
    v_mfma_f32_16x16x32_bf16 v[52:55], a[64:67], v[68:71], 0
    ds_read_b128 v[56:59], v5 offset:0
    ds_read_b128 v[60:63], v5 offset:16384
    ds_read_b128 v[64:67], v5 offset:32768
    ds_read_b128 v[68:71], v5 offset:49152
    s_waitcnt lgkmcnt(4)
    v_mfma_f32_16x16x32_bf16 v[24:27], a[4:7], v[72:75], v[24:27]
    v_mfma_f32_16x16x32_bf16 v[40:43], a[68:71], v[72:75], v[40:43]
    v_mfma_f32_16x16x32_bf16 v[28:31], a[4:7], v[76:79], v[28:31]
    v_mfma_f32_16x16x32_bf16 v[44:47], a[68:71], v[76:79], v[44:47]
    v_mfma_f32_16x16x32_bf16 v[32:35], a[4:7], v[80:83], v[32:35]
    v_mfma_f32_16x16x32_bf16 v[48:51], a[68:71], v[80:83], v[48:51]
    v_mfma_f32_16x16x32_bf16 v[36:39], a[4:7], v[84:87], v[36:39]
    v_mfma_f32_16x16x32_bf16 v[52:55], a[68:71], v[84:87], v[52:55]
    ds_read_b128 v[72:75], v6 offset:0
    ds_read_b128 v[76:79], v6 offset:16384
    ds_read_b128 v[80:83], v6 offset:32768
    ds_read_b128 v[84:87], v6 offset:49152
    s_waitcnt lgkmcnt(4)
    v_mfma_f32_16x16x32_bf16 v[24:27], a[8:11], v[56:59], v[24:27]
    v_mfma_f32_16x16x32_bf16 v[40:43], a[72:75], v[56:59], v[40:43]
    v_mfma_f32_16x16x32_bf16 v[28:31], a[8:11], v[60:63], v[28:31]
    v_mfma_f32_16x16x32_bf16 v[44:47], a[72:75], v[60:63], v[44:47]
    v_mfma_f32_16x16x32_bf16 v[32:35], a[8:11], v[64:67], v[32:35]
    v_mfma_f32_16x16x32_bf16 v[48:51], a[72:75], v[64:67], v[48:51]
    v_mfma_f32_16x16x32_bf16 v[36:39], a[8:11], v[68:71], v[36:39]
    v_mfma_f32_16x16x32_bf16 v[52:55], a[72:75], v[68:71], v[52:55]
    ds_read_b128 v[56:59], v3 offset:256
    ds_read_b128 v[60:63], v3 offset:16640
    ds_read_b128 v[64:67], v3 offset:33024
    ds_read_b128 v[68:71], v3 offset:49408
    s_waitcnt lgkmcnt(4)
    v_mfma_f32_16x16x32_bf16 v[24:27], a[12:15], v[72:75], v[24:27]
    v_mfma_f32_16x16x32_bf16 v[40:43], a[76:79], v[72:75], v[40:43]
    v_mfma_f32_16x16x32_bf16 v[28:31], a[12:15], v[76:79], v[28:31]
    v_mfma_f32_16x16x32_bf16 v[44:47], a[76:79], v[76:79], v[44:47]
    v_mfma_f32_16x16x32_bf16 v[32:35], a[12:15], v[80:83], v[32:35]
    v_mfma_f32_16x16x32_bf16 v[48:51], a[76:79], v[80:83], v[48:51]
    v_mfma_f32_16x16x32_bf16 v[36:39], a[12:15], v[84:87], v[36:39]
    v_mfma_f32_16x16x32_bf16 v[52:55], a[76:79], v[84:87], v[52:55]
    ds_read_b128 v[72:75], v4 offset:256
    ds_read_b128 v[76:79], v4 offset:16640
    ds_read_b128 v[80:83], v4 offset:33024
    ds_read_b128 v[84:87], v4 offset:49408
    s_waitcnt lgkmcnt(4)
    v_mfma_f32_16x16x32_bf16 v[24:27], a[16:19], v[56:59], v[24:27]
    v_mfma_f32_16x16x32_bf16 v[40:43], a[80:83], v[56:59], v[40:43]
    v_mfma_f32_16x16x32_bf16 v[28:31], a[16:19], v[60:63], v[28:31]
    v_mfma_f32_16x16x32_bf16 v[44:47], a[80:83], v[60:63], v[44:47]
    v_mfma_f32_16x16x32_bf16 v[32:35], a[16:19], v[64:67], v[32:35]
    v_mfma_f32_16x16x32_bf16 v[48:51], a[80:83], v[64:67], v[48:51]
    v_mfma_f32_16x16x32_bf16 v[36:39], a[16:19], v[68:71], v[36:39]
    v_mfma_f32_16x16x32_bf16 v[52:55], a[80:83], v[68:71], v[52:55]
    ds_read_b128 v[56:59], v5 offset:256
    ds_read_b128 v[60:63], v5 offset:16640
    ds_read_b128 v[64:67], v5 offset:33024
    ds_read_b128 v[68:71], v5 offset:49408
    s_waitcnt lgkmcnt(4)
    v_mfma_f32_16x16x32_bf16 v[24:27], a[20:23], v[72:75], v[24:27]
    v_mfma_f32_16x16x32_bf16 v[40:43], a[84:87], v[72:75], v[40:43]
    v_mfma_f32_16x16x32_bf16 v[28:31], a[20:23], v[76:79], v[28:31]
    v_mfma_f32_16x16x32_bf16 v[44:47], a[84:87], v[76:79], v[44:47]
    v_mfma_f32_16x16x32_bf16 v[32:35], a[20:23], v[80:83], v[32:35]
    v_mfma_f32_16x16x32_bf16 v[48:51], a[84:87], v[80:83], v[48:51]
    v_mfma_f32_16x16x32_bf16 v[36:39], a[20:23], v[84:87], v[36:39]
    v_mfma_f32_16x16x32_bf16 v[52:55], a[84:87], v[84:87], v[52:55]
    ds_read_b128 v[72:75], v6 offset:256
    ds_read_b128 v[76:79], v6 offset:16640
    ds_read_b128 v[80:83], v6 offset:33024
    ds_read_b128 v[84:87], v6 offset:49408
    s_waitcnt lgkmcnt(4)
    v_mfma_f32_16x16x32_bf16 v[24:27], a[24:27], v[56:59], v[24:27]
    v_mfma_f32_16x16x32_bf16 v[40:43], a[88:91], v[56:59], v[40:43]
    v_mfma_f32_16x16x32_bf16 v[28:31], a[24:27], v[60:63], v[28:31]
    v_mfma_f32_16x16x32_bf16 v[44:47], a[88:91], v[60:63], v[44:47]
    v_mfma_f32_16x16x32_bf16 v[32:35], a[24:27], v[64:67], v[32:35]
    v_mfma_f32_16x16x32_bf16 v[48:51], a[88:91], v[64:67], v[48:51]
    v_mfma_f32_16x16x32_bf16 v[36:39], a[24:27], v[68:71], v[36:39]
    v_mfma_f32_16x16x32_bf16 v[52:55], a[88:91], v[68:71], v[52:55]
    ds_read_b128 v[56:59], v3 offset:512
    ds_read_b128 v[60:63], v3 offset:16896
    ds_read_b128 v[64:67], v3 offset:33280
    ds_read_b128 v[68:71], v3 offset:49664
    s_waitcnt lgkmcnt(4)
    v_mfma_f32_16x16x32_bf16 v[24:27], a[28:31], v[72:75], v[24:27]
    v_mfma_f32_16x16x32_bf16 v[40:43], a[92:95], v[72:75], v[40:43]
    v_mfma_f32_16x16x32_bf16 v[28:31], a[28:31], v[76:79], v[28:31]
    v_mfma_f32_16x16x32_bf16 v[44:47], a[92:95], v[76:79], v[44:47]
    v_mfma_f32_16x16x32_bf16 v[32:35], a[28:31], v[80:83], v[32:35]
    v_mfma_f32_16x16x32_bf16 v[48:51], a[92:95], v[80:83], v[48:51]
    v_mfma_f32_16x16x32_bf16 v[36:39], a[28:31], v[84:87], v[36:39]
    v_mfma_f32_16x16x32_bf16 v[52:55], a[92:95], v[84:87], v[52:55]
    ds_read_b128 v[72:75], v4 offset:512
    ds_read_b128 v[76:79], v4 offset:16896
    ds_read_b128 v[80:83], v4 offset:33280
    ds_read_b128 v[84:87], v4 offset:49664
    s_waitcnt lgkmcnt(4)
    v_mfma_f32_16x16x32_bf16 v[24:27], a[32:35], v[56:59], v[24:27]
    v_mfma_f32_16x16x32_bf16 v[40:43], a[96:99], v[56:59], v[40:43]
    v_mfma_f32_16x16x32_bf16 v[28:31], a[32:35], v[60:63], v[28:31]
    v_mfma_f32_16x16x32_bf16 v[44:47], a[96:99], v[60:63], v[44:47]
    v_mfma_f32_16x16x32_bf16 v[32:35], a[32:35], v[64:67], v[32:35]
    v_mfma_f32_16x16x32_bf16 v[48:51], a[96:99], v[64:67], v[48:51]
    v_mfma_f32_16x16x32_bf16 v[36:39], a[32:35], v[68:71], v[36:39]
    v_mfma_f32_16x16x32_bf16 v[52:55], a[96:99], v[68:71], v[52:55]
    ds_read_b128 v[56:59], v5 offset:512
    ds_read_b128 v[60:63], v5 offset:16896
    ds_read_b128 v[64:67], v5 offset:33280
    ds_read_b128 v[68:71], v5 offset:49664
    s_waitcnt lgkmcnt(4)
    v_mfma_f32_16x16x32_bf16 v[24:27], a[36:39], v[72:75], v[24:27]
    v_mfma_f32_16x16x32_bf16 v[40:43], a[100:103], v[72:75], v[40:43]
    v_mfma_f32_16x16x32_bf16 v[28:31], a[36:39], v[76:79], v[28:31]
    v_mfma_f32_16x16x32_bf16 v[44:47], a[100:103], v[76:79], v[44:47]
    v_mfma_f32_16x16x32_bf16 v[32:35], a[36:39], v[80:83], v[32:35]
    v_mfma_f32_16x16x32_bf16 v[48:51], a[100:103], v[80:83], v[48:51]
    v_mfma_f32_16x16x32_bf16 v[36:39], a[36:39], v[84:87], v[36:39]
    v_mfma_f32_16x16x32_bf16 v[52:55], a[100:103], v[84:87], v[52:55]
    ds_read_b128 v[72:75], v6 offset:512
    ds_read_b128 v[76:79], v6 offset:16896
    ds_read_b128 v[80:83], v6 offset:33280
    ds_read_b128 v[84:87], v6 offset:49664
    s_waitcnt lgkmcnt(4)
    v_mfma_f32_16x16x32_bf16 v[24:27], a[40:43], v[56:59], v[24:27]
    v_mfma_f32_16x16x32_bf16 v[40:43], a[104:107], v[56:59], v[40:43]
    v_mfma_f32_16x16x32_bf16 v[28:31], a[40:43], v[60:63], v[28:31]
    v_mfma_f32_16x16x32_bf16 v[44:47], a[104:107], v[60:63], v[44:47]
    v_mfma_f32_16x16x32_bf16 v[32:35], a[40:43], v[64:67], v[32:35]
    v_mfma_f32_16x16x32_bf16 v[48:51], a[104:107], v[64:67], v[48:51]
    v_mfma_f32_16x16x32_bf16 v[36:39], a[40:43], v[68:71], v[36:39]
    v_mfma_f32_16x16x32_bf16 v[52:55], a[104:107], v[68:71], v[52:55]
    ds_read_b128 v[56:59], v3 offset:768
    ds_read_b128 v[60:63], v3 offset:17152
    ds_read_b128 v[64:67], v3 offset:33536
    ds_read_b128 v[68:71], v3 offset:49920
    s_waitcnt lgkmcnt(4)
    v_mfma_f32_16x16x32_bf16 v[24:27], a[44:47], v[72:75], v[24:27]
    v_mfma_f32_16x16x32_bf16 v[40:43], a[108:111], v[72:75], v[40:43]
    v_mfma_f32_16x16x32_bf16 v[28:31], a[44:47], v[76:79], v[28:31]
    v_mfma_f32_16x16x32_bf16 v[44:47], a[108:111], v[76:79], v[44:47]
    v_mfma_f32_16x16x32_bf16 v[32:35], a[44:47], v[80:83], v[32:35]
    v_mfma_f32_16x16x32_bf16 v[48:51], a[108:111], v[80:83], v[48:51]
    v_mfma_f32_16x16x32_bf16 v[36:39], a[44:47], v[84:87], v[36:39]
    v_mfma_f32_16x16x32_bf16 v[52:55], a[108:111], v[84:87], v[52:55]
    ds_read_b128 v[72:75], v4 offset:768
    ds_read_b128 v[76:79], v4 offset:17152
    ds_read_b128 v[80:83], v4 offset:33536
    ds_read_b128 v[84:87], v4 offset:49920
    s_waitcnt lgkmcnt(4)
    v_mfma_f32_16x16x32_bf16 v[24:27], a[48:51], v[56:59], v[24:27]
    v_mfma_f32_16x16x32_bf16 v[40:43], a[112:115], v[56:59], v[40:43]
    v_mfma_f32_16x16x32_bf16 v[28:31], a[48:51], v[60:63], v[28:31]
    v_mfma_f32_16x16x32_bf16 v[44:47], a[112:115], v[60:63], v[44:47]
    v_mfma_f32_16x16x32_bf16 v[32:35], a[48:51], v[64:67], v[32:35]
    v_mfma_f32_16x16x32_bf16 v[48:51], a[112:115], v[64:67], v[48:51]
    v_mfma_f32_16x16x32_bf16 v[36:39], a[48:51], v[68:71], v[36:39]
    v_mfma_f32_16x16x32_bf16 v[52:55], a[112:115], v[68:71], v[52:55]
    ds_read_b128 v[56:59], v5 offset:768
    ds_read_b128 v[60:63], v5 offset:17152
    ds_read_b128 v[64:67], v5 offset:33536
    ds_read_b128 v[68:71], v5 offset:49920
    s_waitcnt lgkmcnt(4)
    v_mfma_f32_16x16x32_bf16 v[24:27], a[52:55], v[72:75], v[24:27]
    v_mfma_f32_16x16x32_bf16 v[40:43], a[116:119], v[72:75], v[40:43]
    v_mfma_f32_16x16x32_bf16 v[28:31], a[52:55], v[76:79], v[28:31]
    v_mfma_f32_16x16x32_bf16 v[44:47], a[116:119], v[76:79], v[44:47]
    v_mfma_f32_16x16x32_bf16 v[32:35], a[52:55], v[80:83], v[32:35]
    v_mfma_f32_16x16x32_bf16 v[48:51], a[116:119], v[80:83], v[48:51]
    v_mfma_f32_16x16x32_bf16 v[36:39], a[52:55], v[84:87], v[36:39]
    v_mfma_f32_16x16x32_bf16 v[52:55], a[116:119], v[84:87], v[52:55]
    ds_read_b128 v[72:75], v6 offset:768
    ds_read_b128 v[76:79], v6 offset:17152
    ds_read_b128 v[80:83], v6 offset:33536
    ds_read_b128 v[84:87], v6 offset:49920
    s_waitcnt lgkmcnt(4)
    v_mfma_f32_16x16x32_bf16 v[24:27], a[56:59], v[56:59], v[24:27]
    v_mfma_f32_16x16x32_bf16 v[40:43], a[120:123], v[56:59], v[40:43]
    v_mfma_f32_16x16x32_bf16 v[28:31], a[56:59], v[60:63], v[28:31]
    v_mfma_f32_16x16x32_bf16 v[44:47], a[120:123], v[60:63], v[44:47]
    v_mfma_f32_16x16x32_bf16 v[32:35], a[56:59], v[64:67], v[32:35]
    v_mfma_f32_16x16x32_bf16 v[48:51], a[120:123], v[64:67], v[48:51]
    v_mfma_f32_16x16x32_bf16 v[36:39], a[56:59], v[68:71], v[36:39]
    v_mfma_f32_16x16x32_bf16 v[52:55], a[120:123], v[68:71], v[52:55]
    s_waitcnt lgkmcnt(0)
    v_mfma_f32_16x16x32_bf16 v[24:27], a[60:63], v[72:75], v[24:27]
    v_mfma_f32_16x16x32_bf16 v[40:43], a[124:127], v[72:75], v[40:43]
    v_mfma_f32_16x16x32_bf16 v[28:31], a[60:63], v[76:79], v[28:31]
    v_mfma_f32_16x16x32_bf16 v[44:47], a[124:127], v[76:79], v[44:47]
    v_mfma_f32_16x16x32_bf16 v[32:35], a[60:63], v[80:83], v[32:35]
    v_mfma_f32_16x16x32_bf16 v[48:51], a[124:127], v[80:83], v[48:51]
    v_mfma_f32_16x16x32_bf16 v[36:39], a[60:63], v[84:87], v[36:39]
    v_mfma_f32_16x16x32_bf16 v[52:55], a[124:127], v[84:87], v[52:55]
    s_mov_b32 s23, 0x3d372713
    s_mov_b32 s24, 0xc0135761
    v_cvt_pk_bf16_f32 v56, v24, v25
    v_cvt_pk_bf16_f32 v57, v40, v41
    v_lshlrev_b32 v24, 16, v56
    v_and_b32 v25, 0xffff0000, v56
    v_lshlrev_b32 v40, 16, v57
    v_and_b32 v41, 0xffff0000, v57
    v_cvt_pk_bf16_f32 v56, v26, v27
    v_cvt_pk_bf16_f32 v57, v42, v43
    v_lshlrev_b32 v26, 16, v56
    v_and_b32 v27, 0xffff0000, v56
    v_lshlrev_b32 v42, 16, v57
    v_and_b32 v43, 0xffff0000, v57
    v_cvt_pk_bf16_f32 v56, v28, v29
    v_cvt_pk_bf16_f32 v57, v44, v45
    v_lshlrev_b32 v28, 16, v56
    v_and_b32 v29, 0xffff0000, v56
    v_lshlrev_b32 v44, 16, v57
    v_and_b32 v45, 0xffff0000, v57
    v_cvt_pk_bf16_f32 v56, v30, v31
    v_cvt_pk_bf16_f32 v57, v46, v47
    v_lshlrev_b32 v30, 16, v56
    v_and_b32 v31, 0xffff0000, v56
    v_lshlrev_b32 v46, 16, v57
    v_and_b32 v47, 0xffff0000, v57
    v_cvt_pk_bf16_f32 v56, v32, v33
    v_cvt_pk_bf16_f32 v57, v48, v49
    v_lshlrev_b32 v32, 16, v56
    v_and_b32 v33, 0xffff0000, v56
    v_lshlrev_b32 v48, 16, v57
    v_and_b32 v49, 0xffff0000, v57
    v_cvt_pk_bf16_f32 v56, v34, v35
    v_cvt_pk_bf16_f32 v57, v50, v51
    v_lshlrev_b32 v34, 16, v56
    v_and_b32 v35, 0xffff0000, v56
    v_lshlrev_b32 v50, 16, v57
    v_and_b32 v51, 0xffff0000, v57
    v_cvt_pk_bf16_f32 v56, v36, v37
    v_cvt_pk_bf16_f32 v57, v52, v53
    v_lshlrev_b32 v36, 16, v56
    v_and_b32 v37, 0xffff0000, v56
    v_lshlrev_b32 v52, 16, v57
    v_and_b32 v53, 0xffff0000, v57
    v_cvt_pk_bf16_f32 v56, v38, v39
    v_cvt_pk_bf16_f32 v57, v54, v55
    v_lshlrev_b32 v38, 16, v56
    v_and_b32 v39, 0xffff0000, v56
    v_lshlrev_b32 v54, 16, v57
    v_and_b32 v55, 0xffff0000, v57
    v_mul_f32 v56, v24, v24
    v_mul_f32 v56, s23, v56
    v_fma_f32 v56, v56, v24, v24
    v_mul_f32 v56, s24, v56
    v_mul_f32 v57, v25, v25
    v_mul_f32 v57, s23, v57
    v_fma_f32 v57, v57, v25, v25
    v_mul_f32 v57, s24, v57
    v_mul_f32 v58, v26, v26
    v_mul_f32 v58, s23, v58
    v_fma_f32 v58, v58, v26, v26
    v_mul_f32 v58, s24, v58
    v_mul_f32 v59, v27, v27
    v_mul_f32 v59, s23, v59
    v_fma_f32 v59, v59, v27, v27
    v_mul_f32 v59, s24, v59
    v_mul_f32 v60, v28, v28
    v_mul_f32 v60, s23, v60
    v_fma_f32 v60, v60, v28, v28
    v_mul_f32 v60, s24, v60
    v_mul_f32 v61, v29, v29
    v_mul_f32 v61, s23, v61
    v_fma_f32 v61, v61, v29, v29
    v_mul_f32 v61, s24, v61
    v_mul_f32 v62, v30, v30
    v_mul_f32 v62, s23, v62
    v_fma_f32 v62, v62, v30, v30
    v_mul_f32 v62, s24, v62
    v_mul_f32 v63, v31, v31
    v_mul_f32 v63, s23, v63
    v_fma_f32 v63, v63, v31, v31
    v_mul_f32 v63, s24, v63
    v_mul_f32 v64, v32, v32
    v_mul_f32 v64, s23, v64
    v_fma_f32 v64, v64, v32, v32
    v_mul_f32 v64, s24, v64
    v_mul_f32 v65, v33, v33
    v_mul_f32 v65, s23, v65
    v_fma_f32 v65, v65, v33, v33
    v_mul_f32 v65, s24, v65
    v_mul_f32 v66, v34, v34
    v_mul_f32 v66, s23, v66
    v_fma_f32 v66, v66, v34, v34
    v_mul_f32 v66, s24, v66
    v_mul_f32 v67, v35, v35
    v_mul_f32 v67, s23, v67
    v_fma_f32 v67, v67, v35, v35
    v_mul_f32 v67, s24, v67
    v_mul_f32 v68, v36, v36
    v_mul_f32 v68, s23, v68
    v_fma_f32 v68, v68, v36, v36
    v_mul_f32 v68, s24, v68
    v_mul_f32 v69, v37, v37
    v_mul_f32 v69, s23, v69
    v_fma_f32 v69, v69, v37, v37
    v_mul_f32 v69, s24, v69
    v_mul_f32 v70, v38, v38
    v_mul_f32 v70, s23, v70
    v_fma_f32 v70, v70, v38, v38
    v_mul_f32 v70, s24, v70
    v_mul_f32 v71, v39, v39
    v_mul_f32 v71, s23, v71
    v_fma_f32 v71, v71, v39, v39
    v_mul_f32 v71, s24, v71
    v_exp_f32 v56, v56
    v_exp_f32 v57, v57
    v_exp_f32 v58, v58
    v_exp_f32 v59, v59
    v_exp_f32 v60, v60
    v_exp_f32 v61, v61
    v_exp_f32 v62, v62
    v_exp_f32 v63, v63
    v_exp_f32 v64, v64
    v_exp_f32 v65, v65
    v_exp_f32 v66, v66
    v_exp_f32 v67, v67
    v_exp_f32 v68, v68
    v_exp_f32 v69, v69
    v_exp_f32 v70, v70
    v_exp_f32 v71, v71
    v_add_f32 v56, 1.0, v56
    v_add_f32 v57, 1.0, v57
    v_add_f32 v58, 1.0, v58
    v_add_f32 v59, 1.0, v59
    v_add_f32 v60, 1.0, v60
    v_add_f32 v61, 1.0, v61
    v_add_f32 v62, 1.0, v62
    v_add_f32 v63, 1.0, v63
    v_add_f32 v64, 1.0, v64
    v_add_f32 v65, 1.0, v65
    v_add_f32 v66, 1.0, v66
    v_add_f32 v67, 1.0, v67
    v_add_f32 v68, 1.0, v68
    v_add_f32 v69, 1.0, v69
    v_add_f32 v70, 1.0, v70
    v_add_f32 v71, 1.0, v71
    v_rcp_f32 v56, v56
    v_rcp_f32 v57, v57
    v_rcp_f32 v58, v58
    v_rcp_f32 v59, v59
    v_rcp_f32 v60, v60
    v_rcp_f32 v61, v61
    v_rcp_f32 v62, v62
    v_rcp_f32 v63, v63
    v_rcp_f32 v64, v64
    v_rcp_f32 v65, v65
    v_rcp_f32 v66, v66
    v_rcp_f32 v67, v67
    v_rcp_f32 v68, v68
    v_rcp_f32 v69, v69
    v_rcp_f32 v70, v70
    v_rcp_f32 v71, v71
    v_mul_f32 v24, v24, v56
    v_mul_f32 v25, v25, v57
    v_mul_f32 v26, v26, v58
    v_mul_f32 v27, v27, v59
    v_mul_f32 v28, v28, v60
    v_mul_f32 v29, v29, v61
    v_mul_f32 v30, v30, v62
    v_mul_f32 v31, v31, v63
    v_mul_f32 v32, v32, v64
    v_mul_f32 v33, v33, v65
    v_mul_f32 v34, v34, v66
    v_mul_f32 v35, v35, v67
    v_mul_f32 v36, v36, v68
    v_mul_f32 v37, v37, v69
    v_mul_f32 v38, v38, v70
    v_mul_f32 v39, v39, v71
    v_cvt_pk_bf16_f32 v56, v24, v25
    v_lshlrev_b32 v24, 16, v56
    v_and_b32 v25, 0xffff0000, v56
    v_cvt_pk_bf16_f32 v56, v26, v27
    v_lshlrev_b32 v26, 16, v56
    v_and_b32 v27, 0xffff0000, v56
    v_cvt_pk_bf16_f32 v56, v28, v29
    v_lshlrev_b32 v28, 16, v56
    v_and_b32 v29, 0xffff0000, v56
    v_cvt_pk_bf16_f32 v56, v30, v31
    v_lshlrev_b32 v30, 16, v56
    v_and_b32 v31, 0xffff0000, v56
    v_cvt_pk_bf16_f32 v56, v32, v33
    v_lshlrev_b32 v32, 16, v56
    v_and_b32 v33, 0xffff0000, v56
    v_cvt_pk_bf16_f32 v56, v34, v35
    v_lshlrev_b32 v34, 16, v56
    v_and_b32 v35, 0xffff0000, v56
    v_cvt_pk_bf16_f32 v56, v36, v37
    v_lshlrev_b32 v36, 16, v56
    v_and_b32 v37, 0xffff0000, v56
    v_cvt_pk_bf16_f32 v56, v38, v39
    v_lshlrev_b32 v38, 16, v56
    v_and_b32 v39, 0xffff0000, v56
    v_mul_f32 v24, v24, v40
    v_mul_f32 v25, v25, v41
    v_mul_f32 v26, v26, v42
    v_mul_f32 v27, v27, v43
    v_mul_f32 v28, v28, v44
    v_mul_f32 v29, v29, v45
    v_mul_f32 v30, v30, v46
    v_mul_f32 v31, v31, v47
    v_mul_f32 v32, v32, v48
    v_mul_f32 v33, v33, v49
    v_mul_f32 v34, v34, v50
    v_mul_f32 v35, v35, v51
    v_mul_f32 v36, v36, v52
    v_mul_f32 v37, v37, v53
    v_mul_f32 v38, v38, v54
    v_mul_f32 v39, v39, v55
    v_cvt_pk_bf16_f32 v56, v24, v25
    v_cvt_pk_bf16_f32 v57, v26, v27
    ds_write_b64 v20, v[56:57] offset:0
    v_cvt_pk_bf16_f32 v58, v28, v29
    v_cvt_pk_bf16_f32 v59, v30, v31
    ds_write_b64 v20, v[58:59] offset:512
    v_cvt_pk_bf16_f32 v60, v32, v33
    v_cvt_pk_bf16_f32 v61, v34, v35
    ds_write_b64 v20, v[60:61] offset:1024
    v_cvt_pk_bf16_f32 v62, v36, v37
    v_cvt_pk_bf16_f32 v63, v38, v39
    ds_write_b64 v20, v[62:63] offset:1536
    s_waitcnt lgkmcnt(0)
    s_barrier
    ds_read_b64 v[24:25], v21 offset:0
    ds_read_b64 v[26:27], v21 offset:2048
    ds_read_b64 v[28:29], v21 offset:4096
    ds_read_b64 v[30:31], v21 offset:6144
    ds_read_b64 v[32:33], v21 offset:512
    ds_read_b64 v[34:35], v21 offset:2560
    ds_read_b64 v[36:37], v21 offset:4608
    ds_read_b64 v[38:39], v21 offset:6656
    ds_read_b64 v[40:41], v21 offset:1024
    ds_read_b64 v[42:43], v21 offset:3072
    ds_read_b64 v[44:45], v21 offset:5120
    ds_read_b64 v[46:47], v21 offset:7168
    ds_read_b64 v[48:49], v21 offset:1536
    ds_read_b64 v[50:51], v21 offset:3584
    ds_read_b64 v[52:53], v21 offset:5632
    ds_read_b64 v[54:55], v21 offset:7680
    s_sub_u32 s23, s34, 1
    v_min_u32 v16, v16, v17
    v_cmp_gt_u32 s[40:41], s23, v16
    s_cmp_eq_u64 s[40:41], 0
    s_cbranch_scc1 Ldok_35
    v_lshlrev_b32 v124, 3, v0
    v_add_u32 v124, s60, v124
    s_mov_b32 s90, 0
    s_nop 0
Lpoll_36:
    global_load_dwordx2 v[126:127], v124, s[4:5] sc1
    s_waitcnt vmcnt(0)
    v_min_u32 v126, v126, v127
    v_cmp_gt_u32 s[40:41], s23, v126
    s_cmp_eq_u64 s[40:41], 0
    s_cbranch_scc1 Lpd_37
    s_add_u32 s90, s90, 1
    s_cmp_lt_u32 s90, 400000
    s_nop 0
    s_cbranch_scc1 Lpoll_36
    v_mov_b32 v126, 100
    v_mov_b32 v127, 265
    global_store_dword v126, v127, s[10:11]
    s_waitcnt vmcnt(0)
    s_endpgm
Lpd_37:
Ldok_35:
    s_waitcnt lgkmcnt(0)
    v_mfma_f32_16x16x32_bf16 v[88:91], v[128:131], v[24:27], 0
    v_mfma_f32_16x16x32_bf16 v[92:95], v[128:131], v[32:35], 0
    v_mfma_f32_16x16x32_bf16 v[96:99], v[128:131], v[40:43], 0
    v_mfma_f32_16x16x32_bf16 v[100:103], v[128:131], v[48:51], 0
    v_mfma_f32_16x16x32_bf16 v[88:91], v[132:135], v[28:31], v[88:91]
    v_mfma_f32_16x16x32_bf16 v[92:95], v[132:135], v[36:39], v[92:95]
    v_mfma_f32_16x16x32_bf16 v[96:99], v[132:135], v[44:47], v[96:99]
    v_mfma_f32_16x16x32_bf16 v[100:103], v[132:135], v[52:55], v[100:103]
    s_nop 4
    v_cvt_pk_bf16_f32 v104, v88, v89
    v_cvt_pk_bf16_f32 v105, v90, v91
    v_cvt_pk_bf16_f32 v106, v92, v93
    v_cvt_pk_bf16_f32 v107, v94, v95
    v_cvt_pk_bf16_f32 v108, v96, v97
    v_cvt_pk_bf16_f32 v109, v98, v99
    v_cvt_pk_bf16_f32 v110, v100, v101
    v_cvt_pk_bf16_f32 v111, v102, v103
    v_add_u32 v124, 0, v11
    global_store_dwordx4 v124, v[104:107], s[4:5]
    global_store_dwordx4 v124, v[108:111], s[4:5] offset:1024
    v_mfma_f32_16x16x32_bf16 v[88:91], v[136:139], v[24:27], 0
    v_mfma_f32_16x16x32_bf16 v[92:95], v[136:139], v[32:35], 0
    v_mfma_f32_16x16x32_bf16 v[96:99], v[136:139], v[40:43], 0
    v_mfma_f32_16x16x32_bf16 v[100:103], v[136:139], v[48:51], 0
    v_mfma_f32_16x16x32_bf16 v[88:91], v[140:143], v[28:31], v[88:91]
    v_mfma_f32_16x16x32_bf16 v[92:95], v[140:143], v[36:39], v[92:95]
    v_mfma_f32_16x16x32_bf16 v[96:99], v[140:143], v[44:47], v[96:99]
    v_mfma_f32_16x16x32_bf16 v[100:103], v[140:143], v[52:55], v[100:103]
    s_nop 4
    v_cvt_pk_bf16_f32 v104, v88, v89
    v_cvt_pk_bf16_f32 v105, v90, v91
    v_cvt_pk_bf16_f32 v106, v92, v93
    v_cvt_pk_bf16_f32 v107, v94, v95
    v_cvt_pk_bf16_f32 v108, v96, v97
    v_cvt_pk_bf16_f32 v109, v98, v99
    v_cvt_pk_bf16_f32 v110, v100, v101
    v_cvt_pk_bf16_f32 v111, v102, v103
    v_add_u32 v124, 65536, v11
    global_store_dwordx4 v124, v[104:107], s[4:5]
    global_store_dwordx4 v124, v[108:111], s[4:5] offset:1024
    v_mfma_f32_16x16x32_bf16 v[88:91], v[144:147], v[24:27], 0
    v_mfma_f32_16x16x32_bf16 v[92:95], v[144:147], v[32:35], 0
    v_mfma_f32_16x16x32_bf16 v[96:99], v[144:147], v[40:43], 0
    v_mfma_f32_16x16x32_bf16 v[100:103], v[144:147], v[48:51], 0
    v_mfma_f32_16x16x32_bf16 v[88:91], v[148:151], v[28:31], v[88:91]
    v_mfma_f32_16x16x32_bf16 v[92:95], v[148:151], v[36:39], v[92:95]
    v_mfma_f32_16x16x32_bf16 v[96:99], v[148:151], v[44:47], v[96:99]
    v_mfma_f32_16x16x32_bf16 v[100:103], v[148:151], v[52:55], v[100:103]
    s_nop 4
    v_cvt_pk_bf16_f32 v104, v88, v89
    v_cvt_pk_bf16_f32 v105, v90, v91
    v_cvt_pk_bf16_f32 v106, v92, v93
    v_cvt_pk_bf16_f32 v107, v94, v95
    v_cvt_pk_bf16_f32 v108, v96, v97
    v_cvt_pk_bf16_f32 v109, v98, v99
    v_cvt_pk_bf16_f32 v110, v100, v101
    v_cvt_pk_bf16_f32 v111, v102, v103
    v_add_u32 v124, 131072, v11
    global_store_dwordx4 v124, v[104:107], s[4:5]
    global_store_dwordx4 v124, v[108:111], s[4:5] offset:1024
    v_mfma_f32_16x16x32_bf16 v[88:91], v[152:155], v[24:27], 0
    v_mfma_f32_16x16x32_bf16 v[92:95], v[152:155], v[32:35], 0
    v_mfma_f32_16x16x32_bf16 v[96:99], v[152:155], v[40:43], 0
    v_mfma_f32_16x16x32_bf16 v[100:103], v[152:155], v[48:51], 0
    v_mfma_f32_16x16x32_bf16 v[88:91], v[156:159], v[28:31], v[88:91]
    v_mfma_f32_16x16x32_bf16 v[92:95], v[156:159], v[36:39], v[92:95]
    v_mfma_f32_16x16x32_bf16 v[96:99], v[156:159], v[44:47], v[96:99]
    v_mfma_f32_16x16x32_bf16 v[100:103], v[156:159], v[52:55], v[100:103]
    s_nop 4
    v_cvt_pk_bf16_f32 v104, v88, v89
    v_cvt_pk_bf16_f32 v105, v90, v91
    v_cvt_pk_bf16_f32 v106, v92, v93
    v_cvt_pk_bf16_f32 v107, v94, v95
    v_cvt_pk_bf16_f32 v108, v96, v97
    v_cvt_pk_bf16_f32 v109, v98, v99
    v_cvt_pk_bf16_f32 v110, v100, v101
    v_cvt_pk_bf16_f32 v111, v102, v103
    v_add_u32 v124, 196608, v11
    global_store_dwordx4 v124, v[104:107], s[4:5]
    global_store_dwordx4 v124, v[108:111], s[4:5] offset:1024
    v_mfma_f32_16x16x32_bf16 v[88:91], v[160:163], v[24:27], 0
    v_mfma_f32_16x16x32_bf16 v[92:95], v[160:163], v[32:35], 0
    v_mfma_f32_16x16x32_bf16 v[96:99], v[160:163], v[40:43], 0
    v_mfma_f32_16x16x32_bf16 v[100:103], v[160:163], v[48:51], 0
    v_mfma_f32_16x16x32_bf16 v[88:91], v[164:167], v[28:31], v[88:91]
    v_mfma_f32_16x16x32_bf16 v[92:95], v[164:167], v[36:39], v[92:95]
    v_mfma_f32_16x16x32_bf16 v[96:99], v[164:167], v[44:47], v[96:99]
    v_mfma_f32_16x16x32_bf16 v[100:103], v[164:167], v[52:55], v[100:103]
    s_nop 4
    v_cvt_pk_bf16_f32 v104, v88, v89
    v_cvt_pk_bf16_f32 v105, v90, v91
    v_cvt_pk_bf16_f32 v106, v92, v93
    v_cvt_pk_bf16_f32 v107, v94, v95
    v_cvt_pk_bf16_f32 v108, v96, v97
    v_cvt_pk_bf16_f32 v109, v98, v99
    v_cvt_pk_bf16_f32 v110, v100, v101
    v_cvt_pk_bf16_f32 v111, v102, v103
    v_add_u32 v124, 262144, v11
    global_store_dwordx4 v124, v[104:107], s[4:5]
    global_store_dwordx4 v124, v[108:111], s[4:5] offset:1024
    v_mfma_f32_16x16x32_bf16 v[88:91], v[168:171], v[24:27], 0
    v_mfma_f32_16x16x32_bf16 v[92:95], v[168:171], v[32:35], 0
    v_mfma_f32_16x16x32_bf16 v[96:99], v[168:171], v[40:43], 0
    v_mfma_f32_16x16x32_bf16 v[100:103], v[168:171], v[48:51], 0
    v_mfma_f32_16x16x32_bf16 v[88:91], v[172:175], v[28:31], v[88:91]
    v_mfma_f32_16x16x32_bf16 v[92:95], v[172:175], v[36:39], v[92:95]
    v_mfma_f32_16x16x32_bf16 v[96:99], v[172:175], v[44:47], v[96:99]
    v_mfma_f32_16x16x32_bf16 v[100:103], v[172:175], v[52:55], v[100:103]
    s_nop 4
    v_cvt_pk_bf16_f32 v104, v88, v89
    v_cvt_pk_bf16_f32 v105, v90, v91
    v_cvt_pk_bf16_f32 v106, v92, v93
    v_cvt_pk_bf16_f32 v107, v94, v95
    v_cvt_pk_bf16_f32 v108, v96, v97
    v_cvt_pk_bf16_f32 v109, v98, v99
    v_cvt_pk_bf16_f32 v110, v100, v101
    v_cvt_pk_bf16_f32 v111, v102, v103
    v_add_u32 v124, 327680, v11
    global_store_dwordx4 v124, v[104:107], s[4:5]
    global_store_dwordx4 v124, v[108:111], s[4:5] offset:1024
    v_mfma_f32_16x16x32_bf16 v[88:91], v[176:179], v[24:27], 0
    v_mfma_f32_16x16x32_bf16 v[92:95], v[176:179], v[32:35], 0
    v_mfma_f32_16x16x32_bf16 v[96:99], v[176:179], v[40:43], 0
    v_mfma_f32_16x16x32_bf16 v[100:103], v[176:179], v[48:51], 0
    v_mfma_f32_16x16x32_bf16 v[88:91], v[180:183], v[28:31], v[88:91]
    v_mfma_f32_16x16x32_bf16 v[92:95], v[180:183], v[36:39], v[92:95]
    v_mfma_f32_16x16x32_bf16 v[96:99], v[180:183], v[44:47], v[96:99]
    v_mfma_f32_16x16x32_bf16 v[100:103], v[180:183], v[52:55], v[100:103]
    s_nop 4
    v_cvt_pk_bf16_f32 v104, v88, v89
    v_cvt_pk_bf16_f32 v105, v90, v91
    v_cvt_pk_bf16_f32 v106, v92, v93
    v_cvt_pk_bf16_f32 v107, v94, v95
    v_cvt_pk_bf16_f32 v108, v96, v97
    v_cvt_pk_bf16_f32 v109, v98, v99
    v_cvt_pk_bf16_f32 v110, v100, v101
    v_cvt_pk_bf16_f32 v111, v102, v103
    v_add_u32 v124, 393216, v11
    global_store_dwordx4 v124, v[104:107], s[4:5]
    global_store_dwordx4 v124, v[108:111], s[4:5] offset:1024
    v_mfma_f32_16x16x32_bf16 v[88:91], v[184:187], v[24:27], 0
    v_mfma_f32_16x16x32_bf16 v[92:95], v[184:187], v[32:35], 0
    v_mfma_f32_16x16x32_bf16 v[96:99], v[184:187], v[40:43], 0
    v_mfma_f32_16x16x32_bf16 v[100:103], v[184:187], v[48:51], 0
    v_mfma_f32_16x16x32_bf16 v[88:91], v[188:191], v[28:31], v[88:91]
    v_mfma_f32_16x16x32_bf16 v[92:95], v[188:191], v[36:39], v[92:95]
    v_mfma_f32_16x16x32_bf16 v[96:99], v[188:191], v[44:47], v[96:99]
    v_mfma_f32_16x16x32_bf16 v[100:103], v[188:191], v[52:55], v[100:103]
    s_nop 4
    v_cvt_pk_bf16_f32 v104, v88, v89
    v_cvt_pk_bf16_f32 v105, v90, v91
    v_cvt_pk_bf16_f32 v106, v92, v93
    v_cvt_pk_bf16_f32 v107, v94, v95
    v_cvt_pk_bf16_f32 v108, v96, v97
    v_cvt_pk_bf16_f32 v109, v98, v99
    v_cvt_pk_bf16_f32 v110, v100, v101
    v_cvt_pk_bf16_f32 v111, v102, v103
    v_add_u32 v124, 458752, v11
    global_store_dwordx4 v124, v[104:107], s[4:5]
    global_store_dwordx4 v124, v[108:111], s[4:5] offset:1024
    s_waitcnt vmcnt(0)
    s_barrier
    s_lshl_b32 s23, s21, 2
    s_add_u32 s23, s23, s57
    v_mov_b32 v124, s23
    v_mov_b32 v125, s34
    global_store_dword v124, v125, s[4:5]
    s_nop 0
LF_cons:
    v_and_b32 v124, 31, v0
    v_min_u32 v124, 27, v124
    v_lshlrev_b32 v124, 2, v124
    v_add_u32 v124, s57, v124
    s_mov_b32 s90, 0
    s_nop 0
Lpoll_38:
    global_load_dword v125, v124, s[4:5] sc1
    s_waitcnt vmcnt(0)
    v_cmp_gt_u32 s[40:41], s34, v125
    s_cmp_eq_u64 s[40:41], 0
    s_cbranch_scc1 Lpd_39
    s_add_u32 s90, s90, 1
    s_cmp_lt_u32 s90, 400000
    s_nop 0
    s_cbranch_scc1 Lpoll_38
    v_mov_b32 v126, 104
    v_mov_b32 v127, 266
    global_store_dword v126, v127, s[10:11]
    s_waitcnt vmcnt(0)
    s_endpgm
Lpd_39:
    v_add_u32 v124, 0, v12
    global_load_dwordx4 v[40:43], v124, s[4:5] sc1
    v_add_u32 v124, 4096, v12
    global_load_dwordx4 v[44:47], v124, s[4:5] sc1
    v_add_u32 v124, 8192, v12
    global_load_dwordx4 v[48:51], v124, s[4:5] sc1
    v_add_u32 v124, 12288, v12
    global_load_dwordx4 v[52:55], v124, s[4:5] sc1
    v_add_u32 v124, 16384, v12
    global_load_dwordx4 v[56:59], v124, s[4:5] sc1
    v_add_u32 v124, 20480, v12
    global_load_dwordx4 v[60:63], v124, s[4:5] sc1
    v_add_u32 v124, 24576, v12
    global_load_dwordx4 v[64:67], v124, s[4:5] sc1
    v_add_u32 v124, 28672, v12
    global_load_dwordx4 v[68:71], v124, s[4:5] sc1
    v_add_u32 v124, 32768, v12
    global_load_dwordx4 v[72:75], v124, s[4:5] sc1
    v_add_u32 v124, 36864, v12
    global_load_dwordx4 v[76:79], v124, s[4:5] sc1
    v_add_u32 v124, 40960, v12
    global_load_dwordx4 v[80:83], v124, s[4:5] sc1
    v_add_u32 v124, 45056, v12
    global_load_dwordx4 v[84:87], v124, s[4:5] sc1
    v_add_u32 v124, 49152, v12
    global_load_dwordx4 v[88:91], v124, s[4:5] sc1
    v_add_u32 v124, 53248, v12
    global_load_dwordx4 v[92:95], v124, s[4:5] sc1
    s_waitcnt vmcnt(13)
    v_lshlrev_b32 v24, 16, v40
    v_and_b32 v25, 0xffff0000, v40
    v_lshlrev_b32 v26, 16, v41
    v_and_b32 v27, 0xffff0000, v41
    v_lshlrev_b32 v28, 16, v42
    v_and_b32 v29, 0xffff0000, v42
    v_lshlrev_b32 v30, 16, v43
    v_and_b32 v31, 0xffff0000, v43
    s_waitcnt vmcnt(12)
    v_lshlrev_b32 v124, 16, v44
    v_and_b32 v125, 0xffff0000, v44
    v_pk_add_f32 v[24:25], v[24:25], v[124:125]
    v_lshlrev_b32 v124, 16, v45
    v_and_b32 v125, 0xffff0000, v45
    v_pk_add_f32 v[26:27], v[26:27], v[124:125]
    v_lshlrev_b32 v124, 16, v46
    v_and_b32 v125, 0xffff0000, v46
    v_pk_add_f32 v[28:29], v[28:29], v[124:125]
    v_lshlrev_b32 v124, 16, v47
    v_and_b32 v125, 0xffff0000, v47
    v_pk_add_f32 v[30:31], v[30:31], v[124:125]
    s_waitcnt vmcnt(11)
    v_lshlrev_b32 v124, 16, v48
    v_and_b32 v125, 0xffff0000, v48
    v_pk_add_f32 v[24:25], v[24:25], v[124:125]
    v_lshlrev_b32 v124, 16, v49
    v_and_b32 v125, 0xffff0000, v49
    v_pk_add_f32 v[26:27], v[26:27], v[124:125]
    v_lshlrev_b32 v124, 16, v50
    v_and_b32 v125, 0xffff0000, v50
    v_pk_add_f32 v[28:29], v[28:29], v[124:125]
    v_lshlrev_b32 v124, 16, v51
    v_and_b32 v125, 0xffff0000, v51
    v_pk_add_f32 v[30:31], v[30:31], v[124:125]
    s_waitcnt vmcnt(10)
    v_lshlrev_b32 v124, 16, v52
    v_and_b32 v125, 0xffff0000, v52
    v_pk_add_f32 v[24:25], v[24:25], v[124:125]
    v_lshlrev_b32 v124, 16, v53
    v_and_b32 v125, 0xffff0000, v53
    v_pk_add_f32 v[26:27], v[26:27], v[124:125]
    v_lshlrev_b32 v124, 16, v54
    v_and_b32 v125, 0xffff0000, v54
    v_pk_add_f32 v[28:29], v[28:29], v[124:125]
    v_lshlrev_b32 v124, 16, v55
    v_and_b32 v125, 0xffff0000, v55
    v_pk_add_f32 v[30:31], v[30:31], v[124:125]
    s_waitcnt vmcnt(9)
    v_lshlrev_b32 v124, 16, v56
    v_and_b32 v125, 0xffff0000, v56
    v_pk_add_f32 v[24:25], v[24:25], v[124:125]
    v_lshlrev_b32 v124, 16, v57
    v_and_b32 v125, 0xffff0000, v57
    v_pk_add_f32 v[26:27], v[26:27], v[124:125]
    v_lshlrev_b32 v124, 16, v58
    v_and_b32 v125, 0xffff0000, v58
    v_pk_add_f32 v[28:29], v[28:29], v[124:125]
    v_lshlrev_b32 v124, 16, v59
    v_and_b32 v125, 0xffff0000, v59
    v_pk_add_f32 v[30:31], v[30:31], v[124:125]
    s_waitcnt vmcnt(8)
    v_lshlrev_b32 v124, 16, v60
    v_and_b32 v125, 0xffff0000, v60
    v_pk_add_f32 v[24:25], v[24:25], v[124:125]
    v_lshlrev_b32 v124, 16, v61
    v_and_b32 v125, 0xffff0000, v61
    v_pk_add_f32 v[26:27], v[26:27], v[124:125]
    v_lshlrev_b32 v124, 16, v62
    v_and_b32 v125, 0xffff0000, v62
    v_pk_add_f32 v[28:29], v[28:29], v[124:125]
    v_lshlrev_b32 v124, 16, v63
    v_and_b32 v125, 0xffff0000, v63
    v_pk_add_f32 v[30:31], v[30:31], v[124:125]
    s_waitcnt vmcnt(7)
    v_lshlrev_b32 v124, 16, v64
    v_and_b32 v125, 0xffff0000, v64
    v_pk_add_f32 v[24:25], v[24:25], v[124:125]
    v_lshlrev_b32 v124, 16, v65
    v_and_b32 v125, 0xffff0000, v65
    v_pk_add_f32 v[26:27], v[26:27], v[124:125]
    v_lshlrev_b32 v124, 16, v66
    v_and_b32 v125, 0xffff0000, v66
    v_pk_add_f32 v[28:29], v[28:29], v[124:125]
    v_lshlrev_b32 v124, 16, v67
    v_and_b32 v125, 0xffff0000, v67
    v_pk_add_f32 v[30:31], v[30:31], v[124:125]
    s_waitcnt vmcnt(6)
    v_lshlrev_b32 v124, 16, v68
    v_and_b32 v125, 0xffff0000, v68
    v_pk_add_f32 v[24:25], v[24:25], v[124:125]
    v_lshlrev_b32 v124, 16, v69
    v_and_b32 v125, 0xffff0000, v69
    v_pk_add_f32 v[26:27], v[26:27], v[124:125]
    v_lshlrev_b32 v124, 16, v70
    v_and_b32 v125, 0xffff0000, v70
    v_pk_add_f32 v[28:29], v[28:29], v[124:125]
    v_lshlrev_b32 v124, 16, v71
    v_and_b32 v125, 0xffff0000, v71
    v_pk_add_f32 v[30:31], v[30:31], v[124:125]
    s_waitcnt vmcnt(5)
    v_lshlrev_b32 v124, 16, v72
    v_and_b32 v125, 0xffff0000, v72
    v_pk_add_f32 v[24:25], v[24:25], v[124:125]
    v_lshlrev_b32 v124, 16, v73
    v_and_b32 v125, 0xffff0000, v73
    v_pk_add_f32 v[26:27], v[26:27], v[124:125]
    v_lshlrev_b32 v124, 16, v74
    v_and_b32 v125, 0xffff0000, v74
    v_pk_add_f32 v[28:29], v[28:29], v[124:125]
    v_lshlrev_b32 v124, 16, v75
    v_and_b32 v125, 0xffff0000, v75
    v_pk_add_f32 v[30:31], v[30:31], v[124:125]
    s_waitcnt vmcnt(4)
    v_lshlrev_b32 v124, 16, v76
    v_and_b32 v125, 0xffff0000, v76
    v_pk_add_f32 v[24:25], v[24:25], v[124:125]
    v_lshlrev_b32 v124, 16, v77
    v_and_b32 v125, 0xffff0000, v77
    v_pk_add_f32 v[26:27], v[26:27], v[124:125]
    v_lshlrev_b32 v124, 16, v78
    v_and_b32 v125, 0xffff0000, v78
    v_pk_add_f32 v[28:29], v[28:29], v[124:125]
    v_lshlrev_b32 v124, 16, v79
    v_and_b32 v125, 0xffff0000, v79
    v_pk_add_f32 v[30:31], v[30:31], v[124:125]
    s_waitcnt vmcnt(3)
    v_lshlrev_b32 v124, 16, v80
    v_and_b32 v125, 0xffff0000, v80
    v_pk_add_f32 v[24:25], v[24:25], v[124:125]
    v_lshlrev_b32 v124, 16, v81
    v_and_b32 v125, 0xffff0000, v81
    v_pk_add_f32 v[26:27], v[26:27], v[124:125]
    v_lshlrev_b32 v124, 16, v82
    v_and_b32 v125, 0xffff0000, v82
    v_pk_add_f32 v[28:29], v[28:29], v[124:125]
    v_lshlrev_b32 v124, 16, v83
    v_and_b32 v125, 0xffff0000, v83
    v_pk_add_f32 v[30:31], v[30:31], v[124:125]
    s_waitcnt vmcnt(2)
    v_lshlrev_b32 v124, 16, v84
    v_and_b32 v125, 0xffff0000, v84
    v_pk_add_f32 v[24:25], v[24:25], v[124:125]
    v_lshlrev_b32 v124, 16, v85
    v_and_b32 v125, 0xffff0000, v85
    v_pk_add_f32 v[26:27], v[26:27], v[124:125]
    v_lshlrev_b32 v124, 16, v86
    v_and_b32 v125, 0xffff0000, v86
    v_pk_add_f32 v[28:29], v[28:29], v[124:125]
    v_lshlrev_b32 v124, 16, v87
    v_and_b32 v125, 0xffff0000, v87
    v_pk_add_f32 v[30:31], v[30:31], v[124:125]
    s_waitcnt vmcnt(1)
    v_lshlrev_b32 v124, 16, v88
    v_and_b32 v125, 0xffff0000, v88
    v_pk_add_f32 v[24:25], v[24:25], v[124:125]
    v_lshlrev_b32 v124, 16, v89
    v_and_b32 v125, 0xffff0000, v89
    v_pk_add_f32 v[26:27], v[26:27], v[124:125]
    v_lshlrev_b32 v124, 16, v90
    v_and_b32 v125, 0xffff0000, v90
    v_pk_add_f32 v[28:29], v[28:29], v[124:125]
    v_lshlrev_b32 v124, 16, v91
    v_and_b32 v125, 0xffff0000, v91
    v_pk_add_f32 v[30:31], v[30:31], v[124:125]
    s_waitcnt vmcnt(0)
    v_lshlrev_b32 v124, 16, v92
    v_and_b32 v125, 0xffff0000, v92
    v_pk_add_f32 v[24:25], v[24:25], v[124:125]
    v_lshlrev_b32 v124, 16, v93
    v_and_b32 v125, 0xffff0000, v93
    v_pk_add_f32 v[26:27], v[26:27], v[124:125]
    v_lshlrev_b32 v124, 16, v94
    v_and_b32 v125, 0xffff0000, v94
    v_pk_add_f32 v[28:29], v[28:29], v[124:125]
    v_lshlrev_b32 v124, 16, v95
    v_and_b32 v125, 0xffff0000, v95
    v_pk_add_f32 v[30:31], v[30:31], v[124:125]
    s_lshl_b32 s23, s52, 2
    s_add_u32 s23, s23, s60
    v_mov_b32 v124, s23
    v_mov_b32 v125, s34
    global_store_dword v124, v125, s[4:5]
    v_mov_b32 v32, v24
    s_nop 1
    v_permlane32_swap_b32 v24, v32
    v_add_f32 v24, v24, v32
    v_mov_b32 v33, v25
    s_nop 1
    v_permlane32_swap_b32 v25, v33
    v_add_f32 v25, v25, v33
    v_mov_b32 v34, v26
    s_nop 1
    v_permlane32_swap_b32 v26, v34
    v_add_f32 v26, v26, v34
    v_mov_b32 v35, v27
    s_nop 1
    v_permlane32_swap_b32 v27, v35
    v_add_f32 v27, v27, v35
    v_mov_b32 v36, v28
    s_nop 1
    v_permlane32_swap_b32 v28, v36
    v_add_f32 v28, v28, v36
    v_mov_b32 v37, v29
    s_nop 1
    v_permlane32_swap_b32 v29, v37
    v_add_f32 v29, v29, v37
    v_mov_b32 v38, v30
    s_nop 1
    v_permlane32_swap_b32 v30, v38
    v_add_f32 v30, v30, v38
    v_mov_b32 v39, v31
    s_nop 1
    v_permlane32_swap_b32 v31, v39
    v_add_f32 v31, v31, v39
    v_cndmask_b32 v24, v24, v28, s[58:59]
    v_cndmask_b32 v25, v25, v29, s[58:59]
    v_cndmask_b32 v26, v26, v30, s[58:59]
    v_cndmask_b32 v27, v27, v31, s[58:59]
    s_lshl_b32 s23, s35, 16
    v_add_u32 v124, s23, v13
    v_cvt_pk_bf16_f32 v34, v24, v25
    v_cvt_pk_bf16_f32 v35, v26, v27
    v_lshlrev_b32 v24, 16, v34
    v_and_b32 v25, 0xffff0000, v34
    v_lshlrev_b32 v28, 16, v22
    v_and_b32 v29, 0xffff0000, v22
    v_lshlrev_b32 v26, 16, v35
    v_and_b32 v27, 0xffff0000, v35
    v_lshlrev_b32 v30, 16, v23
    v_and_b32 v31, 0xffff0000, v23
    v_add_f32 v24, v24, v28
    v_add_f32 v25, v25, v29
    v_add_f32 v26, v26, v30
    v_add_f32 v27, v27, v31
    v_cvt_pk_bf16_f32 v32, v24, v25
    v_cvt_pk_bf16_f32 v33, v26, v27
    s_cmp_eq_u32 s61, 0
    s_cbranch_scc0 Lfo_40
    v_add_u32 v125, 31457280, v124
    global_store_dwordx2 v125, v[32:33], s[4:5] sc1
    s_waitcnt vmcnt(0)
    s_lshl_b32 s23, s35, 7
    s_add_u32 s23, s23, s52
    s_lshl_b32 s23, s23, 2
    s_add_u32 s23, s23, 163840
    v_mov_b32 v124, s23
    v_mov_b32 v125, 1
    global_store_dword v124, v125, s[4:5] sc1
    s_branch Lfo_41
Lfo_40:
    global_store_dwordx2 v124, v[32:33], s[8:9]
Lfo_41:
    s_add_u32 s34, s34, 1
    s_branch LF_item
LF_done:
    s_waitcnt vmcnt(0)
    s_endpgm
.p2align 6
Ltab_A:
.long 0, 2, 4, 6, 32, 33, 34, 35, 36, 37, 38, 39, 40, 41, 42, 43, 44, 45, 46, 47, 48, 49, 50, 51, 52, 53, 54, 55, 56, 58, 60, 62, 255, 255, 255, 255, 255, 255, 255, 255, 255, 255, 255, 255, 255, 255, 255, 255, 255, 255, 255, 255, 255, 255, 255, 255, 255, 255, 255, 255, 255, 255, 255, 255
.long 1, 3, 5, 7, 8, 9, 10, 11, 12, 13, 14, 15, 16, 17, 18, 19, 20, 21, 22, 23, 24, 25, 26, 27, 28, 29, 30, 31, 57, 59, 61, 63, 255, 255, 255, 255, 255, 255, 255, 255, 255, 255, 255, 255, 255, 255, 255, 255, 255, 255, 255, 255, 255, 255, 255, 255, 255, 255, 255, 255, 255, 255, 255, 255
Ltab_F:
.long 0, 3, 32, 7, 35, 10, 38, 13, 41, 16, 44, 19, 47, 22, 50, 25, 53, 28, 56, 31, 60, 63, 255, 255, 255, 255, 255, 255, 255, 255, 255, 255, 255, 255, 255, 255, 255, 255, 255, 255, 255, 255, 255, 255, 255, 255, 255, 255, 255, 255, 255, 255, 255, 255, 255, 255, 255, 255, 255, 255, 255, 255, 255, 255
.long 1, 4, 6, 34, 9, 37, 12, 40, 15, 43, 18, 46, 21, 49, 24, 52, 27, 55, 30, 58, 61, 255, 255, 255, 255, 255, 255, 255, 255, 255, 255, 255, 255, 255, 255, 255, 255, 255, 255, 255, 255, 255, 255, 255, 255, 255, 255, 255, 255, 255, 255, 255, 255, 255, 255, 255, 255, 255, 255, 255, 255, 255, 255, 255
.long 2, 5, 33, 8, 36, 11, 39, 14, 42, 17, 45, 20, 48, 23, 51, 26, 54, 29, 57, 59, 62, 255, 255, 255, 255, 255, 255, 255, 255, 255, 255, 255, 255, 255, 255, 255, 255, 255, 255, 255, 255, 255, 255, 255, 255, 255, 255, 255, 255, 255, 255, 255, 255, 255, 255, 255, 255, 255, 255, 255, 255, 255, 255, 255
.section .rodata,"a"
.p2align 6
.amdhsa_kernel mega_kernel
  .amdhsa_next_free_vgpr 512
  .amdhsa_next_free_sgpr 102
  .amdhsa_accum_offset 256
  .amdhsa_group_segment_fixed_size 0
  .amdhsa_kernarg_size 112
  .amdhsa_user_sgpr_count 2
  .amdhsa_user_sgpr_kernarg_segment_ptr 1
  .amdhsa_system_sgpr_workgroup_id_x 1
.end_amdhsa_kernel
```
